```python
import torch

def _softmax(x, axis=-1):
    return torch.softmax(x, dim=axis)
def _gelu(x):
    return torch.nn.functional.gelu(x, approximate="tanh")
def _silu(x):
    return torch.nn.functional.silu(x)
def _sigmoid(x):
    return torch.sigmoid(x)
def _layernorm(x, axis=-1, eps=1e-5):
    m = x.mean(dim=axis, keepdim=True)
    v = x.var(dim=axis, keepdim=True, unbiased=False)
    return (x - m) / torch.sqrt(v + eps)
def _scatter_add(tgt, idx, src, axis=0):
    return tgt.clone().index_add_(axis, idx, src)
def _segment_sum(src, seg, n):
    out = torch.zeros((n,) + src.shape[1:], dtype=src.dtype)
    return out.index_add_(0, seg, src)
def _pad(x, pw):
    flat = tuple(v for pair in reversed(pw) for v in pair)
    return torch.nn.functional.pad(x, flat)

kernel_name = 'sequential_preLN__ssm_conv_s4__dense_activation_gelu__prompt'

def setup_inputs():

    _w = (lambda a: (lambda t: t.to(torch.bfloat16) if t.is_floating_point() else t)(torch.as_tensor(a)))
    def _A_setup():
        B, L, D, N = 1, 2048, 640, 192
        A_re = -(lambda _x: torch.exp(torch.as_tensor(_x)))((lambda *s: torch.randn(*s, dtype=torch.bfloat16) * 6.4)(D, N))
        A_im = torch.pi * (lambda *s: torch.randn(*s, dtype=torch.bfloat16) * 0.05)(D, N)
        B_re = (lambda *s: torch.randn(*s, dtype=torch.bfloat16) * 0.05)(D, N)
        B_im = (lambda *s: torch.randn(*s, dtype=torch.bfloat16) * 0.05)(D, N)
        C_re = (lambda *s: torch.randn(*s, dtype=torch.bfloat16) * 0.05)(D, N)
        C_im = (lambda *s: torch.randn(*s, dtype=torch.bfloat16) * 0.05)(D, N)
        log_dt = (lambda *s: torch.randn(*s, dtype=torch.bfloat16) * 0.05)(D) * 0.5 - 4.0
        Dskip = (lambda *s: torch.randn(*s, dtype=torch.bfloat16) * 0.05)(D)
        return {
            "u": _w((lambda *s: torch.randn(*s, dtype=torch.bfloat16) * 0.05)(B, L, D)),
            "A_re": _w(A_re),
            "A_im": _w(A_im),
            "B_re": _w(B_re),
            "B_im": _w(B_im),
            "C_re": _w(C_re),
            "C_im": _w(C_im),
            "log_dt": _w(log_dt),
            "Dskip": _w(Dskip),
        }
    _A_in = _A_setup()

    def _B_setup():
        B, S, D, F = 1, 2048, 640, 1536
        return {
            "x": _w((lambda *s: torch.randn(*s, dtype=torch.bfloat16) * 0.05)(B, S, D)),
            "w1": _w((lambda *s: torch.randn(*s, dtype=torch.bfloat16) * 0.8)(D, F) * (D ** -0.5)),
            "b1": _w((lambda *s: torch.randn(*s, dtype=torch.bfloat16) * 12.8)(F) * 0.01),
            "w2": _w((lambda *s: torch.randn(*s, dtype=torch.bfloat16) * 0.4)(F, D) * (F ** -0.5)),
            "b2": _w((lambda *s: torch.randn(*s, dtype=torch.bfloat16) * 6.4)(D) * 0.01),
        }
    _B_in = _B_setup()

    return {
        "A_u": _A_in["u"],
        "A_A_re": _A_in["A_re"],
        "A_A_im": _A_in["A_im"],
        "A_B_re": _A_in["B_re"],
        "A_B_im": _A_in["B_im"],
        "A_C_re": _A_in["C_re"],
        "A_C_im": _A_in["C_im"],
        "A_log_dt": _A_in["log_dt"],
        "A_Dskip": _A_in["Dskip"],
        "B_x": _B_in["x"],
        "B_w1": _B_in["w1"],
        "B_b1": _B_in["b1"],
        "B_w2": _B_in["w2"],
        "B_b2": _B_in["b2"],
    }

def reference(A_u, A_A_re, A_A_im, A_B_re, A_B_im, A_C_re, A_C_im, A_log_dt, A_Dskip, B_x, B_w1, B_b1, B_w2, B_b2):
    def _A_ref(u, A_re, A_im, B_re, B_im, C_re, C_im, log_dt, Dskip):
        Bsz, L, D = u.shape
        dt = torch.exp(log_dt)[:, None]
        A = A_re + 1j * A_im
        Bc = B_re + 1j * B_im
        Cc = C_re + 1j * C_im
        logdA = dt * A
        dB = dt * Bc
        l = (lambda x, dt: x.to(dt))(torch.arange(L), A_re.dtype)
        P = torch.exp(logdA[:, :, None] * l[None, None, :])
        K = torch.einsum("dn,dnl,dn->dl", Cc, P, dB).real
        L2 = 2 * L
        Kp = _pad(K, ((0, 0), (0, L)))
        up = (lambda x, *d: x.permute(*d))(u, 0, 2, 1)
        up = _pad(up, ((0, 0), (0, 0), (0, L)))
        Kf = (lambda x, axes=(-2,-1): torch.fft.rfft2(x.float(), dim=axes))(Kp[:, None, :], axes=(-2, -1))
        Uf = (lambda x, axes=(-2,-1): torch.fft.rfft2(x.float(), dim=axes))(up[:, :, None, :], axes=(-2, -1))
        Yf = Uf * Kf[None, :, :, :]
        y = (lambda x, s, axes=(-2,-1): torch.fft.irfft2(x, s=s, dim=axes).to(torch.bfloat16))(Yf, (1, L2), axes=(-2, -1))[:, :, 0, :L]
        y = (lambda x, *d: x.permute(*d))(y, 0, 2, 1) + u * Dskip[None, None, :]
        return y

    def _B_ref(x, w1, b1, w2, b2):
        h = torch.einsum("bsd,df->bsf", x, w1) + b1
        h = _gelu(h)
        return torch.einsum("bsf,fd->bsd", h, w2) + b2

    x = A_u
    h = x + _A_ref(_layernorm(x, axis=-1), A_A_re, A_A_im, A_B_re, A_B_im, A_C_re, A_C_im, A_log_dt, A_Dskip)
    h2 = h + _B_ref(_layernorm(h, axis=-1), B_w1, B_b1, B_w2, B_b2)
    return h2
```

```asm
; @launch grid=(256,1,1) block=(256,1,1) lds=163840
.amdgcn_target "amdgcn-amd-amdhsa--gfx950"
.text
.globl sequential_preLN__ssm_conv_s4__dense_activation_gelu__prompt_kernel
.p2align 8
.type sequential_preLN__ssm_conv_s4__dense_activation_gelu__prompt_kernel,@function
sequential_preLN__ssm_conv_s4__dense_activation_gelu__prompt_kernel:
    s_cmp_ge_u32 s2, 256
    s_cbranch_scc1 L_end
    s_nop 0
    s_load_dwordx16 s[4:19], s[0:1], 0
    s_load_dwordx4 s[20:23], s[0:1], 64
    s_load_dwordx8 s[24:31], s[0:1], 80
    s_load_dwordx4 s[32:35], s[0:1], 112
    s_load_dwordx2 s[36:37], s[0:1], 128
    v_and_b32 v1, 63, v0
    v_lshrrev_b32 v2, 6, v0
    s_lshr_b32 s72, s2, 3
    v_readfirstlane_b32 s60, v2
    s_getpc_b64 s[38:39]
    s_mul_i32 s3, s72, 1536
    v_mad_u32_u24 v2, v2, 3, v1
    v_lshl_add_u32 v2, v2, 7, s3
    s_mov_b64 exec, 7
    global_load_dword v249, v2, s[38:39]
    s_mov_b64 exec, -1
    s_and_b32 s3, s2, 7
    s_lshl_b32 s61, s3, 5
    s_add_u32 s61, s61, s72
    s_and_b32 s66, s61, 1
    s_lshr_b32 s65, s61, 1
    s_mul_i32 s65, s65, 5
    s_mul_i32 s64, s66, 3
    s_add_u32 s64, s64, s65
    s_add_u32 s65, s65, 2
    s_cmp_eq_u32 s60, 3
    s_cbranch_scc1 L_w3
    s_add_u32 s73, s64, s60
    s_cmp_lt_u32 s60, 2
    s_cselect_b32 s73, s73, s65
    s_mul_i32 s74, s73, 384
    v_mul_u32_u24 v2, 6, v1
    v_and_b32 v2, 0x1fc, v2
    v_add_u32 v2, s74, v2
    s_lshl_b32 s74, s73, 1
    v_mov_b32 v3, s74
    s_waitcnt lgkmcnt(0)
    global_load_ushort v70, v3, s[18:19]
    global_load_dwordx2 v[4:5], v2, s[6:7]
    global_load_dwordx2 v[6:7], v2, s[8:9]
    global_load_dwordx2 v[8:9], v2, s[10:11]
    global_load_dwordx2 v[10:11], v2, s[12:13]
    global_load_dwordx2 v[12:13], v2, s[14:15]
    global_load_dwordx2 v[14:15], v2, s[16:17]
    global_load_ushort v71, v3, s[20:21]
    s_branch L_kbody
L_w3:
    s_lshr_b32 s62, s61, 2
    s_and_b32 s63, s61, 3
    v_lshrrev_b32 v2, 2, v1
    v_mul_u32_u24 v2, 1280, v2
    v_and_b32 v57, 3, v1
    v_lshl_add_u32 v2, v57, 4, v2
    s_mul_i32 s72, s62, 40960
    s_mul_i32 s73, s63, 320
    s_add_u32 s73, s73, s72
    s_mov_b32 s42, 2621440
    s_mov_b32 s43, 0x20000
    s_mov_b32 m0, 77824
    s_waitcnt lgkmcnt(0)
    s_mov_b64 s[40:41], s[4:5]
    buffer_load_dwordx4 v2, s[40:43], s73 offen offset:0 lds
    s_add_u32 m0, m0, 960
    s_nop 0
    buffer_load_dwordx4 v2, s[40:43], s73 offen offset:64 lds
    s_add_u32 m0, m0, 960
    s_nop 0
    buffer_load_dwordx4 v2, s[40:43], s73 offen offset:128 lds
    s_add_u32 m0, m0, 960
    s_nop 0
    buffer_load_dwordx4 v2, s[40:43], s73 offen offset:192 lds
    s_add_u32 m0, m0, 960
    s_nop 0
    buffer_load_dwordx4 v2, s[40:43], s73 offen offset:256 lds
    s_add_u32 m0, m0, 1280
    s_add_u32 s73, s73, 20480
    buffer_load_dwordx4 v2, s[40:43], s73 offen offset:0 lds
    s_add_u32 m0, m0, 960
    s_nop 0
    buffer_load_dwordx4 v2, s[40:43], s73 offen offset:64 lds
    s_add_u32 m0, m0, 960
    s_nop 0
    buffer_load_dwordx4 v2, s[40:43], s73 offen offset:128 lds
    s_add_u32 m0, m0, 960
    s_nop 0
    buffer_load_dwordx4 v2, s[40:43], s73 offen offset:192 lds
    s_add_u32 m0, m0, 960
    s_nop 0
    buffer_load_dwordx4 v2, s[40:43], s73 offen offset:256 lds
    v_lshrrev_b32 v8, 3, v1
    v_and_b32 v10, 7, v1
    v_mul_u32_u24 v7, 1280, v8
    v_lshl_add_u32 v7, v10, 4, v7
    s_mul_i32 s74, s61, 10240
    buffer_load_dwordx4 v[12:15], v7, s[40:43], s74 offen offset:0
    buffer_load_dwordx4 v[16:19], v7, s[40:43], s74 offen offset:128
    buffer_load_dwordx4 v[20:23], v7, s[40:43], s74 offen offset:256
    buffer_load_dwordx4 v[24:27], v7, s[40:43], s74 offen offset:384
    buffer_load_dwordx4 v[28:31], v7, s[40:43], s74 offen offset:512
    buffer_load_dwordx4 v[32:35], v7, s[40:43], s74 offen offset:640
    buffer_load_dwordx4 v[36:39], v7, s[40:43], s74 offen offset:768
    buffer_load_dwordx4 v[40:43], v7, s[40:43], s74 offen offset:896
    buffer_load_dwordx4 v[44:47], v7, s[40:43], s74 offen offset:1024
    buffer_load_dwordx4 v[48:51], v7, s[40:43], s74 offen offset:1152
    s_mov_b32 s52, s36
    s_mov_b32 s53, s37
    s_mov_b32 s54, 268435456
    s_mov_b32 s55, 0x20000
    v_mov_b32 v53, 0
    buffer_load_dword v250, v53, s[52:55], 0 offen sc1
    s_branch L_w3body
L_kbody:
    s_mov_b32 s52, s36
    s_mov_b32 s53, s37
    s_mov_b32 s54, 268435456
    s_mov_b32 s55, 0x20000
    s_and_b32 s3, s2, 7
    s_lshr_b32 s72, s2, 3
    s_lshr_b32 s67, s3, 1
    s_lshl_b32 s67, s67, 2
    s_lshr_b32 s73, s72, 3
    s_add_u32 s67, s67, s73
    s_and_b32 s68, s3, 1
    s_lshl_b32 s68, s68, 3
    s_and_b32 s74, s72, 7
    s_add_u32 s68, s68, s74
    s_lshr_b32 s67, s3, 2
    s_lshl_b32 s67, s67, 3
    s_lshr_b32 s75, s72, 2
    s_add_u32 s67, s67, s75
    s_and_b32 s68, s3, 3
    s_lshl_b32 s68, s68, 2
    s_and_b32 s75, s72, 3
    s_add_u32 s68, s68, s75
    s_lshr_b32 s69, s3, 1
    s_lshl_b32 s69, s69, 3
    s_lshr_b32 s73, s72, 2
    s_add_u32 s69, s69, s73
    s_and_b32 s70, s3, 1
    s_lshl_b32 s70, s70, 2
    s_and_b32 s74, s72, 3
    s_add_u32 s70, s70, s74
    s_mov_b32 s56, s32
    s_mov_b32 s57, s33
    s_mov_b32 s58, 2621440
    s_mov_b32 s59, 0x20000
    s_mul_i32 s3, s60, 4352
    s_add_u32 m0, s3, 0
    v_and_b32 v126, 15, v1
    v_mul_u32_u24 v126, 272, v126
    v_lshrrev_b32 v127, 4, v1
    v_lshl_add_u32 v126, v127, 4, v126
    v_add_u32 v126, m0, v126
    v_mov_b32 v127, 0x3f80
    v_and_b32 v16, 1, v1
    v_cmp_eq_u32 vcc, 0, v16
    v_mov_b32 v16, 0x07060c0c
    v_mov_b32 v17, 0x01000c0c
    v_cndmask_b32 v16, v16, v17, vcc
    s_mul_i32 s3, s60, 4352
    s_add_u32 s3, s3, 0
    v_and_b32 v18, 15, v1
    v_lshrrev_b32 v19, 4, v1
    v_lshlrev_b32 v184, 5, v18
    v_lshl_add_u32 v184, v19, 3, v184
    v_add_u32 v184, s3, v184
    v_lshlrev_b32 v185, 4, v18
    v_lshl_add_u32 v185, v19, 3, v185
    v_lshlrev_b32 v20, 3, v18
    v_lshl_add_u32 v20, v19, 7, v20
    v_cmp_gt_u32 vcc, 2, v19
    v_lshlrev_b32 v186, 2, v18
    v_lshl_add_u32 v186, v19, 7, v186
    v_cndmask_b32 v185, v20, v185, vcc
    v_add_u32 v185, s3, v185
    v_add_u32 v186, s3, v186
    v_mov_b32 v187, s3
    v_lshl_add_u32 v188, v1, 2, s3
    v_add_u32 v188, 772, v188
    v_and_b32_e64 v20, 31, v1
    v_lshl_add_u32 v189, v20, 3, s3
    v_lshl_add_u32 v190, v20, 4, s3
    s_mul_i32 s3, s60, 9152
    s_add_u32 s3, s3, 25024
    v_lshl_add_u32 v191, v1, 5, s3
    v_lshl_add_u32 v192, v1, 4, s3
    v_lshrrev_b32 v21, 5, v1
    v_mul_u32_u24 v194, 4576, v21
    v_lshl_add_u32 v194, v20, 4, v194
    v_add_u32 v194, s3, v194
    v_mov_b32 v24, 0
    v_mov_b32 v25, 0
    v_mov_b32 v26, 0
    v_mov_b32 v27, 0
    s_mov_b32 exec_lo, 0x0fffffff
    s_mov_b32 exec_hi, 0x0fffffff
    ds_write_b128 v194, v[24:27]
    s_mov_b64 exec, -1
    v_cmp_eq_u32 vcc, 0, v21
    v_mov_b32 v22, 0x3020504
    v_mov_b32 v23, 0x5040706
    v_mov_b32 v28, 0x1000302
    v_mov_b32 v197, 0x3020302
    v_cndmask_b32 v195, v23, v22, vcc
    v_cndmask_b32 v196, v22, v28, vcc
    v_cmp_eq_u32 vcc, 0, v1
    s_nop 1
    v_cndmask_b32 v197, v197, v28, vcc
    s_lshr_b32 s72, s60, 1
    s_and_b32 s73, s60, 1
    v_and_b32 v52, 15, v1
    v_lshrrev_b32 v53, 4, v1
    v_and_b32 v54, 1, v1
    v_mul_u32_u24 v55, 4576, v54
    v_lshl_add_u32 v55, v53, 4, v55
    v_lshrrev_b32 v56, 1, v52
    v_lshl_add_u32 v166, v56, 6, v55
    v_xor_b32 v56, s73, v56
    v_lshl_add_u32 v164, v56, 6, v55
    v_xor_b32 v54, 1, v54
    v_mul_u32_u24 v56, 4220, v54
    v_lshl_add_u32 v56, v52, 2, v56
    v_lshlrev_b32 v57, 4, v53
    v_sub_u32 v56, v56, v57
    s_mul_i32 s74, s72, 9152
    s_lshl_b32 s75, s73, 8
    s_add_u32 s74, s74, s75
    s_add_u32 s74, s74, 25024
    v_add_u32 v164, s74, v164
    s_mul_i32 s74, s72, 8448
    s_sub_u32 s74, s74, s75
    s_add_u32 s74, s74, 52788
    v_add_u32 v165, s74, v56
    s_lshl_b32 s75, s60, 7
    s_add_u32 s74, s75, 43328
    v_add_u32 v166, s74, v166
    s_sub_u32 s74, 69812, s75
    v_add_u32 v167, s74, v56
    v_lshlrev_b32 v168, 7, v53
    v_lshl_add_u32 v168, v52, 2, v168
    v_mul_u32_u24 v169, 81920, v53
    v_lshl_add_u32 v169, v52, 2, v169
    v_lshlrev_b32 v176, 4, v1
    s_lshl_b32 s74, s60, 12
    v_add_u32 v170, s74, v176
    v_xor_b32 v171, 4096, v170
    s_lshl_b32 s74, s72, 10
    s_lshl_b32 s75, s73, 3
    s_add_u32 s74, s74, s75
    v_add_u32 v148, s74, v176
    s_mul_i32 s76, s72, 3
    s_xor_b32 s76, s76, s66
    s_add_u32 s74, s64, s72
    s_lshl_b32 s75, s73, 6
    s_lshl_b32 s84, s74, 12
    s_add_u32 s84, s84, s75
    s_add_u32 s84, s84, 1048576
    s_lshl_b32 s85, s65, 12
    s_add_u32 s85, s85, s75
    s_lshl_b32 s75, s76, 9
    s_add_u32 s85, s85, s75
    s_add_u32 s85, s85, 1048576
    s_mul_i32 s75, s73, 40960
    s_add_u32 s75, s75, 8388608
    s_lshl_b32 s88, s74, 6
    s_add_u32 s88, s88, s75
    s_lshl_b32 s89, s65, 6
    s_add_u32 s89, s89, s75
    s_mul_i32 s75, s76, 327680
    s_add_u32 s89, s89, s75
    s_mul_i32 s32, s68, 40
    s_mul_i32 s74, s73, 20
    s_add_u32 s32, s32, s74
    s_mul_i32 s32, s32, 3072
    s_add_u32 s32, s32, 4194304
    s_mov_b32 s80, s32
    s_mul_i32 s75, s73, 43008
    s_add_u32 s75, s75, 77824
    s_lshl_b32 s74, s72, 10
    s_add_u32 s81, s75, s74
    v_add_u32 v149, s74, v176
    s_lshl_b32 s74, s73, 8
    v_xor_b32 v175, s74, v176
    v_add_u32 v181, s75, v175
    s_mul_i32 s74, s70, 80
    s_add_u32 s75, s74, 79
    s_lshr_b32 s74, s74, 7
    s_lshr_b32 s75, s75, 7
    s_sub_u32 s75, s75, s74
    s_mul_i32 s76, s60, 60
    s_add_u32 s74, s74, s76
    v_min_u32 v54, 23, v1
    v_lshrrev_b32 v55, 1, v54
    v_mul_u32_u24 v55, 5, v55
    v_and_b32 v54, s75, v54
    v_add3_u32 v54, v54, v55, s74
    v_lshlrev_b32 v178, 9, v54
    s_lshl_b32 s74, s61, 9
    v_lshl_add_u32 v177, v1, 2, s74
    s_min_u32 s74, s61, 239
    s_mul_i32 s22, s74, 205
    s_lshr_b32 s22, s22, 10
    s_mul_i32 s23, s22, 5
    s_sub_u32 s23, s74, s23
    v_lshrrev_b32 v54, 5, v1
    v_bfe_u32 v55, v1, 2, 2
    v_bfe_u32 v56, v1, 4, 1
    v_and_b32 v57, 3, v1
    v_lshlrev_b32 v54, 4, v54
    v_lshl_add_u32 v54, v56, 2, v54
    v_add_u32 v54, v54, v55
    v_lshlrev_b32 v54, 8, v54
    s_lshl_b32 s74, s60, 6
    s_add_u32 s74, s74, 16384
    v_add_u32 v54, s74, v54
    s_lshl_b32 s78, s23, 2
    s_add_u32 s78, s78, s60
    s_mul_i32 s79, s78, 205
    s_lshr_b32 s79, s79, 10
    s_mul_i32 s74, s79, 5
    s_sub_u32 s74, s78, s74
    s_cmp_eq_u32 s74, 2
    s_cselect_b32 s75, 8, 16
    s_cselect_b32 s76, 32, 8
    s_cselect_b32 s77, 240, 1
    v_mad_u32_u24 v128, v57, s75, v54
    v_add_u32 v129, s76, v128
    s_lshl_b32 s78, s79, 1
    s_cmp_ge_u32 s74, 3
    s_addc_u32 s78, s78, 0
    s_cmp_ge_u32 s74, 3
    s_cselect_b32 s79, 3, 0
    s_sub_u32 s74, s74, s79
    s_lshl_b32 s74, s74, 1
    s_mul_i32 s78, s78, 48
    s_add_u32 s78, s78, s22
    s_mul_i32 s78, s78, 5
    s_add_u32 s78, s78, s74
    s_add_u32 s78, s78, 6144
    s_add_u32 s79, s78, s77
    s_lshl_b32 s78, s78, 10
    s_lshl_b32 s79, s79, 10
    v_add_u32 v130, s78, v176
    v_add_u32 v131, s79, v176
    s_lshl_b32 s74, s73, 11
    v_add_u32 v183, s74, v176
    v_xor_b32 v182, 2048, v183
    v_add_u32 v142, 4096, v176
    s_lshl_b32 s83, s70, 2
    s_add_u32 s83, s83, s60
    s_mul_i32 s83, s83, 61440
    s_add_u32 s83, s83, 6291456
    s_lshl_b32 s74, s61, 4
    v_lshl_add_u32 v172, v1, 2, s74
    v_lshlrev_b32 v173, 4, v0
    s_lshr_b32 s10, s60, 1
    s_and_b32 s11, s60, 1
    v_lshrrev_b32 v144, 5, v1
    v_bfe_u32 v145, v1, 2, 2
    v_bfe_u32 v146, v1, 4, 1
    v_and_b32 v147, 3, v1
    v_lshlrev_b32 v138, 10, v146
    v_and_b32 v132, 15, v1
    v_lshl_add_u32 v138, v132, 4, v138
    v_lshl_add_u32 v138, v144, 8, v138
    s_lshl_b32 s12, s67, 1
    s_add_u32 s12, s12, s10
    s_mul_i32 s86, s12, 48
    s_mul_i32 s13, s68, 3
    s_add_u32 s86, s86, s13
    s_lshl_b32 s86, s86, 11
    s_lshl_b32 s13, s11, 9
    s_add_u32 s86, s86, s13
    s_add_u32 s86, s86, 11534336
    s_add_u32 s87, s86, 4096
    v_lshl_add_u32 v132, v144, 3, v145
    v_lshlrev_b32 v132, 6, v132
    v_lshl_add_u32 v132, v146, 5, v132
    v_lshl_add_u32 v132, v147, 3, v132
    s_mul_i32 s8, s60, 12288
    s_add_u32 s8, s8, 25024
    v_add_u32 v132, s8, v132
    s_lshl_b32 s12, s67, 4
    s_add_u32 s12, s12, s68
    s_lshl_b32 s12, s12, 7
    v_lshl_add_u32 v135, v1, 2, s12
    s_lshr_b32 s12, s69, 1
    s_lshl_b32 s12, s12, 11
    v_and_b32 v136, 15, v1
    v_lshl_add_u32 v136, v136, 7, s12
    s_mul_i32 s12, s60, 6144
    v_add_u32 v133, s12, v176
    s_xor_b32 s12, s60, 1
    s_mul_i32 s12, s12, 6144
    v_add_u32 v134, s12, v176
    s_lshl_b32 s12, s11, 6
    s_add_u32 s12, s12, 74176
    v_lshl_add_u32 v137, v144, 4, s12
    v_min_u32 v144, 19, v1
    v_lshrrev_b32 v145, 1, v144
    v_mul_u32_u24 v145, 22, v145
    v_add_u32 v144, v144, v145
    s_mul_i32 s13, s68, 3
    s_lshr_b32 s13, s13, 1
    s_lshl_b32 s13, s13, 9
    s_add_u32 s13, s13, 131200
    v_lshl_add_u32 v140, v144, 9, s13
    v_add_u32 v139, 1024, v176
    v_min_u32 v143, 95, v0
    v_lshlrev_b32 v143, 2, v143
    s_lshl_b32 s12, s67, 1
    s_add_u32 s12, s12, s10
    s_mul_i32 s15, s12, 40960
    s_mul_i32 s13, s11, 20480
    s_add_u32 s15, s15, s13
    s_add_u32 s15, s15, 8388608
    s_lshr_b32 s33, s68, 2
    s_add_u32 s13, s33, 0
    s_and_b32 s13, s13, 3
    s_mul_i32 s13, s13, 5120
    s_add_u32 s16, s15, s13
    s_add_u32 s13, s33, 1
    s_and_b32 s13, s13, 3
    s_mul_i32 s13, s13, 5120
    s_add_u32 s17, s15, s13
    s_add_u32 s13, s33, 2
    s_and_b32 s13, s13, 3
    s_mul_i32 s13, s13, 5120
    s_add_u32 s18, s15, s13
    s_add_u32 s13, s33, 3
    s_and_b32 s13, s13, 3
    s_mul_i32 s13, s13, 5120
    s_add_u32 s19, s15, s13
    s_lshl_b32 s39, s12, 11
    s_add_u32 s39, s39, 262144
    s_lshl_b32 s13, s33, 9
    s_add_u32 s9, s39, s13
    s_lshl_b32 s13, s11, 8
    s_add_u32 s9, s9, s13
    s_and_b32 s33, s68, 3
    s_lshl_b32 s13, s33, 28
    s_add_u32 s9, s9, s13
    s_mul_i32 s14, s68, 384
    s_add_u32 s14, s14, 65536
    s_mul_i32 s13, s68, 192
    v_lshrrev_b32 v141, 1, v143
    v_add_u32 v141, s13, v141
    v_lshlrev_b32 v180, 2, v1
    s_lshl_b32 s3, s60, 10
    s_add_u32 s3, s3, 1048576
    s_lshl_b32 s4, s64, 12
    s_add_u32 s4, s4, s3
    s_add_u32 s5, s4, 4096
    s_lshl_b32 s6, s65, 12
    s_add_u32 s6, s6, s3
    s_lshl_b32 s7, s60, 12
    s_add_u32 s7, s7, 16384
    s_waitcnt vmcnt(0)
    v_lshlrev_b32 v70, 16, v70
    v_lshlrev_b32 v71, 16, v71
    v_mul_f32 v96, 0x3fb8aa3b, v70
    v_exp_f32 v96, v96
    v_and_b32 v52, 0xffff0000, v4
    v_lshlrev_b32 v58, 16, v5
    v_perm_b32 v64, v5, v4, v16
    v_and_b32 v53, 0xffff0000, v6
    v_lshlrev_b32 v59, 16, v7
    v_perm_b32 v65, v7, v6, v16
    v_and_b32 v54, 0xffff0000, v8
    v_lshlrev_b32 v60, 16, v9
    v_perm_b32 v66, v9, v8, v16
    v_and_b32 v55, 0xffff0000, v10
    v_lshlrev_b32 v61, 16, v11
    v_perm_b32 v67, v11, v10, v16
    v_and_b32 v56, 0xffff0000, v12
    v_lshlrev_b32 v62, 16, v13
    v_perm_b32 v68, v13, v12, v16
    v_and_b32 v57, 0xffff0000, v14
    v_lshlrev_b32 v63, 16, v15
    v_perm_b32 v69, v15, v14, v16
    v_cvt_pk_bf16_f32 v96, v96, v96
    v_and_b32 v96, 0xffff0000, v96
    v_mul_f32 v98, 0x3fb8aa3b, v96
    v_mul_f32 v99, 0x3e22f983, v96
    s_mov_b32 s72, 0x41800000
    s_mov_b32 s74, 0x43800000
    v_pk_mul_f32 v[52:53], v[52:53], v[98:99]
    v_pk_mul_f32 v[72:73], v[54:55], v[56:57] op_sel:[0,0] op_sel_hi:[0,1]
    v_pk_fma_f32 v[72:73], v[54:55], v[56:57], v[72:73] op_sel:[1,1,0] op_sel_hi:[1,0,1] neg_lo:[1,0,0]
    v_pk_mul_f32 v[72:73], v[72:73], v[96:97] op_sel_hi:[1,0]
    v_pk_mul_f32 v[118:119], v[52:53], s[72:73] op_sel_hi:[1,0]
    v_pk_mul_f32 v[122:123], v[52:53], s[74:75] op_sel_hi:[1,0]
    v_fract_f32 v115, v53
    v_exp_f32 v116, v52
    v_cos_f32 v74, v115
    v_sin_f32 v75, v115
    v_fract_f32 v119, v119
    v_exp_f32 v120, v118
    v_cos_f32 v76, v119
    v_sin_f32 v77, v119
    v_fract_f32 v123, v123
    v_exp_f32 v124, v122
    v_cos_f32 v78, v123
    v_sin_f32 v79, v123
    v_pk_mul_f32 v[74:75], v[74:75], v[116:117] op_sel_hi:[1,0]
    v_pk_mul_f32 v[76:77], v[76:77], v[120:121] op_sel_hi:[1,0]
    v_pk_mul_f32 v[78:79], v[78:79], v[124:125] op_sel_hi:[1,0]
    v_pk_mul_f32 v[58:59], v[58:59], v[98:99]
    v_pk_mul_f32 v[80:81], v[60:61], v[62:63] op_sel:[0,0] op_sel_hi:[0,1]
    v_pk_fma_f32 v[80:81], v[60:61], v[62:63], v[80:81] op_sel:[1,1,0] op_sel_hi:[1,0,1] neg_lo:[1,0,0]
    v_pk_mul_f32 v[80:81], v[80:81], v[96:97] op_sel_hi:[1,0]
    v_pk_mul_f32 v[118:119], v[58:59], s[72:73] op_sel_hi:[1,0]
    v_pk_mul_f32 v[122:123], v[58:59], s[74:75] op_sel_hi:[1,0]
    v_fract_f32 v115, v59
    v_exp_f32 v116, v58
    v_cos_f32 v82, v115
    v_sin_f32 v83, v115
    v_fract_f32 v119, v119
    v_exp_f32 v120, v118
    v_cos_f32 v84, v119
    v_sin_f32 v85, v119
    v_fract_f32 v123, v123
    v_exp_f32 v124, v122
    v_cos_f32 v86, v123
    v_sin_f32 v87, v123
    v_pk_mul_f32 v[82:83], v[82:83], v[116:117] op_sel_hi:[1,0]
    v_pk_mul_f32 v[84:85], v[84:85], v[120:121] op_sel_hi:[1,0]
    v_pk_mul_f32 v[86:87], v[86:87], v[124:125] op_sel_hi:[1,0]
    v_pk_mul_f32 v[64:65], v[64:65], v[98:99]
    v_pk_mul_f32 v[88:89], v[66:67], v[68:69] op_sel:[0,0] op_sel_hi:[0,1]
    v_pk_fma_f32 v[88:89], v[66:67], v[68:69], v[88:89] op_sel:[1,1,0] op_sel_hi:[1,0,1] neg_lo:[1,0,0]
    v_pk_mul_f32 v[88:89], v[88:89], v[96:97] op_sel_hi:[1,0]
    v_pk_mul_f32 v[118:119], v[64:65], s[72:73] op_sel_hi:[1,0]
    v_pk_mul_f32 v[122:123], v[64:65], s[74:75] op_sel_hi:[1,0]
    v_fract_f32 v115, v65
    v_exp_f32 v116, v64
    v_cos_f32 v90, v115
    v_sin_f32 v91, v115
    v_fract_f32 v119, v119
    v_exp_f32 v120, v118
    v_cos_f32 v92, v119
    v_sin_f32 v93, v119
    v_fract_f32 v123, v123
    v_exp_f32 v124, v122
    v_cos_f32 v94, v123
    v_sin_f32 v95, v123
    v_pk_mul_f32 v[90:91], v[90:91], v[116:117] op_sel_hi:[1,0]
    v_pk_mul_f32 v[92:93], v[92:93], v[120:121] op_sel_hi:[1,0]
    v_pk_mul_f32 v[94:95], v[94:95], v[124:125] op_sel_hi:[1,0]
    v_pk_mul_f32 v[98:99], v[72:73], v[76:77] op_sel:[0,0] op_sel_hi:[0,1]
    v_pk_fma_f32 v[98:99], v[72:73], v[76:77], v[98:99] op_sel:[1,1,0] op_sel_hi:[1,0,1] neg_lo:[1,0,0]
    v_pk_mul_f32 v[100:101], v[98:99], v[76:77] op_sel:[0,0] op_sel_hi:[0,1]
    v_pk_fma_f32 v[100:101], v[98:99], v[76:77], v[100:101] op_sel:[1,1,0] op_sel_hi:[1,0,1] neg_lo:[1,0,0]
    v_pk_mul_f32 v[102:103], v[100:101], v[76:77] op_sel:[0,0] op_sel_hi:[0,1]
    v_pk_fma_f32 v[102:103], v[100:101], v[76:77], v[102:103] op_sel:[1,1,0] op_sel_hi:[1,0,1] neg_lo:[1,0,0]
    v_pk_mul_f32 v[104:105], v[102:103], v[76:77] op_sel:[0,0] op_sel_hi:[0,1]
    v_pk_fma_f32 v[104:105], v[102:103], v[76:77], v[104:105] op_sel:[1,1,0] op_sel_hi:[1,0,1] neg_lo:[1,0,0]
    v_pk_mul_f32 v[106:107], v[104:105], v[76:77] op_sel:[0,0] op_sel_hi:[0,1]
    v_pk_fma_f32 v[106:107], v[104:105], v[76:77], v[106:107] op_sel:[1,1,0] op_sel_hi:[1,0,1] neg_lo:[1,0,0]
    v_pk_mul_f32 v[108:109], v[106:107], v[76:77] op_sel:[0,0] op_sel_hi:[0,1]
    v_pk_fma_f32 v[108:109], v[106:107], v[76:77], v[108:109] op_sel:[1,1,0] op_sel_hi:[1,0,1] neg_lo:[1,0,0]
    v_pk_mul_f32 v[110:111], v[108:109], v[76:77] op_sel:[0,0] op_sel_hi:[0,1]
    v_pk_fma_f32 v[110:111], v[108:109], v[76:77], v[110:111] op_sel:[1,1,0] op_sel_hi:[1,0,1] neg_lo:[1,0,0]
    v_cvt_pk_bf16_f32 v44, v72, -v73
    v_cvt_pk_bf16_f32 v45, v98, -v99
    v_cvt_pk_bf16_f32 v46, v100, -v101
    v_cvt_pk_bf16_f32 v47, v102, -v103
    v_cvt_pk_bf16_f32 v48, v104, -v105
    v_cvt_pk_bf16_f32 v49, v106, -v107
    v_cvt_pk_bf16_f32 v50, v108, -v109
    v_cvt_pk_bf16_f32 v51, v110, -v111
    ds_write_addtid_b32 v44 offset:0
    ds_write_addtid_b32 v45 offset:272
    ds_write_addtid_b32 v46 offset:544
    ds_write_addtid_b32 v47 offset:816
    ds_write_addtid_b32 v48 offset:1088
    ds_write_addtid_b32 v49 offset:1360
    ds_write_addtid_b32 v50 offset:1632
    ds_write_addtid_b32 v51 offset:1904
    v_pk_mul_f32 v[96:97], v[110:111], v[76:77] op_sel:[0,0] op_sel_hi:[0,1]
    v_pk_fma_f32 v[96:97], v[110:111], v[76:77], v[96:97] op_sel:[1,1,0] op_sel_hi:[1,0,1] neg_lo:[1,0,0]
    v_pk_mul_f32 v[98:99], v[96:97], v[76:77] op_sel:[0,0] op_sel_hi:[0,1]
    v_pk_fma_f32 v[98:99], v[96:97], v[76:77], v[98:99] op_sel:[1,1,0] op_sel_hi:[1,0,1] neg_lo:[1,0,0]
    v_pk_mul_f32 v[100:101], v[98:99], v[76:77] op_sel:[0,0] op_sel_hi:[0,1]
    v_pk_fma_f32 v[100:101], v[98:99], v[76:77], v[100:101] op_sel:[1,1,0] op_sel_hi:[1,0,1] neg_lo:[1,0,0]
    v_pk_mul_f32 v[102:103], v[100:101], v[76:77] op_sel:[0,0] op_sel_hi:[0,1]
    v_pk_fma_f32 v[102:103], v[100:101], v[76:77], v[102:103] op_sel:[1,1,0] op_sel_hi:[1,0,1] neg_lo:[1,0,0]
    v_pk_mul_f32 v[104:105], v[102:103], v[76:77] op_sel:[0,0] op_sel_hi:[0,1]
    v_pk_fma_f32 v[104:105], v[102:103], v[76:77], v[104:105] op_sel:[1,1,0] op_sel_hi:[1,0,1] neg_lo:[1,0,0]
    v_pk_mul_f32 v[106:107], v[104:105], v[76:77] op_sel:[0,0] op_sel_hi:[0,1]
    v_pk_fma_f32 v[106:107], v[104:105], v[76:77], v[106:107] op_sel:[1,1,0] op_sel_hi:[1,0,1] neg_lo:[1,0,0]
    v_pk_mul_f32 v[108:109], v[106:107], v[76:77] op_sel:[0,0] op_sel_hi:[0,1]
    v_pk_fma_f32 v[108:109], v[106:107], v[76:77], v[108:109] op_sel:[1,1,0] op_sel_hi:[1,0,1] neg_lo:[1,0,0]
    v_pk_mul_f32 v[110:111], v[108:109], v[76:77] op_sel:[0,0] op_sel_hi:[0,1]
    v_pk_fma_f32 v[110:111], v[108:109], v[76:77], v[110:111] op_sel:[1,1,0] op_sel_hi:[1,0,1] neg_lo:[1,0,0]
    v_cvt_pk_bf16_f32 v44, v96, -v97
    v_cvt_pk_bf16_f32 v45, v98, -v99
    v_cvt_pk_bf16_f32 v46, v100, -v101
    v_cvt_pk_bf16_f32 v47, v102, -v103
    v_cvt_pk_bf16_f32 v48, v104, -v105
    v_cvt_pk_bf16_f32 v49, v106, -v107
    v_cvt_pk_bf16_f32 v50, v108, -v109
    v_cvt_pk_bf16_f32 v51, v110, -v111
    ds_write_addtid_b32 v44 offset:2176
    ds_write_addtid_b32 v45 offset:2448
    ds_write_addtid_b32 v46 offset:2720
    ds_write_addtid_b32 v47 offset:2992
    ds_write_addtid_b32 v48 offset:3264
    ds_write_addtid_b32 v49 offset:3536
    ds_write_addtid_b32 v50 offset:3808
    ds_write_addtid_b32 v51 offset:4080
    ds_read_b128 a[0:3], v126 offset:0
    ds_read_b128 a[4:7], v126 offset:64
    ds_read_b128 a[8:11], v126 offset:128
    ds_read_b128 a[12:15], v126 offset:192
    v_pk_mul_f32 v[2:3], v[74:75], v[74:75] op_sel:[0,0] op_sel_hi:[0,1]
    v_pk_fma_f32 v[2:3], v[74:75], v[74:75], v[2:3] op_sel:[1,1,0] op_sel_hi:[1,0,1] neg_lo:[1,0,0]
    v_pk_mul_f32 v[4:5], v[2:3], v[74:75] op_sel:[0,0] op_sel_hi:[0,1]
    v_pk_fma_f32 v[4:5], v[2:3], v[74:75], v[4:5] op_sel:[1,1,0] op_sel_hi:[1,0,1] neg_lo:[1,0,0]
    v_pk_mul_f32 v[6:7], v[2:3], v[2:3] op_sel:[0,0] op_sel_hi:[0,1]
    v_pk_fma_f32 v[6:7], v[2:3], v[2:3], v[6:7] op_sel:[1,1,0] op_sel_hi:[1,0,1] neg_lo:[1,0,0]
    v_pk_mul_f32 v[8:9], v[6:7], v[74:75] op_sel:[0,0] op_sel_hi:[0,1]
    v_pk_fma_f32 v[8:9], v[6:7], v[74:75], v[8:9] op_sel:[1,1,0] op_sel_hi:[1,0,1] neg_lo:[1,0,0]
    v_pk_mul_f32 v[10:11], v[6:7], v[2:3] op_sel:[0,0] op_sel_hi:[0,1]
    v_pk_fma_f32 v[10:11], v[6:7], v[2:3], v[10:11] op_sel:[1,1,0] op_sel_hi:[1,0,1] neg_lo:[1,0,0]
    v_pk_mul_f32 v[12:13], v[6:7], v[4:5] op_sel:[0,0] op_sel_hi:[0,1]
    v_pk_fma_f32 v[12:13], v[6:7], v[4:5], v[12:13] op_sel:[1,1,0] op_sel_hi:[1,0,1] neg_lo:[1,0,0]
    v_pk_mul_f32 v[14:15], v[6:7], v[6:7] op_sel:[0,0] op_sel_hi:[0,1]
    v_pk_fma_f32 v[14:15], v[6:7], v[6:7], v[14:15] op_sel:[1,1,0] op_sel_hi:[1,0,1] neg_lo:[1,0,0]
    v_cvt_pk_bf16_f32 v44, v74, v75
    v_cvt_pk_bf16_f32 v45, v2, v3
    v_cvt_pk_bf16_f32 v46, v4, v5
    v_cvt_pk_bf16_f32 v47, v6, v7
    v_cvt_pk_bf16_f32 v48, v8, v9
    v_cvt_pk_bf16_f32 v49, v10, v11
    v_cvt_pk_bf16_f32 v50, v12, v13
    v_cvt_pk_bf16_f32 v51, v14, v15
    ds_write_addtid_b32 v44 offset:0
    ds_write_addtid_b32 v45 offset:272
    ds_write_addtid_b32 v46 offset:544
    ds_write_addtid_b32 v47 offset:816
    ds_write_addtid_b32 v48 offset:1088
    ds_write_addtid_b32 v49 offset:1360
    ds_write_addtid_b32 v50 offset:1632
    ds_write_addtid_b32 v51 offset:1904
    v_pk_mul_f32 v[16:17], v[14:15], v[74:75] op_sel:[0,0] op_sel_hi:[0,1]
    v_pk_fma_f32 v[16:17], v[14:15], v[74:75], v[16:17] op_sel:[1,1,0] op_sel_hi:[1,0,1] neg_lo:[1,0,0]
    v_pk_mul_f32 v[18:19], v[14:15], v[2:3] op_sel:[0,0] op_sel_hi:[0,1]
    v_pk_fma_f32 v[18:19], v[14:15], v[2:3], v[18:19] op_sel:[1,1,0] op_sel_hi:[1,0,1] neg_lo:[1,0,0]
    v_pk_mul_f32 v[20:21], v[14:15], v[4:5] op_sel:[0,0] op_sel_hi:[0,1]
    v_pk_fma_f32 v[20:21], v[14:15], v[4:5], v[20:21] op_sel:[1,1,0] op_sel_hi:[1,0,1] neg_lo:[1,0,0]
    v_pk_mul_f32 v[22:23], v[14:15], v[6:7] op_sel:[0,0] op_sel_hi:[0,1]
    v_pk_fma_f32 v[22:23], v[14:15], v[6:7], v[22:23] op_sel:[1,1,0] op_sel_hi:[1,0,1] neg_lo:[1,0,0]
    v_pk_mul_f32 v[24:25], v[14:15], v[8:9] op_sel:[0,0] op_sel_hi:[0,1]
    v_pk_fma_f32 v[24:25], v[14:15], v[8:9], v[24:25] op_sel:[1,1,0] op_sel_hi:[1,0,1] neg_lo:[1,0,0]
    v_pk_mul_f32 v[26:27], v[14:15], v[10:11] op_sel:[0,0] op_sel_hi:[0,1]
    v_pk_fma_f32 v[26:27], v[14:15], v[10:11], v[26:27] op_sel:[1,1,0] op_sel_hi:[1,0,1] neg_lo:[1,0,0]
    v_pk_mul_f32 v[28:29], v[14:15], v[12:13] op_sel:[0,0] op_sel_hi:[0,1]
    v_pk_fma_f32 v[28:29], v[14:15], v[12:13], v[28:29] op_sel:[1,1,0] op_sel_hi:[1,0,1] neg_lo:[1,0,0]
    v_cvt_pk_bf16_f32 v44, v16, v17
    v_cvt_pk_bf16_f32 v45, v18, v19
    v_cvt_pk_bf16_f32 v46, v20, v21
    v_cvt_pk_bf16_f32 v47, v22, v23
    v_cvt_pk_bf16_f32 v48, v24, v25
    v_cvt_pk_bf16_f32 v49, v26, v27
    v_cvt_pk_bf16_f32 v50, v28, v29
    v_cvt_pk_bf16_f32 v51, v76, v77
    ds_write_addtid_b32 v44 offset:2176
    ds_write_addtid_b32 v45 offset:2448
    ds_write_addtid_b32 v46 offset:2720
    ds_write_addtid_b32 v47 offset:2992
    ds_write_addtid_b32 v48 offset:3264
    ds_write_addtid_b32 v49 offset:3536
    ds_write_addtid_b32 v50 offset:3808
    ds_write_addtid_b32 v51 offset:4080
    ds_read_b128 a[16:19], v126 offset:0
    ds_read_b128 a[20:23], v126 offset:64
    ds_read_b128 a[24:27], v126 offset:128
    ds_read_b128 a[28:31], v126 offset:192
    v_pk_mul_f32 v[96:97], v[78:79], v[2:3] op_sel:[0,0] op_sel_hi:[0,1]
    v_pk_fma_f32 v[96:97], v[78:79], v[2:3], v[96:97] op_sel:[1,1,0] op_sel_hi:[1,0,1] neg_lo:[1,0,0]
    v_pk_mul_f32 v[98:99], v[78:79], v[6:7] op_sel:[0,0] op_sel_hi:[0,1]
    v_pk_fma_f32 v[98:99], v[78:79], v[6:7], v[98:99] op_sel:[1,1,0] op_sel_hi:[1,0,1] neg_lo:[1,0,0]
    v_pk_mul_f32 v[100:101], v[78:79], v[10:11] op_sel:[0,0] op_sel_hi:[0,1]
    v_pk_fma_f32 v[100:101], v[78:79], v[10:11], v[100:101] op_sel:[1,1,0] op_sel_hi:[1,0,1] neg_lo:[1,0,0]
    v_pk_mul_f32 v[102:103], v[78:79], v[14:15] op_sel:[0,0] op_sel_hi:[0,1]
    v_pk_fma_f32 v[102:103], v[78:79], v[14:15], v[102:103] op_sel:[1,1,0] op_sel_hi:[1,0,1] neg_lo:[1,0,0]
    v_pk_mul_f32 v[104:105], v[78:79], v[18:19] op_sel:[0,0] op_sel_hi:[0,1]
    v_pk_fma_f32 v[104:105], v[78:79], v[18:19], v[104:105] op_sel:[1,1,0] op_sel_hi:[1,0,1] neg_lo:[1,0,0]
    v_pk_mul_f32 v[106:107], v[78:79], v[22:23] op_sel:[0,0] op_sel_hi:[0,1]
    v_pk_fma_f32 v[106:107], v[78:79], v[22:23], v[106:107] op_sel:[1,1,0] op_sel_hi:[1,0,1] neg_lo:[1,0,0]
    v_pk_mul_f32 v[108:109], v[78:79], v[26:27] op_sel:[0,0] op_sel_hi:[0,1]
    v_pk_fma_f32 v[108:109], v[78:79], v[26:27], v[108:109] op_sel:[1,1,0] op_sel_hi:[1,0,1] neg_lo:[1,0,0]
    v_pk_mul_f32 v[110:111], v[78:79], v[76:77] op_sel:[0,0] op_sel_hi:[0,1]
    v_pk_fma_f32 v[110:111], v[78:79], v[76:77], v[110:111] op_sel:[1,1,0] op_sel_hi:[1,0,1] neg_lo:[1,0,0]
    v_cvt_pk_bf16_f32 v44, v96, v97
    v_cvt_pk_bf16_f32 v45, v98, v99
    v_cvt_pk_bf16_f32 v46, v100, v101
    v_cvt_pk_bf16_f32 v47, v102, v103
    v_cvt_pk_bf16_f32 v48, v104, v105
    v_cvt_pk_bf16_f32 v49, v106, v107
    v_cvt_pk_bf16_f32 v50, v108, v109
    v_cvt_pk_bf16_f32 v51, v110, v111
    ds_write_addtid_b32 v44 offset:0
    ds_write_addtid_b32 v45 offset:272
    ds_write_addtid_b32 v46 offset:544
    ds_write_addtid_b32 v47 offset:816
    ds_write_addtid_b32 v48 offset:1088
    ds_write_addtid_b32 v49 offset:1360
    ds_write_addtid_b32 v50 offset:1632
    ds_write_addtid_b32 v51 offset:1904
    v_pk_mul_f32 v[32:33], v[78:79], v[78:79] op_sel:[0,0] op_sel_hi:[0,1]
    v_pk_fma_f32 v[32:33], v[78:79], v[78:79], v[32:33] op_sel:[1,1,0] op_sel_hi:[1,0,1] neg_lo:[1,0,0]
    v_pk_mul_f32 v[34:35], v[32:33], v[78:79] op_sel:[0,0] op_sel_hi:[0,1]
    v_pk_fma_f32 v[34:35], v[32:33], v[78:79], v[34:35] op_sel:[1,1,0] op_sel_hi:[1,0,1] neg_lo:[1,0,0]
    v_pk_mul_f32 v[96:97], v[32:33], v[6:7] op_sel:[0,0] op_sel_hi:[0,1]
    v_pk_fma_f32 v[96:97], v[32:33], v[6:7], v[96:97] op_sel:[1,1,0] op_sel_hi:[1,0,1] neg_lo:[1,0,0]
    v_pk_mul_f32 v[98:99], v[32:33], v[14:15] op_sel:[0,0] op_sel_hi:[0,1]
    v_pk_fma_f32 v[98:99], v[32:33], v[14:15], v[98:99] op_sel:[1,1,0] op_sel_hi:[1,0,1] neg_lo:[1,0,0]
    v_pk_mul_f32 v[100:101], v[32:33], v[22:23] op_sel:[0,0] op_sel_hi:[0,1]
    v_pk_fma_f32 v[100:101], v[32:33], v[22:23], v[100:101] op_sel:[1,1,0] op_sel_hi:[1,0,1] neg_lo:[1,0,0]
    v_pk_mul_f32 v[102:103], v[32:33], v[76:77] op_sel:[0,0] op_sel_hi:[0,1]
    v_pk_fma_f32 v[102:103], v[32:33], v[76:77], v[102:103] op_sel:[1,1,0] op_sel_hi:[1,0,1] neg_lo:[1,0,0]
    v_pk_mul_f32 v[104:105], v[34:35], v[6:7] op_sel:[0,0] op_sel_hi:[0,1]
    v_pk_fma_f32 v[104:105], v[34:35], v[6:7], v[104:105] op_sel:[1,1,0] op_sel_hi:[1,0,1] neg_lo:[1,0,0]
    v_pk_mul_f32 v[106:107], v[34:35], v[14:15] op_sel:[0,0] op_sel_hi:[0,1]
    v_pk_fma_f32 v[106:107], v[34:35], v[14:15], v[106:107] op_sel:[1,1,0] op_sel_hi:[1,0,1] neg_lo:[1,0,0]
    v_pk_mul_f32 v[108:109], v[34:35], v[22:23] op_sel:[0,0] op_sel_hi:[0,1]
    v_pk_fma_f32 v[108:109], v[34:35], v[22:23], v[108:109] op_sel:[1,1,0] op_sel_hi:[1,0,1] neg_lo:[1,0,0]
    v_pk_mul_f32 v[110:111], v[34:35], v[76:77] op_sel:[0,0] op_sel_hi:[0,1]
    v_pk_fma_f32 v[110:111], v[34:35], v[76:77], v[110:111] op_sel:[1,1,0] op_sel_hi:[1,0,1] neg_lo:[1,0,0]
    s_waitcnt lgkmcnt(8)
    s_nop 0
    v_mfma_f32_16x16x32_bf16 v[112:115], a[16:19], a[0:3], 0
    v_cvt_pk_bf16_f32 v44, v96, v97
    v_cvt_pk_bf16_f32 v45, v98, v99
    v_mfma_f32_16x16x32_bf16 v[112:115], a[20:23], a[4:7], v[112:115]
    v_cvt_pk_bf16_f32 v46, v100, v101
    v_cvt_pk_bf16_f32 v47, v102, v103
    v_mfma_f32_16x16x32_bf16 v[112:115], a[24:27], a[8:11], v[112:115]
    v_cvt_pk_bf16_f32 v48, v104, v105
    v_cvt_pk_bf16_f32 v49, v106, v107
    v_mfma_f32_16x16x32_bf16 v[112:115], a[28:31], a[12:15], v[112:115]
    v_cvt_pk_bf16_f32 v50, v108, v109
    v_cvt_pk_bf16_f32 v51, v110, v111
    ds_write_addtid_b32 v44 offset:2176
    ds_write_addtid_b32 v45 offset:2448
    ds_write_addtid_b32 v46 offset:2720
    ds_write_addtid_b32 v47 offset:2992
    ds_write_addtid_b32 v48 offset:3264
    ds_write_addtid_b32 v49 offset:3536
    ds_write_addtid_b32 v50 offset:3808
    ds_write_addtid_b32 v51 offset:4080
    ds_read_b128 a[16:19], v126 offset:0
    ds_read_b128 a[20:23], v126 offset:64
    ds_read_b128 a[24:27], v126 offset:128
    ds_read_b128 a[28:31], v126 offset:192
    v_pk_mul_f32 v[36:37], v[32:33], v[32:33] op_sel:[0,0] op_sel_hi:[0,1]
    v_pk_fma_f32 v[36:37], v[32:33], v[32:33], v[36:37] op_sel:[1,1,0] op_sel_hi:[1,0,1] neg_lo:[1,0,0]
    v_pk_mul_f32 v[40:41], v[34:35], v[34:35] op_sel:[0,0] op_sel_hi:[0,1]
    v_pk_fma_f32 v[40:41], v[34:35], v[34:35], v[40:41] op_sel:[1,1,0] op_sel_hi:[1,0,1] neg_lo:[1,0,0]
    v_pk_mul_f32 v[38:39], v[36:37], v[78:79] op_sel:[0,0] op_sel_hi:[0,1]
    v_pk_fma_f32 v[38:39], v[36:37], v[78:79], v[38:39] op_sel:[1,1,0] op_sel_hi:[1,0,1] neg_lo:[1,0,0]
    v_pk_mul_f32 v[42:43], v[36:37], v[34:35] op_sel:[0,0] op_sel_hi:[0,1]
    v_pk_fma_f32 v[42:43], v[36:37], v[34:35], v[42:43] op_sel:[1,1,0] op_sel_hi:[1,0,1] neg_lo:[1,0,0]
    v_pk_mul_f32 v[96:97], v[36:37], v[14:15] op_sel:[0,0] op_sel_hi:[0,1]
    v_pk_fma_f32 v[96:97], v[36:37], v[14:15], v[96:97] op_sel:[1,1,0] op_sel_hi:[1,0,1] neg_lo:[1,0,0]
    v_pk_mul_f32 v[98:99], v[36:37], v[76:77] op_sel:[0,0] op_sel_hi:[0,1]
    v_pk_fma_f32 v[98:99], v[36:37], v[76:77], v[98:99] op_sel:[1,1,0] op_sel_hi:[1,0,1] neg_lo:[1,0,0]
    v_pk_mul_f32 v[100:101], v[38:39], v[14:15] op_sel:[0,0] op_sel_hi:[0,1]
    v_pk_fma_f32 v[100:101], v[38:39], v[14:15], v[100:101] op_sel:[1,1,0] op_sel_hi:[1,0,1] neg_lo:[1,0,0]
    v_pk_mul_f32 v[102:103], v[38:39], v[76:77] op_sel:[0,0] op_sel_hi:[0,1]
    v_pk_fma_f32 v[102:103], v[38:39], v[76:77], v[102:103] op_sel:[1,1,0] op_sel_hi:[1,0,1] neg_lo:[1,0,0]
    v_pk_mul_f32 v[104:105], v[40:41], v[14:15] op_sel:[0,0] op_sel_hi:[0,1]
    v_pk_fma_f32 v[104:105], v[40:41], v[14:15], v[104:105] op_sel:[1,1,0] op_sel_hi:[1,0,1] neg_lo:[1,0,0]
    v_pk_mul_f32 v[106:107], v[40:41], v[76:77] op_sel:[0,0] op_sel_hi:[0,1]
    v_pk_fma_f32 v[106:107], v[40:41], v[76:77], v[106:107] op_sel:[1,1,0] op_sel_hi:[1,0,1] neg_lo:[1,0,0]
    v_pk_mul_f32 v[108:109], v[42:43], v[14:15] op_sel:[0,0] op_sel_hi:[0,1]
    v_pk_fma_f32 v[108:109], v[42:43], v[14:15], v[108:109] op_sel:[1,1,0] op_sel_hi:[1,0,1] neg_lo:[1,0,0]
    v_pk_mul_f32 v[110:111], v[42:43], v[76:77] op_sel:[0,0] op_sel_hi:[0,1]
    v_pk_fma_f32 v[110:111], v[42:43], v[76:77], v[110:111] op_sel:[1,1,0] op_sel_hi:[1,0,1] neg_lo:[1,0,0]
    v_cvt_pk_bf16_f32 v44, v96, v97
    v_cvt_pk_bf16_f32 v45, v98, v99
    v_cvt_pk_bf16_f32 v46, v100, v101
    v_cvt_pk_bf16_f32 v47, v102, v103
    v_cvt_pk_bf16_f32 v48, v104, v105
    v_cvt_pk_bf16_f32 v49, v106, v107
    v_cvt_pk_bf16_f32 v50, v108, v109
    v_cvt_pk_bf16_f32 v51, v110, v111
    ds_write_addtid_b32 v44 offset:0
    ds_write_addtid_b32 v45 offset:272
    ds_write_addtid_b32 v46 offset:544
    ds_write_addtid_b32 v47 offset:816
    ds_write_addtid_b32 v48 offset:1088
    ds_write_addtid_b32 v49 offset:1360
    ds_write_addtid_b32 v50 offset:1632
    ds_write_addtid_b32 v51 offset:1904
    ds_write_addtid_b32 v127 offset:2176
    ds_read_b128 a[32:35], v126 offset:0
    ds_read_b128 a[36:39], v126 offset:64
    ds_read_b128 a[40:43], v126 offset:128
    ds_read_b128 a[44:47], v126 offset:192
    v_pk_mul_f32 v[98:99], v[80:81], v[84:85] op_sel:[0,0] op_sel_hi:[0,1]
    v_pk_fma_f32 v[98:99], v[80:81], v[84:85], v[98:99] op_sel:[1,1,0] op_sel_hi:[1,0,1] neg_lo:[1,0,0]
    v_pk_mul_f32 v[100:101], v[98:99], v[84:85] op_sel:[0,0] op_sel_hi:[0,1]
    v_pk_fma_f32 v[100:101], v[98:99], v[84:85], v[100:101] op_sel:[1,1,0] op_sel_hi:[1,0,1] neg_lo:[1,0,0]
    v_pk_mul_f32 v[102:103], v[100:101], v[84:85] op_sel:[0,0] op_sel_hi:[0,1]
    v_pk_fma_f32 v[102:103], v[100:101], v[84:85], v[102:103] op_sel:[1,1,0] op_sel_hi:[1,0,1] neg_lo:[1,0,0]
    v_pk_mul_f32 v[104:105], v[102:103], v[84:85] op_sel:[0,0] op_sel_hi:[0,1]
    v_pk_fma_f32 v[104:105], v[102:103], v[84:85], v[104:105] op_sel:[1,1,0] op_sel_hi:[1,0,1] neg_lo:[1,0,0]
    v_pk_mul_f32 v[106:107], v[104:105], v[84:85] op_sel:[0,0] op_sel_hi:[0,1]
    v_pk_fma_f32 v[106:107], v[104:105], v[84:85], v[106:107] op_sel:[1,1,0] op_sel_hi:[1,0,1] neg_lo:[1,0,0]
    v_pk_mul_f32 v[108:109], v[106:107], v[84:85] op_sel:[0,0] op_sel_hi:[0,1]
    v_pk_fma_f32 v[108:109], v[106:107], v[84:85], v[108:109] op_sel:[1,1,0] op_sel_hi:[1,0,1] neg_lo:[1,0,0]
    v_pk_mul_f32 v[110:111], v[108:109], v[84:85] op_sel:[0,0] op_sel_hi:[0,1]
    v_pk_fma_f32 v[110:111], v[108:109], v[84:85], v[110:111] op_sel:[1,1,0] op_sel_hi:[1,0,1] neg_lo:[1,0,0]
    s_waitcnt lgkmcnt(13)
    s_nop 0
    v_mfma_f32_16x16x32_bf16 v[116:119], a[16:19], a[0:3], 0
    v_cvt_pk_bf16_f32 v44, v80, -v81
    v_cvt_pk_bf16_f32 v45, v98, -v99
    v_mfma_f32_16x16x32_bf16 v[116:119], a[20:23], a[4:7], v[116:119]
    v_cvt_pk_bf16_f32 v46, v100, -v101
    v_cvt_pk_bf16_f32 v47, v102, -v103
    v_mfma_f32_16x16x32_bf16 v[116:119], a[24:27], a[8:11], v[116:119]
    v_cvt_pk_bf16_f32 v48, v104, -v105
    v_cvt_pk_bf16_f32 v49, v106, -v107
    v_mfma_f32_16x16x32_bf16 v[116:119], a[28:31], a[12:15], v[116:119]
    v_cvt_pk_bf16_f32 v50, v108, -v109
    v_cvt_pk_bf16_f32 v51, v110, -v111
    ds_write_addtid_b32 v44 offset:0
    ds_write_addtid_b32 v45 offset:272
    ds_write_addtid_b32 v46 offset:544
    ds_write_addtid_b32 v47 offset:816
    ds_write_addtid_b32 v48 offset:1088
    ds_write_addtid_b32 v49 offset:1360
    ds_write_addtid_b32 v50 offset:1632
    ds_write_addtid_b32 v51 offset:1904
    v_pk_mul_f32 v[96:97], v[110:111], v[84:85] op_sel:[0,0] op_sel_hi:[0,1]
    v_pk_fma_f32 v[96:97], v[110:111], v[84:85], v[96:97] op_sel:[1,1,0] op_sel_hi:[1,0,1] neg_lo:[1,0,0]
    v_pk_mul_f32 v[98:99], v[96:97], v[84:85] op_sel:[0,0] op_sel_hi:[0,1]
    v_pk_fma_f32 v[98:99], v[96:97], v[84:85], v[98:99] op_sel:[1,1,0] op_sel_hi:[1,0,1] neg_lo:[1,0,0]
    v_pk_mul_f32 v[100:101], v[98:99], v[84:85] op_sel:[0,0] op_sel_hi:[0,1]
    v_pk_fma_f32 v[100:101], v[98:99], v[84:85], v[100:101] op_sel:[1,1,0] op_sel_hi:[1,0,1] neg_lo:[1,0,0]
    v_pk_mul_f32 v[102:103], v[100:101], v[84:85] op_sel:[0,0] op_sel_hi:[0,1]
    v_pk_fma_f32 v[102:103], v[100:101], v[84:85], v[102:103] op_sel:[1,1,0] op_sel_hi:[1,0,1] neg_lo:[1,0,0]
    v_pk_mul_f32 v[104:105], v[102:103], v[84:85] op_sel:[0,0] op_sel_hi:[0,1]
    v_pk_fma_f32 v[104:105], v[102:103], v[84:85], v[104:105] op_sel:[1,1,0] op_sel_hi:[1,0,1] neg_lo:[1,0,0]
    v_pk_mul_f32 v[106:107], v[104:105], v[84:85] op_sel:[0,0] op_sel_hi:[0,1]
    v_pk_fma_f32 v[106:107], v[104:105], v[84:85], v[106:107] op_sel:[1,1,0] op_sel_hi:[1,0,1] neg_lo:[1,0,0]
    v_pk_mul_f32 v[108:109], v[106:107], v[84:85] op_sel:[0,0] op_sel_hi:[0,1]
    v_pk_fma_f32 v[108:109], v[106:107], v[84:85], v[108:109] op_sel:[1,1,0] op_sel_hi:[1,0,1] neg_lo:[1,0,0]
    v_pk_mul_f32 v[110:111], v[108:109], v[84:85] op_sel:[0,0] op_sel_hi:[0,1]
    v_pk_fma_f32 v[110:111], v[108:109], v[84:85], v[110:111] op_sel:[1,1,0] op_sel_hi:[1,0,1] neg_lo:[1,0,0]
    s_waitcnt lgkmcnt(8)
    s_nop 0
    v_mfma_f32_16x16x32_bf16 v[120:123], a[32:35], a[0:3], 0
    v_cvt_pk_bf16_f32 v44, v96, -v97
    v_cvt_pk_bf16_f32 v45, v98, -v99
    v_mfma_f32_16x16x32_bf16 v[120:123], a[36:39], a[4:7], v[120:123]
    v_cvt_pk_bf16_f32 v46, v100, -v101
    v_cvt_pk_bf16_f32 v47, v102, -v103
    v_mfma_f32_16x16x32_bf16 v[120:123], a[40:43], a[8:11], v[120:123]
    v_cvt_pk_bf16_f32 v48, v104, -v105
    v_cvt_pk_bf16_f32 v49, v106, -v107
    v_mfma_f32_16x16x32_bf16 v[120:123], a[44:47], a[12:15], v[120:123]
    v_cvt_pk_bf16_f32 v50, v108, -v109
    v_cvt_pk_bf16_f32 v51, v110, -v111
    ds_write_addtid_b32 v44 offset:2176
    ds_write_addtid_b32 v45 offset:2448
    ds_write_addtid_b32 v46 offset:2720
    ds_write_addtid_b32 v47 offset:2992
    ds_write_addtid_b32 v48 offset:3264
    ds_write_addtid_b32 v49 offset:3536
    ds_write_addtid_b32 v50 offset:3808
    ds_write_addtid_b32 v51 offset:4080
    ds_read_b128 a[0:3], v126 offset:0
    ds_read_b128 a[4:7], v126 offset:64
    ds_read_b128 a[8:11], v126 offset:128
    ds_read_b128 a[12:15], v126 offset:192
    v_pk_mul_f32 v[2:3], v[82:83], v[82:83] op_sel:[0,0] op_sel_hi:[0,1]
    v_pk_fma_f32 v[2:3], v[82:83], v[82:83], v[2:3] op_sel:[1,1,0] op_sel_hi:[1,0,1] neg_lo:[1,0,0]
    v_pk_mul_f32 v[4:5], v[2:3], v[82:83] op_sel:[0,0] op_sel_hi:[0,1]
    v_pk_fma_f32 v[4:5], v[2:3], v[82:83], v[4:5] op_sel:[1,1,0] op_sel_hi:[1,0,1] neg_lo:[1,0,0]
    v_pk_mul_f32 v[6:7], v[2:3], v[2:3] op_sel:[0,0] op_sel_hi:[0,1]
    v_pk_fma_f32 v[6:7], v[2:3], v[2:3], v[6:7] op_sel:[1,1,0] op_sel_hi:[1,0,1] neg_lo:[1,0,0]
    v_pk_mul_f32 v[8:9], v[6:7], v[82:83] op_sel:[0,0] op_sel_hi:[0,1]
    v_pk_fma_f32 v[8:9], v[6:7], v[82:83], v[8:9] op_sel:[1,1,0] op_sel_hi:[1,0,1] neg_lo:[1,0,0]
    v_pk_mul_f32 v[10:11], v[6:7], v[2:3] op_sel:[0,0] op_sel_hi:[0,1]
    v_pk_fma_f32 v[10:11], v[6:7], v[2:3], v[10:11] op_sel:[1,1,0] op_sel_hi:[1,0,1] neg_lo:[1,0,0]
    v_pk_mul_f32 v[12:13], v[6:7], v[4:5] op_sel:[0,0] op_sel_hi:[0,1]
    v_pk_fma_f32 v[12:13], v[6:7], v[4:5], v[12:13] op_sel:[1,1,0] op_sel_hi:[1,0,1] neg_lo:[1,0,0]
    v_pk_mul_f32 v[14:15], v[6:7], v[6:7] op_sel:[0,0] op_sel_hi:[0,1]
    v_pk_fma_f32 v[14:15], v[6:7], v[6:7], v[14:15] op_sel:[1,1,0] op_sel_hi:[1,0,1] neg_lo:[1,0,0]
    v_cvt_pk_bf16_f32 v44, v82, v83
    v_cvt_pk_bf16_f32 v45, v2, v3
    v_cvt_pk_bf16_f32 v46, v4, v5
    v_cvt_pk_bf16_f32 v47, v6, v7
    v_cvt_pk_bf16_f32 v48, v8, v9
    v_cvt_pk_bf16_f32 v49, v10, v11
    v_cvt_pk_bf16_f32 v50, v12, v13
    v_cvt_pk_bf16_f32 v51, v14, v15
    ds_write_addtid_b32 v44 offset:0
    ds_write_addtid_b32 v45 offset:272
    ds_write_addtid_b32 v46 offset:544
    ds_write_addtid_b32 v47 offset:816
    ds_write_addtid_b32 v48 offset:1088
    ds_write_addtid_b32 v49 offset:1360
    ds_write_addtid_b32 v50 offset:1632
    ds_write_addtid_b32 v51 offset:1904
    v_pk_mul_f32 v[16:17], v[14:15], v[82:83] op_sel:[0,0] op_sel_hi:[0,1]
    v_pk_fma_f32 v[16:17], v[14:15], v[82:83], v[16:17] op_sel:[1,1,0] op_sel_hi:[1,0,1] neg_lo:[1,0,0]
    v_pk_mul_f32 v[18:19], v[14:15], v[2:3] op_sel:[0,0] op_sel_hi:[0,1]
    v_pk_fma_f32 v[18:19], v[14:15], v[2:3], v[18:19] op_sel:[1,1,0] op_sel_hi:[1,0,1] neg_lo:[1,0,0]
    v_pk_mul_f32 v[20:21], v[14:15], v[4:5] op_sel:[0,0] op_sel_hi:[0,1]
    v_pk_fma_f32 v[20:21], v[14:15], v[4:5], v[20:21] op_sel:[1,1,0] op_sel_hi:[1,0,1] neg_lo:[1,0,0]
    v_pk_mul_f32 v[22:23], v[14:15], v[6:7] op_sel:[0,0] op_sel_hi:[0,1]
    v_pk_fma_f32 v[22:23], v[14:15], v[6:7], v[22:23] op_sel:[1,1,0] op_sel_hi:[1,0,1] neg_lo:[1,0,0]
    v_pk_mul_f32 v[24:25], v[14:15], v[8:9] op_sel:[0,0] op_sel_hi:[0,1]
    v_pk_fma_f32 v[24:25], v[14:15], v[8:9], v[24:25] op_sel:[1,1,0] op_sel_hi:[1,0,1] neg_lo:[1,0,0]
    v_pk_mul_f32 v[26:27], v[14:15], v[10:11] op_sel:[0,0] op_sel_hi:[0,1]
    v_pk_fma_f32 v[26:27], v[14:15], v[10:11], v[26:27] op_sel:[1,1,0] op_sel_hi:[1,0,1] neg_lo:[1,0,0]
    v_pk_mul_f32 v[28:29], v[14:15], v[12:13] op_sel:[0,0] op_sel_hi:[0,1]
    v_pk_fma_f32 v[28:29], v[14:15], v[12:13], v[28:29] op_sel:[1,1,0] op_sel_hi:[1,0,1] neg_lo:[1,0,0]
    v_cvt_pk_bf16_f32 v44, v16, v17
    v_cvt_pk_bf16_f32 v45, v18, v19
    v_cvt_pk_bf16_f32 v46, v20, v21
    v_cvt_pk_bf16_f32 v47, v22, v23
    v_cvt_pk_bf16_f32 v48, v24, v25
    v_cvt_pk_bf16_f32 v49, v26, v27
    v_cvt_pk_bf16_f32 v50, v28, v29
    v_cvt_pk_bf16_f32 v51, v84, v85
    ds_write_addtid_b32 v44 offset:2176
    ds_write_addtid_b32 v45 offset:2448
    ds_write_addtid_b32 v46 offset:2720
    ds_write_addtid_b32 v47 offset:2992
    ds_write_addtid_b32 v48 offset:3264
    ds_write_addtid_b32 v49 offset:3536
    ds_write_addtid_b32 v50 offset:3808
    ds_write_addtid_b32 v51 offset:4080
    ds_read_b128 a[16:19], v126 offset:0
    ds_read_b128 a[20:23], v126 offset:64
    ds_read_b128 a[24:27], v126 offset:128
    ds_read_b128 a[28:31], v126 offset:192
    v_pk_mul_f32 v[96:97], v[86:87], v[2:3] op_sel:[0,0] op_sel_hi:[0,1]
    v_pk_fma_f32 v[96:97], v[86:87], v[2:3], v[96:97] op_sel:[1,1,0] op_sel_hi:[1,0,1] neg_lo:[1,0,0]
    v_pk_mul_f32 v[98:99], v[86:87], v[6:7] op_sel:[0,0] op_sel_hi:[0,1]
    v_pk_fma_f32 v[98:99], v[86:87], v[6:7], v[98:99] op_sel:[1,1,0] op_sel_hi:[1,0,1] neg_lo:[1,0,0]
    v_pk_mul_f32 v[100:101], v[86:87], v[10:11] op_sel:[0,0] op_sel_hi:[0,1]
    v_pk_fma_f32 v[100:101], v[86:87], v[10:11], v[100:101] op_sel:[1,1,0] op_sel_hi:[1,0,1] neg_lo:[1,0,0]
    v_pk_mul_f32 v[102:103], v[86:87], v[14:15] op_sel:[0,0] op_sel_hi:[0,1]
    v_pk_fma_f32 v[102:103], v[86:87], v[14:15], v[102:103] op_sel:[1,1,0] op_sel_hi:[1,0,1] neg_lo:[1,0,0]
    v_pk_mul_f32 v[104:105], v[86:87], v[18:19] op_sel:[0,0] op_sel_hi:[0,1]
    v_pk_fma_f32 v[104:105], v[86:87], v[18:19], v[104:105] op_sel:[1,1,0] op_sel_hi:[1,0,1] neg_lo:[1,0,0]
    v_pk_mul_f32 v[106:107], v[86:87], v[22:23] op_sel:[0,0] op_sel_hi:[0,1]
    v_pk_fma_f32 v[106:107], v[86:87], v[22:23], v[106:107] op_sel:[1,1,0] op_sel_hi:[1,0,1] neg_lo:[1,0,0]
    v_pk_mul_f32 v[108:109], v[86:87], v[26:27] op_sel:[0,0] op_sel_hi:[0,1]
    v_pk_fma_f32 v[108:109], v[86:87], v[26:27], v[108:109] op_sel:[1,1,0] op_sel_hi:[1,0,1] neg_lo:[1,0,0]
    v_pk_mul_f32 v[110:111], v[86:87], v[84:85] op_sel:[0,0] op_sel_hi:[0,1]
    v_pk_fma_f32 v[110:111], v[86:87], v[84:85], v[110:111] op_sel:[1,1,0] op_sel_hi:[1,0,1] neg_lo:[1,0,0]
    v_cvt_pk_bf16_f32 v44, v96, v97
    v_cvt_pk_bf16_f32 v45, v98, v99
    v_cvt_pk_bf16_f32 v46, v100, v101
    v_cvt_pk_bf16_f32 v47, v102, v103
    v_cvt_pk_bf16_f32 v48, v104, v105
    v_cvt_pk_bf16_f32 v49, v106, v107
    v_cvt_pk_bf16_f32 v50, v108, v109
    v_cvt_pk_bf16_f32 v51, v110, v111
    ds_write_addtid_b32 v44 offset:0
    ds_write_addtid_b32 v45 offset:272
    ds_write_addtid_b32 v46 offset:544
    ds_write_addtid_b32 v47 offset:816
    ds_write_addtid_b32 v48 offset:1088
    ds_write_addtid_b32 v49 offset:1360
    ds_write_addtid_b32 v50 offset:1632
    ds_write_addtid_b32 v51 offset:1904
    v_pk_mul_f32 v[32:33], v[86:87], v[86:87] op_sel:[0,0] op_sel_hi:[0,1]
    v_pk_fma_f32 v[32:33], v[86:87], v[86:87], v[32:33] op_sel:[1,1,0] op_sel_hi:[1,0,1] neg_lo:[1,0,0]
    v_pk_mul_f32 v[34:35], v[32:33], v[86:87] op_sel:[0,0] op_sel_hi:[0,1]
    v_pk_fma_f32 v[34:35], v[32:33], v[86:87], v[34:35] op_sel:[1,1,0] op_sel_hi:[1,0,1] neg_lo:[1,0,0]
    v_pk_mul_f32 v[96:97], v[32:33], v[6:7] op_sel:[0,0] op_sel_hi:[0,1]
    v_pk_fma_f32 v[96:97], v[32:33], v[6:7], v[96:97] op_sel:[1,1,0] op_sel_hi:[1,0,1] neg_lo:[1,0,0]
    v_pk_mul_f32 v[98:99], v[32:33], v[14:15] op_sel:[0,0] op_sel_hi:[0,1]
    v_pk_fma_f32 v[98:99], v[32:33], v[14:15], v[98:99] op_sel:[1,1,0] op_sel_hi:[1,0,1] neg_lo:[1,0,0]
    v_pk_mul_f32 v[100:101], v[32:33], v[22:23] op_sel:[0,0] op_sel_hi:[0,1]
    v_pk_fma_f32 v[100:101], v[32:33], v[22:23], v[100:101] op_sel:[1,1,0] op_sel_hi:[1,0,1] neg_lo:[1,0,0]
    v_pk_mul_f32 v[102:103], v[32:33], v[84:85] op_sel:[0,0] op_sel_hi:[0,1]
    v_pk_fma_f32 v[102:103], v[32:33], v[84:85], v[102:103] op_sel:[1,1,0] op_sel_hi:[1,0,1] neg_lo:[1,0,0]
    v_pk_mul_f32 v[104:105], v[34:35], v[6:7] op_sel:[0,0] op_sel_hi:[0,1]
    v_pk_fma_f32 v[104:105], v[34:35], v[6:7], v[104:105] op_sel:[1,1,0] op_sel_hi:[1,0,1] neg_lo:[1,0,0]
    v_pk_mul_f32 v[106:107], v[34:35], v[14:15] op_sel:[0,0] op_sel_hi:[0,1]
    v_pk_fma_f32 v[106:107], v[34:35], v[14:15], v[106:107] op_sel:[1,1,0] op_sel_hi:[1,0,1] neg_lo:[1,0,0]
    v_pk_mul_f32 v[108:109], v[34:35], v[22:23] op_sel:[0,0] op_sel_hi:[0,1]
    v_pk_fma_f32 v[108:109], v[34:35], v[22:23], v[108:109] op_sel:[1,1,0] op_sel_hi:[1,0,1] neg_lo:[1,0,0]
    v_pk_mul_f32 v[110:111], v[34:35], v[84:85] op_sel:[0,0] op_sel_hi:[0,1]
    v_pk_fma_f32 v[110:111], v[34:35], v[84:85], v[110:111] op_sel:[1,1,0] op_sel_hi:[1,0,1] neg_lo:[1,0,0]
    s_waitcnt lgkmcnt(8)
    s_nop 0
    v_mfma_f32_16x16x32_bf16 v[112:115], a[16:19], a[0:3], v[112:115]
    v_cvt_pk_bf16_f32 v44, v96, v97
    v_cvt_pk_bf16_f32 v45, v98, v99
    v_mfma_f32_16x16x32_bf16 v[112:115], a[20:23], a[4:7], v[112:115]
    v_cvt_pk_bf16_f32 v46, v100, v101
    v_cvt_pk_bf16_f32 v47, v102, v103
    v_mfma_f32_16x16x32_bf16 v[112:115], a[24:27], a[8:11], v[112:115]
    v_cvt_pk_bf16_f32 v48, v104, v105
    v_cvt_pk_bf16_f32 v49, v106, v107
    v_mfma_f32_16x16x32_bf16 v[112:115], a[28:31], a[12:15], v[112:115]
    v_cvt_pk_bf16_f32 v50, v108, v109
    v_cvt_pk_bf16_f32 v51, v110, v111
    ds_write_addtid_b32 v44 offset:2176
    ds_write_addtid_b32 v45 offset:2448
    ds_write_addtid_b32 v46 offset:2720
    ds_write_addtid_b32 v47 offset:2992
    ds_write_addtid_b32 v48 offset:3264
    ds_write_addtid_b32 v49 offset:3536
    ds_write_addtid_b32 v50 offset:3808
    ds_write_addtid_b32 v51 offset:4080
    ds_read_b128 a[16:19], v126 offset:0
    ds_read_b128 a[20:23], v126 offset:64
    ds_read_b128 a[24:27], v126 offset:128
    ds_read_b128 a[28:31], v126 offset:192
    v_pk_mul_f32 v[36:37], v[32:33], v[32:33] op_sel:[0,0] op_sel_hi:[0,1]
    v_pk_fma_f32 v[36:37], v[32:33], v[32:33], v[36:37] op_sel:[1,1,0] op_sel_hi:[1,0,1] neg_lo:[1,0,0]
    v_pk_mul_f32 v[40:41], v[34:35], v[34:35] op_sel:[0,0] op_sel_hi:[0,1]
    v_pk_fma_f32 v[40:41], v[34:35], v[34:35], v[40:41] op_sel:[1,1,0] op_sel_hi:[1,0,1] neg_lo:[1,0,0]
    v_pk_mul_f32 v[38:39], v[36:37], v[86:87] op_sel:[0,0] op_sel_hi:[0,1]
    v_pk_fma_f32 v[38:39], v[36:37], v[86:87], v[38:39] op_sel:[1,1,0] op_sel_hi:[1,0,1] neg_lo:[1,0,0]
    v_pk_mul_f32 v[42:43], v[36:37], v[34:35] op_sel:[0,0] op_sel_hi:[0,1]
    v_pk_fma_f32 v[42:43], v[36:37], v[34:35], v[42:43] op_sel:[1,1,0] op_sel_hi:[1,0,1] neg_lo:[1,0,0]
    v_pk_mul_f32 v[96:97], v[36:37], v[14:15] op_sel:[0,0] op_sel_hi:[0,1]
    v_pk_fma_f32 v[96:97], v[36:37], v[14:15], v[96:97] op_sel:[1,1,0] op_sel_hi:[1,0,1] neg_lo:[1,0,0]
    v_pk_mul_f32 v[98:99], v[36:37], v[84:85] op_sel:[0,0] op_sel_hi:[0,1]
    v_pk_fma_f32 v[98:99], v[36:37], v[84:85], v[98:99] op_sel:[1,1,0] op_sel_hi:[1,0,1] neg_lo:[1,0,0]
    v_pk_mul_f32 v[100:101], v[38:39], v[14:15] op_sel:[0,0] op_sel_hi:[0,1]
    v_pk_fma_f32 v[100:101], v[38:39], v[14:15], v[100:101] op_sel:[1,1,0] op_sel_hi:[1,0,1] neg_lo:[1,0,0]
    v_pk_mul_f32 v[102:103], v[38:39], v[84:85] op_sel:[0,0] op_sel_hi:[0,1]
    v_pk_fma_f32 v[102:103], v[38:39], v[84:85], v[102:103] op_sel:[1,1,0] op_sel_hi:[1,0,1] neg_lo:[1,0,0]
    v_pk_mul_f32 v[104:105], v[40:41], v[14:15] op_sel:[0,0] op_sel_hi:[0,1]
    v_pk_fma_f32 v[104:105], v[40:41], v[14:15], v[104:105] op_sel:[1,1,0] op_sel_hi:[1,0,1] neg_lo:[1,0,0]
    v_pk_mul_f32 v[106:107], v[40:41], v[84:85] op_sel:[0,0] op_sel_hi:[0,1]
    v_pk_fma_f32 v[106:107], v[40:41], v[84:85], v[106:107] op_sel:[1,1,0] op_sel_hi:[1,0,1] neg_lo:[1,0,0]
    v_pk_mul_f32 v[108:109], v[42:43], v[14:15] op_sel:[0,0] op_sel_hi:[0,1]
    v_pk_fma_f32 v[108:109], v[42:43], v[14:15], v[108:109] op_sel:[1,1,0] op_sel_hi:[1,0,1] neg_lo:[1,0,0]
    v_pk_mul_f32 v[110:111], v[42:43], v[84:85] op_sel:[0,0] op_sel_hi:[0,1]
    v_pk_fma_f32 v[110:111], v[42:43], v[84:85], v[110:111] op_sel:[1,1,0] op_sel_hi:[1,0,1] neg_lo:[1,0,0]
    v_cvt_pk_bf16_f32 v44, v96, v97
    v_cvt_pk_bf16_f32 v45, v98, v99
    v_cvt_pk_bf16_f32 v46, v100, v101
    v_cvt_pk_bf16_f32 v47, v102, v103
    v_cvt_pk_bf16_f32 v48, v104, v105
    v_cvt_pk_bf16_f32 v49, v106, v107
    v_cvt_pk_bf16_f32 v50, v108, v109
    v_cvt_pk_bf16_f32 v51, v110, v111
    ds_write_addtid_b32 v44 offset:0
    ds_write_addtid_b32 v45 offset:272
    ds_write_addtid_b32 v46 offset:544
    ds_write_addtid_b32 v47 offset:816
    ds_write_addtid_b32 v48 offset:1088
    ds_write_addtid_b32 v49 offset:1360
    ds_write_addtid_b32 v50 offset:1632
    ds_write_addtid_b32 v51 offset:1904
    ds_write_addtid_b32 v127 offset:2176
    ds_read_b128 a[32:35], v126 offset:0
    ds_read_b128 a[36:39], v126 offset:64
    ds_read_b128 a[40:43], v126 offset:128
    ds_read_b128 a[44:47], v126 offset:192
    v_pk_mul_f32 v[98:99], v[88:89], v[92:93] op_sel:[0,0] op_sel_hi:[0,1]
    v_pk_fma_f32 v[98:99], v[88:89], v[92:93], v[98:99] op_sel:[1,1,0] op_sel_hi:[1,0,1] neg_lo:[1,0,0]
    v_pk_mul_f32 v[100:101], v[98:99], v[92:93] op_sel:[0,0] op_sel_hi:[0,1]
    v_pk_fma_f32 v[100:101], v[98:99], v[92:93], v[100:101] op_sel:[1,1,0] op_sel_hi:[1,0,1] neg_lo:[1,0,0]
    v_pk_mul_f32 v[102:103], v[100:101], v[92:93] op_sel:[0,0] op_sel_hi:[0,1]
    v_pk_fma_f32 v[102:103], v[100:101], v[92:93], v[102:103] op_sel:[1,1,0] op_sel_hi:[1,0,1] neg_lo:[1,0,0]
    v_pk_mul_f32 v[104:105], v[102:103], v[92:93] op_sel:[0,0] op_sel_hi:[0,1]
    v_pk_fma_f32 v[104:105], v[102:103], v[92:93], v[104:105] op_sel:[1,1,0] op_sel_hi:[1,0,1] neg_lo:[1,0,0]
    v_pk_mul_f32 v[106:107], v[104:105], v[92:93] op_sel:[0,0] op_sel_hi:[0,1]
    v_pk_fma_f32 v[106:107], v[104:105], v[92:93], v[106:107] op_sel:[1,1,0] op_sel_hi:[1,0,1] neg_lo:[1,0,0]
    v_pk_mul_f32 v[108:109], v[106:107], v[92:93] op_sel:[0,0] op_sel_hi:[0,1]
    v_pk_fma_f32 v[108:109], v[106:107], v[92:93], v[108:109] op_sel:[1,1,0] op_sel_hi:[1,0,1] neg_lo:[1,0,0]
    v_pk_mul_f32 v[110:111], v[108:109], v[92:93] op_sel:[0,0] op_sel_hi:[0,1]
    v_pk_fma_f32 v[110:111], v[108:109], v[92:93], v[110:111] op_sel:[1,1,0] op_sel_hi:[1,0,1] neg_lo:[1,0,0]
    s_waitcnt lgkmcnt(13)
    s_nop 0
    v_mfma_f32_16x16x32_bf16 v[116:119], a[16:19], a[0:3], v[116:119]
    v_cvt_pk_bf16_f32 v44, v88, -v89
    v_cvt_pk_bf16_f32 v45, v98, -v99
    v_mfma_f32_16x16x32_bf16 v[116:119], a[20:23], a[4:7], v[116:119]
    v_cvt_pk_bf16_f32 v46, v100, -v101
    v_cvt_pk_bf16_f32 v47, v102, -v103
    v_mfma_f32_16x16x32_bf16 v[116:119], a[24:27], a[8:11], v[116:119]
    v_cvt_pk_bf16_f32 v48, v104, -v105
    v_cvt_pk_bf16_f32 v49, v106, -v107
    v_mfma_f32_16x16x32_bf16 v[116:119], a[28:31], a[12:15], v[116:119]
    v_cvt_pk_bf16_f32 v50, v108, -v109
    v_cvt_pk_bf16_f32 v51, v110, -v111
    ds_write_addtid_b32 v44 offset:0
    ds_write_addtid_b32 v45 offset:272
    ds_write_addtid_b32 v46 offset:544
    ds_write_addtid_b32 v47 offset:816
    ds_write_addtid_b32 v48 offset:1088
    ds_write_addtid_b32 v49 offset:1360
    ds_write_addtid_b32 v50 offset:1632
    ds_write_addtid_b32 v51 offset:1904
    v_pk_mul_f32 v[96:97], v[110:111], v[92:93] op_sel:[0,0] op_sel_hi:[0,1]
    v_pk_fma_f32 v[96:97], v[110:111], v[92:93], v[96:97] op_sel:[1,1,0] op_sel_hi:[1,0,1] neg_lo:[1,0,0]
    v_pk_mul_f32 v[98:99], v[96:97], v[92:93] op_sel:[0,0] op_sel_hi:[0,1]
    v_pk_fma_f32 v[98:99], v[96:97], v[92:93], v[98:99] op_sel:[1,1,0] op_sel_hi:[1,0,1] neg_lo:[1,0,0]
    v_pk_mul_f32 v[100:101], v[98:99], v[92:93] op_sel:[0,0] op_sel_hi:[0,1]
    v_pk_fma_f32 v[100:101], v[98:99], v[92:93], v[100:101] op_sel:[1,1,0] op_sel_hi:[1,0,1] neg_lo:[1,0,0]
    v_pk_mul_f32 v[102:103], v[100:101], v[92:93] op_sel:[0,0] op_sel_hi:[0,1]
    v_pk_fma_f32 v[102:103], v[100:101], v[92:93], v[102:103] op_sel:[1,1,0] op_sel_hi:[1,0,1] neg_lo:[1,0,0]
    v_pk_mul_f32 v[104:105], v[102:103], v[92:93] op_sel:[0,0] op_sel_hi:[0,1]
    v_pk_fma_f32 v[104:105], v[102:103], v[92:93], v[104:105] op_sel:[1,1,0] op_sel_hi:[1,0,1] neg_lo:[1,0,0]
    v_pk_mul_f32 v[106:107], v[104:105], v[92:93] op_sel:[0,0] op_sel_hi:[0,1]
    v_pk_fma_f32 v[106:107], v[104:105], v[92:93], v[106:107] op_sel:[1,1,0] op_sel_hi:[1,0,1] neg_lo:[1,0,0]
    v_pk_mul_f32 v[108:109], v[106:107], v[92:93] op_sel:[0,0] op_sel_hi:[0,1]
    v_pk_fma_f32 v[108:109], v[106:107], v[92:93], v[108:109] op_sel:[1,1,0] op_sel_hi:[1,0,1] neg_lo:[1,0,0]
    v_pk_mul_f32 v[110:111], v[108:109], v[92:93] op_sel:[0,0] op_sel_hi:[0,1]
    v_pk_fma_f32 v[110:111], v[108:109], v[92:93], v[110:111] op_sel:[1,1,0] op_sel_hi:[1,0,1] neg_lo:[1,0,0]
    s_waitcnt lgkmcnt(8)
    s_nop 0
    v_mfma_f32_16x16x32_bf16 v[120:123], a[32:35], a[0:3], v[120:123]
    v_cvt_pk_bf16_f32 v44, v96, -v97
    v_cvt_pk_bf16_f32 v45, v98, -v99
    v_mfma_f32_16x16x32_bf16 v[120:123], a[36:39], a[4:7], v[120:123]
    v_cvt_pk_bf16_f32 v46, v100, -v101
    v_cvt_pk_bf16_f32 v47, v102, -v103
    v_mfma_f32_16x16x32_bf16 v[120:123], a[40:43], a[8:11], v[120:123]
    v_cvt_pk_bf16_f32 v48, v104, -v105
    v_cvt_pk_bf16_f32 v49, v106, -v107
    v_mfma_f32_16x16x32_bf16 v[120:123], a[44:47], a[12:15], v[120:123]
    v_cvt_pk_bf16_f32 v50, v108, -v109
    v_cvt_pk_bf16_f32 v51, v110, -v111
    ds_write_addtid_b32 v44 offset:2176
    ds_write_addtid_b32 v45 offset:2448
    ds_write_addtid_b32 v46 offset:2720
    ds_write_addtid_b32 v47 offset:2992
    ds_write_addtid_b32 v48 offset:3264
    ds_write_addtid_b32 v49 offset:3536
    ds_write_addtid_b32 v50 offset:3808
    ds_write_addtid_b32 v51 offset:4080
    ds_read_b128 a[0:3], v126 offset:0
    ds_read_b128 a[4:7], v126 offset:64
    ds_read_b128 a[8:11], v126 offset:128
    ds_read_b128 a[12:15], v126 offset:192
    v_pk_mul_f32 v[2:3], v[90:91], v[90:91] op_sel:[0,0] op_sel_hi:[0,1]
    v_pk_fma_f32 v[2:3], v[90:91], v[90:91], v[2:3] op_sel:[1,1,0] op_sel_hi:[1,0,1] neg_lo:[1,0,0]
    v_pk_mul_f32 v[4:5], v[2:3], v[90:91] op_sel:[0,0] op_sel_hi:[0,1]
    v_pk_fma_f32 v[4:5], v[2:3], v[90:91], v[4:5] op_sel:[1,1,0] op_sel_hi:[1,0,1] neg_lo:[1,0,0]
    v_pk_mul_f32 v[6:7], v[2:3], v[2:3] op_sel:[0,0] op_sel_hi:[0,1]
    v_pk_fma_f32 v[6:7], v[2:3], v[2:3], v[6:7] op_sel:[1,1,0] op_sel_hi:[1,0,1] neg_lo:[1,0,0]
    v_pk_mul_f32 v[8:9], v[6:7], v[90:91] op_sel:[0,0] op_sel_hi:[0,1]
    v_pk_fma_f32 v[8:9], v[6:7], v[90:91], v[8:9] op_sel:[1,1,0] op_sel_hi:[1,0,1] neg_lo:[1,0,0]
    v_pk_mul_f32 v[10:11], v[6:7], v[2:3] op_sel:[0,0] op_sel_hi:[0,1]
    v_pk_fma_f32 v[10:11], v[6:7], v[2:3], v[10:11] op_sel:[1,1,0] op_sel_hi:[1,0,1] neg_lo:[1,0,0]
    v_pk_mul_f32 v[12:13], v[6:7], v[4:5] op_sel:[0,0] op_sel_hi:[0,1]
    v_pk_fma_f32 v[12:13], v[6:7], v[4:5], v[12:13] op_sel:[1,1,0] op_sel_hi:[1,0,1] neg_lo:[1,0,0]
    v_pk_mul_f32 v[14:15], v[6:7], v[6:7] op_sel:[0,0] op_sel_hi:[0,1]
    v_pk_fma_f32 v[14:15], v[6:7], v[6:7], v[14:15] op_sel:[1,1,0] op_sel_hi:[1,0,1] neg_lo:[1,0,0]
    v_cvt_pk_bf16_f32 v44, v90, v91
    v_cvt_pk_bf16_f32 v45, v2, v3
    v_cvt_pk_bf16_f32 v46, v4, v5
    v_cvt_pk_bf16_f32 v47, v6, v7
    v_cvt_pk_bf16_f32 v48, v8, v9
    v_cvt_pk_bf16_f32 v49, v10, v11
    v_cvt_pk_bf16_f32 v50, v12, v13
    v_cvt_pk_bf16_f32 v51, v14, v15
    ds_write_addtid_b32 v44 offset:0
    ds_write_addtid_b32 v45 offset:272
    ds_write_addtid_b32 v46 offset:544
    ds_write_addtid_b32 v47 offset:816
    ds_write_addtid_b32 v48 offset:1088
    ds_write_addtid_b32 v49 offset:1360
    ds_write_addtid_b32 v50 offset:1632
    ds_write_addtid_b32 v51 offset:1904
    v_pk_mul_f32 v[16:17], v[14:15], v[90:91] op_sel:[0,0] op_sel_hi:[0,1]
    v_pk_fma_f32 v[16:17], v[14:15], v[90:91], v[16:17] op_sel:[1,1,0] op_sel_hi:[1,0,1] neg_lo:[1,0,0]
    v_pk_mul_f32 v[18:19], v[14:15], v[2:3] op_sel:[0,0] op_sel_hi:[0,1]
    v_pk_fma_f32 v[18:19], v[14:15], v[2:3], v[18:19] op_sel:[1,1,0] op_sel_hi:[1,0,1] neg_lo:[1,0,0]
    v_pk_mul_f32 v[20:21], v[14:15], v[4:5] op_sel:[0,0] op_sel_hi:[0,1]
    v_pk_fma_f32 v[20:21], v[14:15], v[4:5], v[20:21] op_sel:[1,1,0] op_sel_hi:[1,0,1] neg_lo:[1,0,0]
    v_pk_mul_f32 v[22:23], v[14:15], v[6:7] op_sel:[0,0] op_sel_hi:[0,1]
    v_pk_fma_f32 v[22:23], v[14:15], v[6:7], v[22:23] op_sel:[1,1,0] op_sel_hi:[1,0,1] neg_lo:[1,0,0]
    v_pk_mul_f32 v[24:25], v[14:15], v[8:9] op_sel:[0,0] op_sel_hi:[0,1]
    v_pk_fma_f32 v[24:25], v[14:15], v[8:9], v[24:25] op_sel:[1,1,0] op_sel_hi:[1,0,1] neg_lo:[1,0,0]
    v_pk_mul_f32 v[26:27], v[14:15], v[10:11] op_sel:[0,0] op_sel_hi:[0,1]
    v_pk_fma_f32 v[26:27], v[14:15], v[10:11], v[26:27] op_sel:[1,1,0] op_sel_hi:[1,0,1] neg_lo:[1,0,0]
    v_pk_mul_f32 v[28:29], v[14:15], v[12:13] op_sel:[0,0] op_sel_hi:[0,1]
    v_pk_fma_f32 v[28:29], v[14:15], v[12:13], v[28:29] op_sel:[1,1,0] op_sel_hi:[1,0,1] neg_lo:[1,0,0]
    v_cvt_pk_bf16_f32 v44, v16, v17
    v_cvt_pk_bf16_f32 v45, v18, v19
    v_cvt_pk_bf16_f32 v46, v20, v21
    v_cvt_pk_bf16_f32 v47, v22, v23
    v_cvt_pk_bf16_f32 v48, v24, v25
    v_cvt_pk_bf16_f32 v49, v26, v27
    v_cvt_pk_bf16_f32 v50, v28, v29
    v_cvt_pk_bf16_f32 v51, v92, v93
    ds_write_addtid_b32 v44 offset:2176
    ds_write_addtid_b32 v45 offset:2448
    ds_write_addtid_b32 v46 offset:2720
    ds_write_addtid_b32 v47 offset:2992
    ds_write_addtid_b32 v48 offset:3264
    ds_write_addtid_b32 v49 offset:3536
    ds_write_addtid_b32 v50 offset:3808
    ds_write_addtid_b32 v51 offset:4080
    ds_read_b128 a[16:19], v126 offset:0
    ds_read_b128 a[20:23], v126 offset:64
    ds_read_b128 a[24:27], v126 offset:128
    ds_read_b128 a[28:31], v126 offset:192
    v_pk_mul_f32 v[96:97], v[94:95], v[2:3] op_sel:[0,0] op_sel_hi:[0,1]
    v_pk_fma_f32 v[96:97], v[94:95], v[2:3], v[96:97] op_sel:[1,1,0] op_sel_hi:[1,0,1] neg_lo:[1,0,0]
    v_pk_mul_f32 v[98:99], v[94:95], v[6:7] op_sel:[0,0] op_sel_hi:[0,1]
    v_pk_fma_f32 v[98:99], v[94:95], v[6:7], v[98:99] op_sel:[1,1,0] op_sel_hi:[1,0,1] neg_lo:[1,0,0]
    v_pk_mul_f32 v[100:101], v[94:95], v[10:11] op_sel:[0,0] op_sel_hi:[0,1]
    v_pk_fma_f32 v[100:101], v[94:95], v[10:11], v[100:101] op_sel:[1,1,0] op_sel_hi:[1,0,1] neg_lo:[1,0,0]
    v_pk_mul_f32 v[102:103], v[94:95], v[14:15] op_sel:[0,0] op_sel_hi:[0,1]
    v_pk_fma_f32 v[102:103], v[94:95], v[14:15], v[102:103] op_sel:[1,1,0] op_sel_hi:[1,0,1] neg_lo:[1,0,0]
    v_pk_mul_f32 v[104:105], v[94:95], v[18:19] op_sel:[0,0] op_sel_hi:[0,1]
    v_pk_fma_f32 v[104:105], v[94:95], v[18:19], v[104:105] op_sel:[1,1,0] op_sel_hi:[1,0,1] neg_lo:[1,0,0]
    v_pk_mul_f32 v[106:107], v[94:95], v[22:23] op_sel:[0,0] op_sel_hi:[0,1]
    v_pk_fma_f32 v[106:107], v[94:95], v[22:23], v[106:107] op_sel:[1,1,0] op_sel_hi:[1,0,1] neg_lo:[1,0,0]
    v_pk_mul_f32 v[108:109], v[94:95], v[26:27] op_sel:[0,0] op_sel_hi:[0,1]
    v_pk_fma_f32 v[108:109], v[94:95], v[26:27], v[108:109] op_sel:[1,1,0] op_sel_hi:[1,0,1] neg_lo:[1,0,0]
    v_pk_mul_f32 v[110:111], v[94:95], v[92:93] op_sel:[0,0] op_sel_hi:[0,1]
    v_pk_fma_f32 v[110:111], v[94:95], v[92:93], v[110:111] op_sel:[1,1,0] op_sel_hi:[1,0,1] neg_lo:[1,0,0]
    v_cvt_pk_bf16_f32 v44, v96, v97
    v_cvt_pk_bf16_f32 v45, v98, v99
    v_cvt_pk_bf16_f32 v46, v100, v101
    v_cvt_pk_bf16_f32 v47, v102, v103
    v_cvt_pk_bf16_f32 v48, v104, v105
    v_cvt_pk_bf16_f32 v49, v106, v107
    v_cvt_pk_bf16_f32 v50, v108, v109
    v_cvt_pk_bf16_f32 v51, v110, v111
    ds_write_addtid_b32 v44 offset:0
    ds_write_addtid_b32 v45 offset:272
    ds_write_addtid_b32 v46 offset:544
    ds_write_addtid_b32 v47 offset:816
    ds_write_addtid_b32 v48 offset:1088
    ds_write_addtid_b32 v49 offset:1360
    ds_write_addtid_b32 v50 offset:1632
    ds_write_addtid_b32 v51 offset:1904
    v_pk_mul_f32 v[32:33], v[94:95], v[94:95] op_sel:[0,0] op_sel_hi:[0,1]
    v_pk_fma_f32 v[32:33], v[94:95], v[94:95], v[32:33] op_sel:[1,1,0] op_sel_hi:[1,0,1] neg_lo:[1,0,0]
    v_pk_mul_f32 v[34:35], v[32:33], v[94:95] op_sel:[0,0] op_sel_hi:[0,1]
    v_pk_fma_f32 v[34:35], v[32:33], v[94:95], v[34:35] op_sel:[1,1,0] op_sel_hi:[1,0,1] neg_lo:[1,0,0]
    v_pk_mul_f32 v[96:97], v[32:33], v[6:7] op_sel:[0,0] op_sel_hi:[0,1]
    v_pk_fma_f32 v[96:97], v[32:33], v[6:7], v[96:97] op_sel:[1,1,0] op_sel_hi:[1,0,1] neg_lo:[1,0,0]
    v_pk_mul_f32 v[98:99], v[32:33], v[14:15] op_sel:[0,0] op_sel_hi:[0,1]
    v_pk_fma_f32 v[98:99], v[32:33], v[14:15], v[98:99] op_sel:[1,1,0] op_sel_hi:[1,0,1] neg_lo:[1,0,0]
    v_pk_mul_f32 v[100:101], v[32:33], v[22:23] op_sel:[0,0] op_sel_hi:[0,1]
    v_pk_fma_f32 v[100:101], v[32:33], v[22:23], v[100:101] op_sel:[1,1,0] op_sel_hi:[1,0,1] neg_lo:[1,0,0]
    v_pk_mul_f32 v[102:103], v[32:33], v[92:93] op_sel:[0,0] op_sel_hi:[0,1]
    v_pk_fma_f32 v[102:103], v[32:33], v[92:93], v[102:103] op_sel:[1,1,0] op_sel_hi:[1,0,1] neg_lo:[1,0,0]
    v_pk_mul_f32 v[104:105], v[34:35], v[6:7] op_sel:[0,0] op_sel_hi:[0,1]
    v_pk_fma_f32 v[104:105], v[34:35], v[6:7], v[104:105] op_sel:[1,1,0] op_sel_hi:[1,0,1] neg_lo:[1,0,0]
    v_pk_mul_f32 v[106:107], v[34:35], v[14:15] op_sel:[0,0] op_sel_hi:[0,1]
    v_pk_fma_f32 v[106:107], v[34:35], v[14:15], v[106:107] op_sel:[1,1,0] op_sel_hi:[1,0,1] neg_lo:[1,0,0]
    v_pk_mul_f32 v[108:109], v[34:35], v[22:23] op_sel:[0,0] op_sel_hi:[0,1]
    v_pk_fma_f32 v[108:109], v[34:35], v[22:23], v[108:109] op_sel:[1,1,0] op_sel_hi:[1,0,1] neg_lo:[1,0,0]
    v_pk_mul_f32 v[110:111], v[34:35], v[92:93] op_sel:[0,0] op_sel_hi:[0,1]
    v_pk_fma_f32 v[110:111], v[34:35], v[92:93], v[110:111] op_sel:[1,1,0] op_sel_hi:[1,0,1] neg_lo:[1,0,0]
    s_waitcnt lgkmcnt(8)
    s_nop 0
    v_mfma_f32_16x16x32_bf16 v[112:115], a[16:19], a[0:3], v[112:115]
    v_cvt_pk_bf16_f32 v44, v96, v97
    v_cvt_pk_bf16_f32 v45, v98, v99
    v_mfma_f32_16x16x32_bf16 v[112:115], a[20:23], a[4:7], v[112:115]
    v_cvt_pk_bf16_f32 v46, v100, v101
    v_cvt_pk_bf16_f32 v47, v102, v103
    v_mfma_f32_16x16x32_bf16 v[112:115], a[24:27], a[8:11], v[112:115]
    v_cvt_pk_bf16_f32 v48, v104, v105
    v_cvt_pk_bf16_f32 v49, v106, v107
    v_mfma_f32_16x16x32_bf16 v[112:115], a[28:31], a[12:15], v[112:115]
    v_cvt_pk_bf16_f32 v50, v108, v109
    v_cvt_pk_bf16_f32 v51, v110, v111
    ds_write_addtid_b32 v44 offset:2176
    ds_write_addtid_b32 v45 offset:2448
    ds_write_addtid_b32 v46 offset:2720
    ds_write_addtid_b32 v47 offset:2992
    ds_write_addtid_b32 v48 offset:3264
    ds_write_addtid_b32 v49 offset:3536
    ds_write_addtid_b32 v50 offset:3808
    ds_write_addtid_b32 v51 offset:4080
    ds_read_b128 a[16:19], v126 offset:0
    ds_read_b128 a[20:23], v126 offset:64
    ds_read_b128 a[24:27], v126 offset:128
    ds_read_b128 a[28:31], v126 offset:192
    v_pk_mul_f32 v[36:37], v[32:33], v[32:33] op_sel:[0,0] op_sel_hi:[0,1]
    v_pk_fma_f32 v[36:37], v[32:33], v[32:33], v[36:37] op_sel:[1,1,0] op_sel_hi:[1,0,1] neg_lo:[1,0,0]
    v_pk_mul_f32 v[40:41], v[34:35], v[34:35] op_sel:[0,0] op_sel_hi:[0,1]
    v_pk_fma_f32 v[40:41], v[34:35], v[34:35], v[40:41] op_sel:[1,1,0] op_sel_hi:[1,0,1] neg_lo:[1,0,0]
    v_pk_mul_f32 v[38:39], v[36:37], v[94:95] op_sel:[0,0] op_sel_hi:[0,1]
    v_pk_fma_f32 v[38:39], v[36:37], v[94:95], v[38:39] op_sel:[1,1,0] op_sel_hi:[1,0,1] neg_lo:[1,0,0]
    v_pk_mul_f32 v[42:43], v[36:37], v[34:35] op_sel:[0,0] op_sel_hi:[0,1]
    v_pk_fma_f32 v[42:43], v[36:37], v[34:35], v[42:43] op_sel:[1,1,0] op_sel_hi:[1,0,1] neg_lo:[1,0,0]
    v_pk_mul_f32 v[96:97], v[36:37], v[14:15] op_sel:[0,0] op_sel_hi:[0,1]
    v_pk_fma_f32 v[96:97], v[36:37], v[14:15], v[96:97] op_sel:[1,1,0] op_sel_hi:[1,0,1] neg_lo:[1,0,0]
    v_pk_mul_f32 v[98:99], v[36:37], v[92:93] op_sel:[0,0] op_sel_hi:[0,1]
    v_pk_fma_f32 v[98:99], v[36:37], v[92:93], v[98:99] op_sel:[1,1,0] op_sel_hi:[1,0,1] neg_lo:[1,0,0]
    v_pk_mul_f32 v[100:101], v[38:39], v[14:15] op_sel:[0,0] op_sel_hi:[0,1]
    v_pk_fma_f32 v[100:101], v[38:39], v[14:15], v[100:101] op_sel:[1,1,0] op_sel_hi:[1,0,1] neg_lo:[1,0,0]
    v_pk_mul_f32 v[102:103], v[38:39], v[92:93] op_sel:[0,0] op_sel_hi:[0,1]
    v_pk_fma_f32 v[102:103], v[38:39], v[92:93], v[102:103] op_sel:[1,1,0] op_sel_hi:[1,0,1] neg_lo:[1,0,0]
    v_pk_mul_f32 v[104:105], v[40:41], v[14:15] op_sel:[0,0] op_sel_hi:[0,1]
    v_pk_fma_f32 v[104:105], v[40:41], v[14:15], v[104:105] op_sel:[1,1,0] op_sel_hi:[1,0,1] neg_lo:[1,0,0]
    v_pk_mul_f32 v[106:107], v[40:41], v[92:93] op_sel:[0,0] op_sel_hi:[0,1]
    v_pk_fma_f32 v[106:107], v[40:41], v[92:93], v[106:107] op_sel:[1,1,0] op_sel_hi:[1,0,1] neg_lo:[1,0,0]
    v_pk_mul_f32 v[108:109], v[42:43], v[14:15] op_sel:[0,0] op_sel_hi:[0,1]
    v_pk_fma_f32 v[108:109], v[42:43], v[14:15], v[108:109] op_sel:[1,1,0] op_sel_hi:[1,0,1] neg_lo:[1,0,0]
    v_pk_mul_f32 v[110:111], v[42:43], v[92:93] op_sel:[0,0] op_sel_hi:[0,1]
    v_pk_fma_f32 v[110:111], v[42:43], v[92:93], v[110:111] op_sel:[1,1,0] op_sel_hi:[1,0,1] neg_lo:[1,0,0]
    v_cvt_pk_bf16_f32 v44, v96, v97
    v_cvt_pk_bf16_f32 v45, v98, v99
    v_cvt_pk_bf16_f32 v46, v100, v101
    v_cvt_pk_bf16_f32 v47, v102, v103
    v_cvt_pk_bf16_f32 v48, v104, v105
    v_cvt_pk_bf16_f32 v49, v106, v107
    v_cvt_pk_bf16_f32 v50, v108, v109
    v_cvt_pk_bf16_f32 v51, v110, v111
    ds_write_addtid_b32 v44 offset:0
    ds_write_addtid_b32 v45 offset:272
    ds_write_addtid_b32 v46 offset:544
    ds_write_addtid_b32 v47 offset:816
    ds_write_addtid_b32 v48 offset:1088
    ds_write_addtid_b32 v49 offset:1360
    ds_write_addtid_b32 v50 offset:1632
    ds_write_addtid_b32 v51 offset:1904
    ds_write_addtid_b32 v127 offset:2176
    ds_read_b128 a[32:35], v126 offset:0
    ds_read_b128 a[36:39], v126 offset:64
    ds_read_b128 a[40:43], v126 offset:128
    ds_read_b128 a[44:47], v126 offset:192
    s_barrier
    s_nop 0
    buffer_load_dwordx4 v[216:219], v176, s[52:55], s7 offen offset:0 sc1
    buffer_load_dwordx4 v[220:223], v176, s[52:55], s7 offen offset:1024 sc1
    buffer_load_dwordx4 v[224:227], v176, s[52:55], s7 offen offset:2048 sc1
    buffer_load_dwordx4 v[228:231], v176, s[52:55], s7 offen offset:3072 sc1
    buffer_load_dword v232, v180, s[52:55], s4 offen offset:0 sc1
    buffer_load_dword v233, v180, s[52:55], s4 offen offset:256 sc1
    buffer_load_dword v234, v180, s[52:55], s4 offen offset:512 sc1
    buffer_load_dword v235, v180, s[52:55], s4 offen offset:768 sc1
    buffer_load_dword v236, v180, s[52:55], s5 offen offset:0 sc1
    buffer_load_dword v237, v180, s[52:55], s5 offen offset:256 sc1
    buffer_load_dword v238, v180, s[52:55], s5 offen offset:512 sc1
    buffer_load_dword v239, v180, s[52:55], s5 offen offset:768 sc1
    buffer_load_dword v240, v180, s[52:55], s6 offen offset:0 sc1
    buffer_load_dword v241, v180, s[52:55], s6 offen offset:256 sc1
    buffer_load_dword v242, v180, s[52:55], s6 offen offset:512 sc1
    buffer_load_dword v243, v180, s[52:55], s6 offen offset:768 sc1
    v_mov_b32 v2, 24576
    ds_read_b32 v174, v2
    s_waitcnt lgkmcnt(14)
    v_mfma_f32_16x16x32_bf16 v[116:119], a[16:19], a[0:3], v[116:119]
    v_mfma_f32_16x16x32_bf16 v[116:119], a[20:23], a[4:7], v[116:119]
    v_mfma_f32_16x16x32_bf16 v[116:119], a[24:27], a[8:11], v[116:119]
    v_mfma_f32_16x16x32_bf16 v[116:119], a[28:31], a[12:15], v[116:119]
    v_cvt_pk_bf16_f32 v8, v112, v113
    v_cvt_pk_bf16_f32 v9, v114, v115
    v_mov_b32 v15, 0
    ds_write_b64 v184, v[8:9] offset:8
    s_waitcnt lgkmcnt(2)
    s_nop 0
    v_mfma_f32_16x16x32_bf16 v[120:123], a[32:35], a[0:3], v[120:123]
    v_mfma_f32_16x16x32_bf16 v[120:123], a[36:39], a[4:7], v[120:123]
    v_mfma_f32_16x16x32_bf16 v[120:123], a[40:43], a[8:11], v[120:123]
    v_mfma_f32_16x16x32_bf16 v[120:123], a[44:47], a[12:15], v[120:123]
    v_cvt_pk_bf16_f32 v10, v116, v117
    v_cvt_pk_bf16_f32 v11, v118, v119
    ds_write_b64 v185, v[10:11] offset:520
    s_mov_b32 s72, 0x3020302
    s_mov_b32 s73, 0x5040504
    s_mov_b32 s74, 0x7060706
    s_mov_b32 s75, 0x3020504
    s_mov_b32 s76, 0x5040706
    v_cvt_pk_bf16_f32 v12, v120, v121
    v_cvt_pk_bf16_f32 v13, v122, v123
    v_add_f32 v14, v120, v71
    v_cvt_pk_bf16_f32 v14, v15, v14
    s_mov_b32 exec_hi, 0
    ds_write_b32 v186, v12 offset:1032
    ds_write_b32 v186, v13 offset:1096
    s_mov_b32 exec_lo, 0
    s_mov_b32 exec_hi, 1
    ds_write_b32 v187, v14 offset:4
    s_mov_b64 exec, -1
    s_nop 0
    ds_read2_b32 v[22:23], v188 offset0:0 offset1:1
    ds_read2_b32 v[20:21], v188 offset0:64 offset1:65
    ds_read2_b32 v[24:25], v189 offset0:129 offset1:130
    ds_read_b32 v26, v189 offset:524
    ds_read2_b32 v[28:29], v190 offset0:1 offset1:2
    ds_read2_b32 v[30:31], v190 offset0:3 offset1:4
    ds_read_b32 v32, v190 offset:20
    s_waitcnt lgkmcnt(0)
    s_nop 0
    v_perm_b32 v44, v23, v22, s76
    v_perm_b32 v45, v23, v22, s73
    v_perm_b32 v46, v23, v22, s72
    v_perm_b32 v47, v23, v22, s72
    v_perm_b32 v48, v23, v22, s74
    v_perm_b32 v49, v23, v22, s73
    v_perm_b32 v50, v23, v22, s75
    v_perm_b32 v51, v23, v22, s72
    v_perm_b32 v96, v21, v20, s73
    v_perm_b32 v97, v21, v20, s72
    v_perm_b32 v98, v21, v20, s72
    v_perm_b32 v99, v21, v20, s72
    v_perm_b32 v100, v21, v20, s74
    v_perm_b32 v101, v21, v20, s76
    v_perm_b32 v102, v21, v20, s73
    v_perm_b32 v103, v21, v20, s73
    v_perm_b32 v104, v21, v20, s73
    v_perm_b32 v105, v21, v20, s75
    v_perm_b32 v106, v21, v20, s72
    v_perm_b32 v107, v21, v20, s72
    v_perm_b32 v108, v21, v20, s74
    v_perm_b32 v109, v21, v20, s74
    v_perm_b32 v110, v21, v20, s73
    v_perm_b32 v111, v21, v20, s73
    v_perm_b32 v36, v26, v25, v195
    v_perm_b32 v37, v25, v24, s74
    v_perm_b32 v38, v25, v24, v195
    v_perm_b32 v39, v25, v24, v197
    v_perm_b32 v40, v32, v31, v196
    v_perm_b32 v41, v31, v30, v196
    v_perm_b32 v42, v30, v29, v196
    v_perm_b32 v43, v29, v28, v196
    ds_write_b128 v192, v[44:47] offset:1472
    ds_write_b128 v192, v[48:51] offset:6048
    ds_write_b128 v191, v[96:99] offset:2496
    ds_write_b128 v191, v[100:103] offset:2512
    ds_write_b128 v191, v[104:107] offset:7072
    ds_write_b128 v191, v[108:111] offset:7088
    ds_write_b128 v194, v[36:39] offset:960
    ds_write_b128 v194, v[40:43] offset:448
    s_waitcnt vmcnt(0)
L_join:
    s_mov_b32 s93, 0x8000
    v_xor_b32 v244, v219, v174
    v_xor_b32 v245, v223, v174
    v_xor_b32 v246, v227, v174
    v_xor_b32 v247, v231, v174
    v_or3_b32 v244, v244, v245, v246
    v_or_b32 v244, v244, v247
    v_cmp_ne_u32 vcc, 0, v244
    s_nop 1
    s_cbranch_vccnz L_slow_3
L_back_4:
    ds_read_b64_tr_b16 v[108:109], v128
    ds_read_b64_tr_b16 v[110:111], v128 offset:2048
    ds_read_b64_tr_b16 v[112:113], v129
    ds_read_b64_tr_b16 v[114:115], v129 offset:2048
    s_lshl_b32 s3, s60, 10
    s_add_u32 m0, s3, 52480
    v_and_b32 v219, 0xffff0000, v218
    v_lshlrev_b32 v218, 16, v218
    v_pk_mul_f32 v[218:219], v[218:219], v[216:217]
    v_and_b32 v223, 0xffff0000, v222
    v_lshlrev_b32 v222, 16, v222
    v_pk_mul_f32 v[222:223], v[222:223], v[220:221]
    v_and_b32 v227, 0xffff0000, v226
    v_lshlrev_b32 v226, 16, v226
    v_pk_mul_f32 v[226:227], v[226:227], v[224:225]
    v_and_b32 v231, 0xffff0000, v230
    v_lshlrev_b32 v230, 16, v230
    v_pk_mul_f32 v[230:231], v[230:231], v[228:229]
    v_lshlrev_b32 v244, 16, v232
    v_and_b32 v245, 0xffff0000, v232
    v_pk_fma_f32 v[244:245], v[244:245], v[216:217], v[218:219] neg_lo:[0,0,1] neg_hi:[0,0,1]
    v_cvt_pk_bf16_f32 v232, v244, v245
    v_lshlrev_b32 v246, 16, v233
    v_and_b32 v247, 0xffff0000, v233
    v_pk_fma_f32 v[246:247], v[246:247], v[220:221], v[222:223] neg_lo:[0,0,1] neg_hi:[0,0,1]
    v_cvt_pk_bf16_f32 v233, v246, v247
    v_lshlrev_b32 v248, 16, v234
    v_and_b32 v249, 0xffff0000, v234
    v_pk_fma_f32 v[248:249], v[248:249], v[224:225], v[226:227] neg_lo:[0,0,1] neg_hi:[0,0,1]
    v_cvt_pk_bf16_f32 v234, v248, v249
    v_lshlrev_b32 v250, 16, v235
    v_and_b32 v251, 0xffff0000, v235
    v_pk_fma_f32 v[250:251], v[250:251], v[228:229], v[230:231] neg_lo:[0,0,1] neg_hi:[0,0,1]
    v_cvt_pk_bf16_f32 v235, v250, v251
    v_lshlrev_b32 v244, 16, v236
    v_and_b32 v245, 0xffff0000, v236
    v_pk_fma_f32 v[244:245], v[244:245], v[216:217], v[218:219] neg_lo:[0,0,1] neg_hi:[0,0,1]
    v_cvt_pk_bf16_f32 v236, v244, v245
    v_lshlrev_b32 v246, 16, v237
    v_and_b32 v247, 0xffff0000, v237
    v_pk_fma_f32 v[246:247], v[246:247], v[220:221], v[222:223] neg_lo:[0,0,1] neg_hi:[0,0,1]
    v_cvt_pk_bf16_f32 v237, v246, v247
    v_lshlrev_b32 v248, 16, v238
    v_and_b32 v249, 0xffff0000, v238
    v_pk_fma_f32 v[248:249], v[248:249], v[224:225], v[226:227] neg_lo:[0,0,1] neg_hi:[0,0,1]
    v_cvt_pk_bf16_f32 v238, v248, v249
    v_lshlrev_b32 v250, 16, v239
    v_and_b32 v251, 0xffff0000, v239
    v_pk_fma_f32 v[250:251], v[250:251], v[228:229], v[230:231] neg_lo:[0,0,1] neg_hi:[0,0,1]
    v_cvt_pk_bf16_f32 v239, v250, v251
    v_lshlrev_b32 v244, 16, v240
    v_and_b32 v245, 0xffff0000, v240
    v_pk_fma_f32 v[244:245], v[244:245], v[216:217], v[218:219] neg_lo:[0,0,1] neg_hi:[0,0,1]
    v_cvt_pk_bf16_f32 v240, v244, v245
    v_lshlrev_b32 v246, 16, v241
    v_and_b32 v247, 0xffff0000, v241
    v_pk_fma_f32 v[246:247], v[246:247], v[220:221], v[222:223] neg_lo:[0,0,1] neg_hi:[0,0,1]
    v_cvt_pk_bf16_f32 v241, v246, v247
    v_lshlrev_b32 v248, 16, v242
    v_and_b32 v249, 0xffff0000, v242
    v_pk_fma_f32 v[248:249], v[248:249], v[224:225], v[226:227] neg_lo:[0,0,1] neg_hi:[0,0,1]
    v_cvt_pk_bf16_f32 v242, v248, v249
    v_lshlrev_b32 v250, 16, v243
    v_and_b32 v251, 0xffff0000, v243
    v_pk_fma_f32 v[250:251], v[250:251], v[228:229], v[230:231] neg_lo:[0,0,1] neg_hi:[0,0,1]
    v_cvt_pk_bf16_f32 v243, v250, v251
    ds_write_addtid_b32 v232 offset:64
    ds_write_addtid_b32 v232 offset:4284
    ds_write_addtid_b32 v233 offset:320
    ds_write_addtid_b32 v233 offset:4540
    ds_write_addtid_b32 v234 offset:576
    ds_write_addtid_b32 v234 offset:4796
    ds_write_addtid_b32 v235 offset:832
    ds_write_addtid_b32 v235 offset:5052
    ds_write_addtid_b32 v236 offset:8512
    ds_write_addtid_b32 v236 offset:12732
    ds_write_addtid_b32 v237 offset:8768
    ds_write_addtid_b32 v237 offset:12988
    ds_write_addtid_b32 v238 offset:9024
    ds_write_addtid_b32 v238 offset:13244
    ds_write_addtid_b32 v239 offset:9280
    ds_write_addtid_b32 v239 offset:13500
    ds_write_addtid_b32 v240 offset:16960
    ds_write_addtid_b32 v240 offset:21180
    ds_write_addtid_b32 v241 offset:17216
    ds_write_addtid_b32 v241 offset:21436
    ds_write_addtid_b32 v242 offset:17472
    ds_write_addtid_b32 v242 offset:21692
    ds_write_addtid_b32 v243 offset:17728
    ds_write_addtid_b32 v243 offset:21948
    buffer_load_dword v50, v140, s[52:55], 0 offen sc1
    s_waitcnt lgkmcnt(0)
    s_barrier
    s_cmp_eq_u32 s66, 1
    s_cbranch_scc1 L_conv_odd
    ds_read_b128 a[32:35], v164 offset:0
    ds_read_b64 a[60:61], v165 offset:1728
    ds_read_b64 a[62:63], v165 offset:1736
    ds_read_b64 a[52:53], v165 offset:1216
    ds_read_b64 a[54:55], v165 offset:1224
    ds_read_b64 a[44:45], v165 offset:704
    ds_read_b64 a[46:47], v165 offset:712
    ds_read_b64 a[36:37], v165 offset:192
    ds_read_b64 a[38:39], v165 offset:200
    ds_read_b128 a[40:43], v164 offset:512
    ds_read_b128 a[48:51], v164 offset:1024
    ds_read_b128 a[56:59], v164 offset:1536
    ds_read_b128 a[0:3], v166 offset:0
    s_waitcnt lgkmcnt(6)
    v_mfma_f32_16x16x32_bf16 v[14:17], a[32:35], a[60:63], 0
    s_nop 0
    ds_read_b64 a[28:29], v167 offset:1600
    buffer_load_dword v154, v168, s[52:55], s84 offen offset:0 sc1
    v_mfma_f32_16x16x32_bf16 v[10:13], a[32:35], a[52:55], 0
    ds_read_b64 a[30:31], v167 offset:1608
    buffer_load_dword v155, v168, s[52:55], s84 offen offset:512 sc1
    v_mfma_f32_16x16x32_bf16 v[6:9], a[32:35], a[44:47], 0
    ds_read_b64 a[4:5], v167 offset:64
    v_accvgpr_write_b32 a252, -1
    s_waitcnt lgkmcnt(6)
    s_nop 0
    v_mfma_f32_16x16x32_bf16 v[2:5], a[32:35], a[36:39], 0
    ds_read_b64 a[6:7], v167 offset:72
    buffer_load_dword v156, v168, s[52:55], s84 offen offset:1024 sc1
    v_mfma_f32_16x16x32_bf16 v[14:17], a[40:43], a[52:55], v[14:17]
    ds_read_b128 a[8:11], v166 offset:512
    buffer_load_dword v157, v168, s[52:55], s84 offen offset:1536 sc1
    v_mfma_f32_16x16x32_bf16 v[10:13], a[40:43], a[44:47], v[10:13]
    ds_read_b64 a[20:21], v167 offset:1088
    ds_read_b64 a[22:23], v167 offset:1096
    buffer_load_dword v158, v168, s[52:55], s85 offen offset:0 sc1
    v_mfma_f32_16x16x32_bf16 v[6:9], a[40:43], a[36:39], v[6:9]
    ds_read_b128 a[16:19], v166 offset:1024
    ds_read_b64 a[12:13], v167 offset:576
    s_waitcnt lgkmcnt(7)
    s_nop 0
    v_mfma_f32_16x16x32_bf16 v[14:17], a[48:51], a[44:47], v[14:17]
    ds_read_b64 a[14:15], v167 offset:584
    ds_read_b128 a[24:27], v166 offset:1536
    buffer_store_dwordx4 v[108:111], v130, s[52:55], 0 offen sc1
    v_mfma_f32_16x16x32_bf16 v[10:13], a[48:51], a[36:39], v[10:13]
    ds_read_b128 a[64:67], v164 offset:64
    v_accvgpr_write_b32 a253, -1
    v_mfma_f32_16x16x32_bf16 v[14:17], a[56:59], a[36:39], v[14:17]
    ds_read_b64 a[92:93], v165 offset:1664
    v_accvgpr_write_b32 a254, -1
    v_mfma_f32_16x16x32_bf16 v[22:25], a[0:3], a[28:31], 0
    ds_read_b64 a[94:95], v165 offset:1672
    buffer_store_dwordx4 v[112:115], v131, s[52:55], 0 offen sc1
    s_waitcnt lgkmcnt(6)
    v_mfma_f32_16x16x32_bf16 v[18:21], a[0:3], a[4:7], 0
    s_nop 0
    ds_read_b64 a[84:85], v165 offset:1152
    v_accvgpr_write_b32 a255, -1
    v_mfma_f32_16x16x32_bf16 v[22:25], a[8:11], a[20:23], v[22:25]
    ds_read_b64 a[86:87], v165 offset:1160
    ds_read_b64 a[76:77], v165 offset:640
    s_waitcnt lgkmcnt(6)
    v_mfma_f32_16x16x32_bf16 v[22:25], a[16:19], a[12:15], v[22:25]
    ds_read_b64 a[78:79], v165 offset:648
    ds_read_b64 a[68:69], v165 offset:128
    v_mfma_f32_16x16x32_bf16 v[22:25], a[24:27], a[4:7], v[22:25]
    ds_read_b64 a[70:71], v165 offset:136
    ds_read_b128 a[72:75], v164 offset:576
    v_mfma_f32_16x16x32_bf16 v[42:45], a[8:11], a[28:31], 0
    ds_read_b128 a[80:83], v164 offset:1088
    v_mfma_f32_16x16x32_bf16 v[42:45], a[16:19], a[20:23], v[42:45]
    ds_read_b128 a[88:91], v164 offset:1600
    v_mfma_f32_16x16x32_bf16 v[42:45], a[24:27], a[12:15], v[42:45]
    ds_read_b128 a[96:99], v166 offset:64
    s_waitcnt lgkmcnt(6)
    v_mfma_f32_16x16x32_bf16 v[14:17], a[64:67], a[92:95], v[14:17]
    ds_read_b64 a[124:125], v167 offset:1536
    v_mfma_f32_16x16x32_bf16 v[10:13], a[64:67], a[84:87], v[10:13]
    ds_read_b64 a[126:127], v167 offset:1544
    s_waitcnt vmcnt(7)
    v_cmp_ne_u32 vcc, v174, v50
    s_nop 1
    s_cbranch_vccnz L_slow_13
L_back_14:
    v_mfma_f32_16x16x32_bf16 v[6:9], a[64:67], a[76:79], v[6:9]
    ds_read_b64 a[100:101], v167 offset:0
    buffer_load_dwordx4 v[184:187], v175, s[52:55], s80 offen offset:0 sc1
    s_waitcnt lgkmcnt(6)
    v_mfma_f32_16x16x32_bf16 v[2:5], a[64:67], a[68:71], v[2:5]
    s_nop 0
    ds_read_b64 a[102:103], v167 offset:8
    v_mfma_f32_16x16x32_bf16 v[14:17], a[72:75], a[84:87], v[14:17]
    ds_read_b128 a[104:107], v166 offset:576
    buffer_load_dwordx4 v[188:191], v175, s[52:55], s80 offen offset:1024 sc1
    v_mfma_f32_16x16x32_bf16 v[10:13], a[72:75], a[76:79], v[10:13]
    ds_read_b64 a[116:117], v167 offset:1024
    ds_read_b64 a[118:119], v167 offset:1032
    v_mfma_f32_16x16x32_bf16 v[6:9], a[72:75], a[68:71], v[6:9]
    ds_read_b128 a[112:115], v166 offset:1088
    ds_read_b64 a[108:109], v167 offset:512
    s_waitcnt lgkmcnt(7)
    v_mfma_f32_16x16x32_bf16 v[14:17], a[80:83], a[76:79], v[14:17]
    ds_read_b64 a[110:111], v167 offset:520
    ds_read_b128 a[120:123], v166 offset:1600
    v_mfma_f32_16x16x32_bf16 v[10:13], a[80:83], a[68:71], v[10:13]
    ds_read_b128 a[128:131], v164 offset:128
    buffer_load_dwordx4 v[192:195], v175, s[52:55], s80 offen offset:2048 sc1
    v_mfma_f32_16x16x32_bf16 v[14:17], a[88:91], a[68:71], v[14:17]
    ds_read_b64 a[156:157], v165 offset:1600
    v_mfma_f32_16x16x32_bf16 v[22:25], a[96:99], a[124:127], v[22:25]
    ds_read_b64 a[158:159], v165 offset:1608
    s_waitcnt lgkmcnt(6)
    v_mfma_f32_16x16x32_bf16 v[18:21], a[96:99], a[100:103], v[18:21]
    ds_read_b64 a[148:149], v165 offset:1088
    v_mfma_f32_16x16x32_bf16 v[22:25], a[104:107], a[116:119], v[22:25]
    ds_read_b64 a[150:151], v165 offset:1096
    ds_read_b64 a[140:141], v165 offset:576
    buffer_load_dwordx4 v[196:199], v175, s[52:55], s80 offen offset:3072 sc1
    s_waitcnt lgkmcnt(6)
    v_mfma_f32_16x16x32_bf16 v[22:25], a[112:115], a[108:111], v[22:25]
    s_nop 0
    ds_read_b64 a[142:143], v165 offset:584
    ds_read_b64 a[132:133], v165 offset:64
    v_mfma_f32_16x16x32_bf16 v[22:25], a[120:123], a[100:103], v[22:25]
    ds_read_b64 a[134:135], v165 offset:72
    ds_read_b128 a[136:139], v164 offset:640
    v_mfma_f32_16x16x32_bf16 v[42:45], a[104:107], a[124:127], v[42:45]
    ds_read_b128 a[144:147], v164 offset:1152
    v_mfma_f32_16x16x32_bf16 v[42:45], a[112:115], a[116:119], v[42:45]
    ds_read_b128 a[152:155], v164 offset:1664
    s_add_u32 s80, s80, 4096
    buffer_load_dwordx4 v[200:203], v175, s[52:55], s80 offen offset:0 sc1
    v_mfma_f32_16x16x32_bf16 v[42:45], a[120:123], a[108:111], v[42:45]
    ds_read_b128 a[160:163], v164 offset:192
    s_waitcnt lgkmcnt(6)
    v_mfma_f32_16x16x32_bf16 v[14:17], a[128:131], a[156:159], v[14:17]
    ds_read_b64 a[188:189], v165 offset:1536
    v_mfma_f32_16x16x32_bf16 v[10:13], a[128:131], a[148:151], v[10:13]
    ds_read_b64 a[190:191], v165 offset:1544
    v_mfma_f32_16x16x32_bf16 v[6:9], a[128:131], a[140:143], v[6:9]
    ds_read_b64 a[180:181], v165 offset:1024
    buffer_load_dwordx4 v[204:207], v175, s[52:55], s80 offen offset:1024 sc1
    s_waitcnt lgkmcnt(6)
    v_mfma_f32_16x16x32_bf16 v[2:5], a[128:131], a[132:135], v[2:5]
    ds_read_b64 a[182:183], v165 offset:1032
    v_mfma_f32_16x16x32_bf16 v[14:17], a[136:139], a[148:151], v[14:17]
    ds_read_b64 a[172:173], v165 offset:512
    v_mfma_f32_16x16x32_bf16 v[10:13], a[136:139], a[140:143], v[10:13]
    ds_read_b64 a[174:175], v165 offset:520
    ds_read_b64 a[164:165], v165 offset:0
    v_mfma_f32_16x16x32_bf16 v[6:9], a[136:139], a[132:135], v[6:9]
    ds_read_b64 a[166:167], v165 offset:8
    ds_read_b128 a[168:171], v164 offset:704
    buffer_load_dwordx4 v[208:211], v175, s[52:55], s80 offen offset:2048 sc1
    s_waitcnt lgkmcnt(7)
    v_mfma_f32_16x16x32_bf16 v[14:17], a[144:147], a[140:143], v[14:17]
    ds_read_b128 a[176:179], v164 offset:1216
    v_mfma_f32_16x16x32_bf16 v[10:13], a[144:147], a[132:135], v[10:13]
    ds_read_b128 a[184:187], v164 offset:1728
    v_mfma_f32_16x16x32_bf16 v[14:17], a[152:155], a[132:135], v[14:17]
    v_mfma_f32_16x16x32_bf16 v[14:17], a[160:163], a[188:191], v[14:17]
    buffer_load_dwordx4 v[212:215], v175, s[52:55], s80 offen offset:3072 sc1
    s_waitcnt lgkmcnt(7)
    v_mfma_f32_16x16x32_bf16 v[10:13], a[160:163], a[180:183], v[10:13]
    s_waitcnt lgkmcnt(5)
    v_mfma_f32_16x16x32_bf16 v[6:9], a[160:163], a[172:175], v[6:9]
    s_waitcnt lgkmcnt(3)
    v_mfma_f32_16x16x32_bf16 v[2:5], a[160:163], a[164:167], v[2:5]
    s_waitcnt lgkmcnt(2)
    v_mfma_f32_16x16x32_bf16 v[14:17], a[168:171], a[180:183], v[14:17]
    s_add_u32 s80, s80, 4096
    buffer_load_dwordx4 v[216:219], v175, s[52:55], s80 offen offset:0 sc1
    v_mfma_f32_16x16x32_bf16 v[10:13], a[168:171], a[172:175], v[10:13]
    v_mfma_f32_16x16x32_bf16 v[6:9], a[168:171], a[164:167], v[6:9]
    s_waitcnt lgkmcnt(1)
    v_mfma_f32_16x16x32_bf16 v[14:17], a[176:179], a[172:175], v[14:17]
    v_mfma_f32_16x16x32_bf16 v[10:13], a[176:179], a[164:167], v[10:13]
    buffer_load_dwordx4 v[220:223], v175, s[52:55], s80 offen offset:1024 sc1
    s_waitcnt lgkmcnt(0)
    v_mfma_f32_16x16x32_bf16 v[14:17], a[184:187], a[164:167], v[14:17]
    ds_write_b128 v170, v[18:21] offset:2048
    ds_write_b128 v170, v[22:25] offset:3072
    v_mfma_f32_16x16x32_bf16 v[26:29], a[40:43], a[60:63], 0
    buffer_load_dwordx4 v[224:227], v175, s[52:55], s80 offen offset:2048 sc1
    v_mfma_f32_16x16x32_bf16 v[26:29], a[48:51], a[52:55], v[26:29]
    ds_write2_b64 v170, v[4:5], v[8:9] offset0:0 offset1:1
    s_nop 1
    ds_write2_b64 v170, v[12:13], v[16:17] offset0:128 offset1:129
    s_waitcnt vmcnt(13)
    v_mfma_f32_16x16x32_bf16 v[30:33], a[48:51], a[60:63], 0
    v_lshlrev_b32 v150, 16, v154
    v_and_b32 v151, 0xffff0000, v154
    v_add_f32 v2, v2, v150
    v_mfma_f32_16x16x32_bf16 v[26:29], a[56:59], a[44:47], v[26:29]
    buffer_load_dwordx4 v[228:231], v175, s[52:55], s80 offen offset:3072 sc1
    v_add_f32 v3, v3, v151
    v_lshlrev_b32 v150, 16, v155
    v_and_b32 v151, 0xffff0000, v155
    v_mfma_f32_16x16x32_bf16 v[30:33], a[56:59], a[52:55], v[30:33]
    v_add_f32 v6, v6, v150
    v_add_f32 v7, v7, v151
    v_lshlrev_b32 v150, 16, v156
    v_mfma_f32_16x16x32_bf16 v[34:37], a[56:59], a[60:63], 0
    v_and_b32 v151, 0xffff0000, v156
    v_add_f32 v10, v10, v150
    v_add_f32 v11, v11, v151
    v_mfma_f32_16x16x32_bf16 v[26:29], a[72:75], a[92:95], v[26:29]
    s_add_u32 s80, s80, 4096
    buffer_load_dwordx4 v[232:235], v175, s[52:55], s80 offen offset:0 sc1
    v_lshlrev_b32 v150, 16, v157
    v_and_b32 v151, 0xffff0000, v157
    v_add_f32 v14, v14, v150
    v_mfma_f32_16x16x32_bf16 v[26:29], a[80:83], a[84:87], v[26:29]
    v_add_f32 v15, v15, v151
    v_lshlrev_b32 v152, 16, v158
    v_and_b32 v153, 0xffff0000, v158
    v_mfma_f32_16x16x32_bf16 v[30:33], a[80:83], a[92:95], v[30:33]
    s_waitcnt lgkmcnt(0)
    s_waitcnt vmcnt(13)
    s_barrier
    s_nop 0
    ds_read_b128 v[116:119], v171
    ds_read_b128 v[120:123], v171 offset:1024
    ds_read2st64_b64 v[124:127], v148 offset0:4 offset1:12
    ds_read2st64_b64 v[128:131], v148 offset0:20 offset1:28
    v_mfma_f32_16x16x32_bf16 v[26:29], a[88:91], a[76:79], v[26:29]
    buffer_load_dwordx4 v[236:239], v175, s[52:55], s80 offen offset:1024 sc1
    s_cmp_lg_u32 s60, 0
    s_cbranch_scc1 L_pub_15
    s_mov_b32 exec_hi, 0
    s_mov_b32 s3, 131328
    buffer_store_dword v174, v177, s[52:55], s3 offen sc1
    s_mov_b64 exec, -1
L_pub_15:
    v_mfma_f32_16x16x32_bf16 v[30:33], a[88:91], a[84:87], v[30:33]
    ds_read_b64 v[52:53], v167 offset:2112
    buffer_load_dwordx4 v[240:243], v175, s[52:55], s80 offen offset:2048 sc1
    v_mfma_f32_16x16x32_bf16 v[34:37], a[88:91], a[92:95], v[34:37]
    ds_read_b64 v[54:55], v167 offset:2120
    v_mfma_f32_16x16x32_bf16 v[26:29], a[136:139], a[156:159], v[26:29]
    ds_read_b128 v[56:59], v166 offset:2048
    v_mfma_f32_16x16x32_bf16 v[26:29], a[144:147], a[148:151], v[26:29]
    v_mfma_f32_16x16x32_bf16 v[30:33], a[144:147], a[156:159], v[30:33]
    ds_read_b64 v[60:61], v167 offset:2624
    buffer_load_dwordx4 v[244:247], v175, s[52:55], s80 offen offset:3072 sc1
    s_waitcnt lgkmcnt(6)
    v_add_f32 v2, v2, v116
    v_add_f32_e64 v3, v3, v117
    v_mfma_f32_16x16x32_bf16 v[26:29], a[152:155], a[140:143], v[26:29]
    ds_read_b64 v[62:63], v167 offset:2632
    v_cvt_pk_bf16_f32 v4, v2, v3
    buffer_store_dword v4, v169, s[52:55], s88 offen sc1
    s_add_u32 s88, s88, 327680
    v_add_f32 v6, v6, v118
    v_mfma_f32_16x16x32_bf16 v[30:33], a[152:155], a[148:151], v[30:33]
    ds_read_b128 v[64:67], v166 offset:2560
    s_add_u32 s80, s80, 4096
    buffer_load_dwordx4 v[248:251], v175, s[52:55], s80 offen offset:0 sc1
    v_add_f32 v7, v7, v119
    v_cvt_pk_bf16_f32 v8, v6, v7
    buffer_store_dword v8, v169, s[52:55], s88 offen sc1
    s_add_u32 s88, s88, 327680
    v_mfma_f32_16x16x32_bf16 v[34:37], a[152:155], a[156:159], v[34:37]
    ds_read_b64 v[68:69], v167 offset:3136
    v_add_f32 v10, v10, v120
    v_add_f32 v11, v11, v121
    v_cvt_pk_bf16_f32 v12, v10, v11
    v_mfma_f32_16x16x32_bf16 v[26:29], a[168:171], a[188:191], v[26:29]
    ds_read_b64 v[70:71], v167 offset:3144
    buffer_load_dwordx4 v[252:255], v175, s[52:55], s80 offen offset:1024 sc1
    buffer_store_dword v12, v169, s[52:55], s88 offen sc1
    s_add_u32 s88, s88, 327680
    v_add_f32 v14, v14, v122
    v_add_f32 v15, v15, v123
    v_mfma_f32_16x16x32_bf16 v[26:29], a[176:179], a[180:183], v[26:29]
    ds_read_b128 v[72:75], v166 offset:3072
    v_cvt_pk_bf16_f32 v16, v14, v15
    buffer_store_dword v16, v169, s[52:55], s88 offen sc1
    s_add_u32 s88, s88, 327680
    s_waitcnt lgkmcnt(9)
    s_nop 0
    v_mfma_f32_16x16x32_bf16 v[30:33], a[176:179], a[188:191], v[30:33]
    ds_read_b64 v[76:77], v167 offset:3648
    s_add_u32 m0, s81, 4294965248
    s_add_u32 s80, s32, 16384
    buffer_load_dwordx4 v149, s[52:55], s80 offen offset:2048 sc1 lds
    v_add_f32 v152, v152, v124
    v_add_f32 v153, v153, v125
    v_add_f32_e64 v152, v152, v126
    v_mfma_f32_16x16x32_bf16 v[26:29], a[184:187], a[172:175], v[26:29]
    ds_read_b64 v[78:79], v167 offset:3656
    s_add_u32 m0, s81, 2048
    s_add_u32 s80, s32, 20480
    buffer_load_dwordx4 v149, s[52:55], s80 offen offset:0 sc1 lds
    v_add_f32 v153, v153, v127
    v_add_f32 v152, v152, v128
    v_add_f32 v153, v153, v129
    v_mfma_f32_16x16x32_bf16 v[30:33], a[184:187], a[180:183], v[30:33]
    ds_read_b128 v[80:83], v166 offset:3584
    v_add_f32 v152, v152, v130
    v_add_f32_e64 v153, v153, v131
    v_cvt_pk_bf16_f32 v152, v152, v153
    v_mfma_f32_16x16x32_bf16 v[34:37], a[184:187], a[188:191], v[34:37]
    ds_read_b64 v[84:85], v165 offset:2240
    buffer_store_dword v152, v169, s[52:55], s89 offen sc1
    s_add_u32 s89, s89, 1310720
    s_waitcnt lgkmcnt(10)
    v_mfma_f32_16x16x32_bf16 v[42:45], a[0:3], v[52:55], v[42:45]
    ds_read_b64 v[86:87], v165 offset:2248
    buffer_load_dword v159, v168, s[52:55], s84 offen offset:2048 sc1
    v_mfma_f32_16x16x32_bf16 v[46:49], a[24:27], v[52:55], 0
    ds_read_b128 v[88:91], v164 offset:2048
    buffer_load_dword v160, v168, s[52:55], s84 offen offset:2560 sc1
    v_mfma_f32_16x16x32_bf16 v[42:45], v[56:59], a[4:7], v[42:45]
    v_mfma_f32_16x16x32_bf16 v[46:49], v[56:59], a[28:31], v[46:49]
    buffer_load_dword v161, v168, s[52:55], s84 offen offset:3072 sc1
    s_waitcnt lgkmcnt(6)
    v_mfma_f32_16x16x32_bf16 v[46:49], a[16:19], v[60:63], v[46:49]
    ds_read_b64 v[92:93], v165 offset:2752
    buffer_load_dword v162, v168, s[52:55], s84 offen offset:3584 sc1
    v_mfma_f32_16x16x32_bf16 v[46:49], v[64:67], a[20:23], v[46:49]
    ds_read_b64 v[94:95], v165 offset:2760
    v_mfma_f32_16x16x32_bf16 v[46:49], a[8:11], v[68:71], v[46:49]
    buffer_load_dword v163, v168, s[52:55], s85 offen offset:2048 sc1
    v_mfma_f32_16x16x32_bf16 v[46:49], v[72:75], a[12:15], v[46:49]
    ds_read_b128 v[96:99], v164 offset:2560
    buffer_load_dwordx4 v149, s[52:55], s80 offen offset:2048 sc1 lds
    s_waitcnt lgkmcnt(6)
    v_mfma_f32_16x16x32_bf16 v[46:49], a[0:3], v[76:79], v[46:49]
    v_mfma_f32_16x16x32_bf16 v[46:49], v[80:83], a[4:7], v[46:49]
    s_waitcnt lgkmcnt(4)
    v_mfma_f32_16x16x32_bf16 v[26:29], a[32:35], v[84:87], v[26:29]
    ds_read_b64 v[100:101], v165 offset:3264
    v_mfma_f32_16x16x32_bf16 v[30:33], a[40:43], v[84:87], v[30:33]
    ds_read_b64 v[102:103], v165 offset:3272
    s_add_u32 m0, s81, 6144
    s_add_u32 s80, s32, 24576
    buffer_load_dwordx4 v149, s[52:55], s80 offen offset:0 sc1 lds
    v_mfma_f32_16x16x32_bf16 v[34:37], a[48:51], v[84:87], v[34:37]
    ds_read_b128 v[104:107], v164 offset:3072
    v_mfma_f32_16x16x32_bf16 v[38:41], a[56:59], v[84:87], 0
    s_waitcnt lgkmcnt(6)
    v_mfma_f32_16x16x32_bf16 v[26:29], v[88:91], a[36:39], v[26:29]
    ds_read_b64 v[108:109], v165 offset:3776
    v_mfma_f32_16x16x32_bf16 v[30:33], v[88:91], a[44:47], v[30:33]
    ds_read_b64 v[110:111], v165 offset:3784
    buffer_load_dwordx4 v149, s[52:55], s80 offen offset:2048 sc1 lds
    v_mfma_f32_16x16x32_bf16 v[34:37], v[88:91], a[52:55], v[34:37]
    ds_read_b128 v[112:115], v164 offset:3584
    v_mfma_f32_16x16x32_bf16 v[38:41], v[88:91], a[60:63], v[38:41]
    ds_read_b64 v[52:53], v165 offset:2176
    s_waitcnt lgkmcnt(7)
    v_mfma_f32_16x16x32_bf16 v[30:33], a[32:35], v[92:95], v[30:33]
    ds_read_b64 v[54:55], v165 offset:2184
    v_mfma_f32_16x16x32_bf16 v[34:37], a[40:43], v[92:95], v[34:37]
    s_add_u32 m0, s81, 10240
    s_add_u32 s80, s32, 28672
    buffer_load_dwordx4 v149, s[52:55], s80 offen offset:0 sc1 lds
    v_mfma_f32_16x16x32_bf16 v[38:41], a[48:51], v[92:95], v[38:41]
    ds_read_b128 v[56:59], v164 offset:2112
    v_mfma_f32_16x16x32_bf16 v[30:33], v[96:99], a[36:39], v[30:33]
    v_mfma_f32_16x16x32_bf16 v[34:37], v[96:99], a[44:47], v[34:37]
    v_mfma_f32_16x16x32_bf16 v[38:41], v[96:99], a[52:55], v[38:41]
    buffer_load_dwordx4 v149, s[52:55], s80 offen offset:2048 sc1 lds
    s_waitcnt lgkmcnt(6)
    v_mfma_f32_16x16x32_bf16 v[34:37], a[32:35], v[100:103], v[34:37]
    ds_read_b64 v[60:61], v165 offset:2688
    v_mfma_f32_16x16x32_bf16 v[38:41], a[40:43], v[100:103], v[38:41]
    s_nop 0
    ds_read_b64 v[62:63], v165 offset:2696
    v_mfma_f32_16x16x32_bf16 v[34:37], v[104:107], a[36:39], v[34:37]
    v_mfma_f32_16x16x32_bf16 v[38:41], v[104:107], a[44:47], v[38:41]
    ds_read_b128 v[64:67], v164 offset:2624
    s_add_u32 m0, s81, 14336
    s_add_u32 s80, s32, 32768
    buffer_load_dwordx4 v149, s[52:55], s80 offen offset:0 sc1 lds
    s_waitcnt lgkmcnt(6)
    v_mfma_f32_16x16x32_bf16 v[38:41], a[32:35], v[108:111], v[38:41]
    v_mfma_f32_16x16x32_bf16 v[38:41], v[112:115], a[36:39], v[38:41]
    s_mov_b32 s3, 131328
    buffer_load_dword v51, v178, s[52:55], s3 offen sc1
    s_waitcnt lgkmcnt(4)
    v_mfma_f32_16x16x32_bf16 v[26:29], a[64:67], v[52:55], v[26:29]
    ds_read_b64 v[68:69], v165 offset:3200
    buffer_load_dwordx4 v149, s[52:55], s80 offen offset:2048 sc1 lds
    v_mfma_f32_16x16x32_bf16 v[30:33], a[72:75], v[52:55], v[30:33]
    ds_read_b64 v[70:71], v165 offset:3208
    v_mfma_f32_16x16x32_bf16 v[34:37], a[80:83], v[52:55], v[34:37]
    ds_read_b128 v[72:75], v164 offset:3136
    v_mfma_f32_16x16x32_bf16 v[38:41], a[88:91], v[52:55], v[38:41]
    s_waitcnt lgkmcnt(6)
    v_mfma_f32_16x16x32_bf16 v[26:29], v[56:59], a[68:71], v[26:29]
    s_nop 0
    ds_read_b64 v[76:77], v165 offset:3712
    s_add_u32 m0, s81, 18432
    s_add_u32 s80, s32, 36864
    buffer_load_dwordx4 v149, s[52:55], s80 offen offset:0 sc1 lds
    v_mfma_f32_16x16x32_bf16 v[30:33], v[56:59], a[76:79], v[30:33]
    ds_read_b64 v[78:79], v165 offset:3720
    v_mfma_f32_16x16x32_bf16 v[34:37], v[56:59], a[84:87], v[34:37]
    ds_read_b128 v[80:83], v164 offset:3648
    v_mfma_f32_16x16x32_bf16 v[38:41], v[56:59], a[92:95], v[38:41]
    ds_read_b64 v[84:85], v167 offset:2048
    s_waitcnt lgkmcnt(7)
    v_mfma_f32_16x16x32_bf16 v[30:33], a[64:67], v[60:63], v[30:33]
    ds_read_b64 v[86:87], v167 offset:2056
    buffer_load_dwordx4 v149, s[52:55], s80 offen offset:2048 sc1 lds
    v_mfma_f32_16x16x32_bf16 v[34:37], a[72:75], v[60:63], v[34:37]
    ds_read_b128 v[88:91], v166 offset:2112
    v_mfma_f32_16x16x32_bf16 v[38:41], a[80:83], v[60:63], v[38:41]
    s_nop 0
    ds_read_b64 v[92:93], v167 offset:2560
    v_mfma_f32_16x16x32_bf16 v[30:33], v[64:67], a[68:71], v[30:33]
    ds_read_b64 v[94:95], v167 offset:2568
    v_mfma_f32_16x16x32_bf16 v[34:37], v[64:67], a[76:79], v[34:37]
    ds_read_b128 v[96:99], v166 offset:2624
    s_add_u32 m0, s81, 22528
    s_add_u32 s80, s32, 40960
    buffer_load_dwordx4 v149, s[52:55], s80 offen offset:0 sc1 lds
    v_mfma_f32_16x16x32_bf16 v[38:41], v[64:67], a[84:87], v[38:41]
    ds_read_b64 v[100:101], v167 offset:3072
    s_waitcnt lgkmcnt(10)
    v_mfma_f32_16x16x32_bf16 v[34:37], a[64:67], v[68:71], v[34:37]
    ds_read_b64 v[102:103], v167 offset:3080
    v_mfma_f32_16x16x32_bf16 v[38:41], a[72:75], v[68:71], v[38:41]
    ds_read_b128 v[104:107], v166 offset:3136
    v_mfma_f32_16x16x32_bf16 v[34:37], v[72:75], a[68:71], v[34:37]
    ds_read_b64 v[108:109], v167 offset:3584
    buffer_load_dwordx4 v149, s[52:55], s80 offen offset:2048 sc1 lds
    v_mfma_f32_16x16x32_bf16 v[38:41], v[72:75], a[76:79], v[38:41]
    ds_read_b64 v[110:111], v167 offset:3592
    s_waitcnt lgkmcnt(9)
    v_mfma_f32_16x16x32_bf16 v[38:41], a[64:67], v[76:79], v[38:41]
    ds_read_b128 v[112:115], v166 offset:3648
    v_mfma_f32_16x16x32_bf16 v[38:41], v[80:83], a[68:71], v[38:41]
    ds_read_b64 v[52:53], v165 offset:2112
    v_mfma_f32_16x16x32_bf16 v[42:45], a[96:99], v[84:87], v[42:45]
    ds_read_b64 v[54:55], v165 offset:2120
    s_add_u32 m0, s81, 26624
    s_add_u32 s80, s32, 45056
    buffer_load_dwordx4 v149, s[52:55], s80 offen offset:0 sc1 lds
    v_mfma_f32_16x16x32_bf16 v[46:49], a[120:123], v[84:87], v[46:49]
    ds_read_b128 v[56:59], v164 offset:2176
    s_waitcnt lgkmcnt(9)
    v_mfma_f32_16x16x32_bf16 v[42:45], v[88:91], a[100:103], v[42:45]
    v_mfma_f32_16x16x32_bf16 v[46:49], v[88:91], a[124:127], v[46:49]
    v_mfma_f32_16x16x32_bf16 v[46:49], a[112:115], v[92:95], v[46:49]
    ds_read_b64 v[60:61], v165 offset:2624
    s_waitcnt vmcnt(18)
    s_barrier
    s_cmp_lg_u32 s60, 0
    s_cbranch_scc1 L_pub_16
    s_mov_b64 exec, 15
    s_mov_b32 s3, 32768
    buffer_store_dword v174, v172, s[52:55], s3 offen sc1
    s_mov_b64 exec, -1
L_pub_16:
    v_mfma_f32_16x16x32_bf16 v[46:49], v[96:99], a[116:119], v[46:49]
    ds_read_b64 v[62:63], v165 offset:2632
    buffer_load_dwordx4 v149, s[52:55], s80 offen offset:2048 sc1 lds
    s_waitcnt lgkmcnt(6)
    v_mfma_f32_16x16x32_bf16 v[46:49], a[104:107], v[100:103], v[46:49]
    v_mfma_f32_16x16x32_bf16 v[46:49], v[104:107], a[108:111], v[46:49]
    ds_read_b128 v[64:67], v164 offset:2688
    s_add_u32 m0, s81, 30720
    s_add_u32 s80, s32, 49152
    buffer_load_dwordx4 v149, s[52:55], s80 offen offset:0 sc1 lds
    v_mfma_f32_16x16x32_bf16 v[46:49], a[96:99], v[108:111], v[46:49]
    s_waitcnt lgkmcnt(6)
    v_mfma_f32_16x16x32_bf16 v[46:49], v[112:115], a[100:103], v[46:49]
    s_waitcnt lgkmcnt(4)
    v_mfma_f32_16x16x32_bf16 v[26:29], a[128:131], v[52:55], v[26:29]
    ds_read_b64 v[68:69], v165 offset:3136
    v_mfma_f32_16x16x32_bf16 v[30:33], a[136:139], v[52:55], v[30:33]
    ds_read_b64 v[70:71], v165 offset:3144
    buffer_load_dwordx4 v149, s[52:55], s80 offen offset:2048 sc1 lds
    v_mfma_f32_16x16x32_bf16 v[34:37], a[144:147], v[52:55], v[34:37]
    ds_read_b128 v[72:75], v164 offset:3200
    v_mfma_f32_16x16x32_bf16 v[38:41], a[152:155], v[52:55], v[38:41]
    s_waitcnt lgkmcnt(6)
    v_mfma_f32_16x16x32_bf16 v[26:29], v[56:59], a[132:135], v[26:29]
    s_nop 0
    ds_read_b64 v[76:77], v165 offset:3648
    v_mfma_f32_16x16x32_bf16 v[30:33], v[56:59], a[140:143], v[30:33]
    ds_read_b64 v[78:79], v165 offset:3656
    s_add_u32 m0, s81, 34816
    s_add_u32 s80, s32, 53248
    buffer_load_dwordx4 v149, s[52:55], s80 offen offset:0 sc1 lds
    v_mfma_f32_16x16x32_bf16 v[34:37], v[56:59], a[148:151], v[34:37]
    ds_read_b128 v[80:83], v164 offset:3712
    v_mfma_f32_16x16x32_bf16 v[38:41], v[56:59], a[156:159], v[38:41]
    ds_read_b64 v[84:85], v165 offset:2048
    s_waitcnt lgkmcnt(7)
    v_mfma_f32_16x16x32_bf16 v[30:33], a[128:131], v[60:63], v[30:33]
    ds_read_b64 v[86:87], v165 offset:2056
    v_mfma_f32_16x16x32_bf16 v[34:37], a[136:139], v[60:63], v[34:37]
    buffer_load_dwordx4 v149, s[52:55], s80 offen offset:2048 sc1 lds
    v_mfma_f32_16x16x32_bf16 v[38:41], a[144:147], v[60:63], v[38:41]
    ds_read_b128 v[88:91], v164 offset:2240
    v_mfma_f32_16x16x32_bf16 v[30:33], v[64:67], a[132:135], v[30:33]
    v_mfma_f32_16x16x32_bf16 v[34:37], v[64:67], a[140:143], v[34:37]
    v_mfma_f32_16x16x32_bf16 v[38:41], v[64:67], a[148:151], v[38:41]
    s_add_u32 m0, s81, 38912
    s_add_u32 s80, s32, 57344
    buffer_load_dwordx4 v149, s[52:55], s80 offen offset:0 sc1 lds
    s_waitcnt lgkmcnt(6)
    v_mfma_f32_16x16x32_bf16 v[34:37], a[128:131], v[68:71], v[34:37]
    ds_read_b64 v[92:93], v165 offset:2560
    v_mfma_f32_16x16x32_bf16 v[38:41], a[136:139], v[68:71], v[38:41]
    ds_read_b64 v[94:95], v165 offset:2568
    s_waitcnt vmcnt(12)
    v_cmp_ne_u32 vcc, v174, v51
    s_nop 1
    s_cbranch_vccnz L_slow_17
L_back_18:
    v_mfma_f32_16x16x32_bf16 v[34:37], v[72:75], a[132:135], v[34:37]
    buffer_load_dwordx4 v149, s[52:55], s80 offen offset:2048 sc1 lds
    v_mfma_f32_16x16x32_bf16 v[38:41], v[72:75], a[140:143], v[38:41]
    ds_read_b128 v[96:99], v164 offset:2752
    s_waitcnt lgkmcnt(6)
    v_mfma_f32_16x16x32_bf16 v[38:41], a[128:131], v[76:79], v[38:41]
    v_mfma_f32_16x16x32_bf16 v[38:41], v[80:83], a[132:135], v[38:41]
    s_waitcnt lgkmcnt(4)
    v_mfma_f32_16x16x32_bf16 v[26:29], a[160:163], v[84:87], v[26:29]
    ds_read_b64 v[100:101], v165 offset:3072
    buffer_load_dword a240, v143, s[52:55], s14 offen sc1
    s_add_u32 s14, s14, 6144
    buffer_load_dword a241, v143, s[52:55], s14 offen sc1
    s_add_u32 s14, s14, 6144
    v_mfma_f32_16x16x32_bf16 v[30:33], a[168:171], v[84:87], v[30:33]
    ds_read_b64 v[102:103], v165 offset:3080
    buffer_load_dword a242, v143, s[52:55], s14 offen sc1
    s_add_u32 s14, s14, 6144
    buffer_load_dword a243, v143, s[52:55], s14 offen sc1
    s_add_u32 s14, s14, 6144
    v_mfma_f32_16x16x32_bf16 v[34:37], a[176:179], v[84:87], v[34:37]
    ds_read_b128 v[104:107], v164 offset:3264
    v_mfma_f32_16x16x32_bf16 v[38:41], a[184:187], v[84:87], v[38:41]
    buffer_load_dword a244, v143, s[52:55], s14 offen sc1
    s_add_u32 s14, s14, 6144
    buffer_load_dword a245, v143, s[52:55], s14 offen sc1
    s_add_u32 s14, s14, 6144
    s_waitcnt lgkmcnt(6)
    s_nop 0
    v_mfma_f32_16x16x32_bf16 v[26:29], v[88:91], a[164:167], v[26:29]
    ds_read_b64 v[108:109], v165 offset:3584
    buffer_load_dword a246, v143, s[52:55], s14 offen sc1
    s_add_u32 s14, s14, 6144
    buffer_load_dword a247, v143, s[52:55], s14 offen sc1
    s_add_u32 s14, s14, 6144
    v_mfma_f32_16x16x32_bf16 v[30:33], v[88:91], a[172:175], v[30:33]
    ds_read_b64 v[110:111], v165 offset:3592
    v_mfma_f32_16x16x32_bf16 v[34:37], v[88:91], a[180:183], v[34:37]
    ds_read_b128 v[112:115], v164 offset:3776
    buffer_load_dword a248, v143, s[52:55], s14 offen sc1
    s_add_u32 s14, s14, 6144
    buffer_load_dword a249, v143, s[52:55], s14 offen sc1
    s_add_u32 s14, s14, 6144
    v_mfma_f32_16x16x32_bf16 v[38:41], v[88:91], a[188:191], v[38:41]
    s_waitcnt lgkmcnt(6)
    v_mfma_f32_16x16x32_bf16 v[30:33], a[160:163], v[92:95], v[30:33]
    global_load_ushort a250, v141, s[26:27]
    v_mfma_f32_16x16x32_bf16 v[34:37], a[168:171], v[92:95], v[34:37]
    buffer_load_dwordx4 a[192:195], v183, s[52:55], s83 offen offset:0 sc1
    v_mfma_f32_16x16x32_bf16 v[38:41], a[176:179], v[92:95], v[38:41]
    v_mfma_f32_16x16x32_bf16 v[30:33], v[96:99], a[164:167], v[30:33]
    v_mfma_f32_16x16x32_bf16 v[34:37], v[96:99], a[172:175], v[34:37]
    v_mfma_f32_16x16x32_bf16 v[38:41], v[96:99], a[180:183], v[38:41]
    buffer_load_dwordx4 a[196:199], v183, s[52:55], s83 offen offset:1024 sc1
    s_waitcnt lgkmcnt(4)
    v_mfma_f32_16x16x32_bf16 v[34:37], a[160:163], v[100:103], v[34:37]
    v_mfma_f32_16x16x32_bf16 v[38:41], a[168:171], v[100:103], v[38:41]
    s_waitcnt lgkmcnt(3)
    v_mfma_f32_16x16x32_bf16 v[34:37], v[104:107], a[164:167], v[34:37]
    v_mfma_f32_16x16x32_bf16 v[38:41], v[104:107], a[172:175], v[38:41]
    buffer_load_dwordx4 a[200:203], v182, s[52:55], s83 offen offset:0 sc1
    s_waitcnt lgkmcnt(1)
    v_mfma_f32_16x16x32_bf16 v[38:41], a[160:163], v[108:111], v[38:41]
    s_waitcnt lgkmcnt(0)
    v_mfma_f32_16x16x32_bf16 v[38:41], v[112:115], a[164:167], v[38:41]
    ds_write_b128 v170, v[42:45] offset:2048
    ds_write_b128 v170, v[46:49] offset:3072
    ds_write2_b64 v170, v[28:29], v[32:33] offset0:0 offset1:1
    s_nop 4
    ds_write2_b64 v170, v[36:37], v[40:41] offset0:128 offset1:129
    v_lshlrev_b32 v150, 16, v159
    buffer_load_dwordx4 a[204:207], v182, s[52:55], s83 offen offset:1024 sc1
    v_and_b32 v151, 0xffff0000, v159
    v_add_f32 v26, v26, v150
    v_add_f32 v27, v27, v151
    v_lshlrev_b32 v150, 16, v160
    v_and_b32 v151, 0xffff0000, v160
    v_add_f32 v30, v30, v150
    v_add_f32 v31, v31, v151
    buffer_load_dwordx4 a[208:211], v142, s[52:55], s83 offen offset:0 sc1
    v_lshlrev_b32 v150, 16, v161
    v_and_b32 v151, 0xffff0000, v161
    v_add_f32 v34, v34, v150
    v_add_f32 v35, v35, v151
    v_lshlrev_b32 v150, 16, v162
    v_and_b32 v151, 0xffff0000, v162
    v_add_f32 v38, v38, v150
    v_add_f32 v39, v39, v151
    v_lshlrev_b32 v152, 16, v163
    v_and_b32 v153, 0xffff0000, v163
    s_waitcnt lgkmcnt(0)
    s_barrier
    s_nop 0
    s_add_u32 s83, s83, 5120
    buffer_load_dwordx4 a[212:215], v183, s[52:55], s83 offen offset:0 sc1
    ds_read_b128 v[116:119], v171
    ds_read_b128 v[120:123], v171 offset:1024
    ds_read2st64_b64 v[124:127], v148 offset0:4 offset1:12
    ds_read2st64_b64 v[128:131], v148 offset0:20 offset1:28
    s_waitcnt lgkmcnt(2)
    v_add_f32 v26, v26, v116
    v_add_f32 v27, v27, v117
    v_cvt_pk_bf16_f32 v28, v26, v27
    buffer_load_dwordx4 a[216:219], v183, s[52:55], s83 offen offset:1024 sc1
    buffer_store_dword v28, v169, s[52:55], s88 offen sc1
    s_add_u32 s88, s88, 327680
    v_add_f32 v30, v30, v118
    v_add_f32 v31, v31, v119
    v_cvt_pk_bf16_f32 v32, v30, v31
    buffer_store_dword v32, v169, s[52:55], s88 offen sc1
    s_add_u32 s88, s88, 327680
    buffer_load_dwordx4 a[220:223], v182, s[52:55], s83 offen offset:0 sc1
    v_add_f32 v34, v34, v120
    v_add_f32 v35, v35, v121
    v_cvt_pk_bf16_f32 v36, v34, v35
    buffer_store_dword v36, v169, s[52:55], s88 offen sc1
    s_add_u32 s88, s88, 327680
    v_add_f32 v38, v38, v122
    v_add_f32 v39, v39, v123
    v_cvt_pk_bf16_f32 v40, v38, v39
    buffer_load_dwordx4 a[224:227], v182, s[52:55], s83 offen offset:1024 sc1
    buffer_store_dword v40, v169, s[52:55], s88 offen sc1
    s_add_u32 s88, s88, 327680
    s_waitcnt lgkmcnt(0)
    v_add_f32 v152, v152, v124
    v_add_f32 v153, v153, v125
    v_add_f32 v152, v152, v126
    v_add_f32 v153, v153, v127
    v_add_f32 v152, v152, v128
    v_add_f32 v153, v153, v129
    v_add_f32 v152, v152, v130
    buffer_load_dwordx4 a[228:231], v142, s[52:55], s83 offen offset:0 sc1
    v_add_f32 v153, v153, v131
    v_cvt_pk_bf16_f32 v152, v152, v153
    buffer_store_dword v152, v169, s[52:55], s89 offen sc1
    s_add_u32 s89, s89, 1310720
    s_mov_b32 s3, 32768
    buffer_load_dword v51, v173, s[52:55], s3 offen sc1
    s_add_u32 s83, s83, 5120
    buffer_load_dwordx4 a[232:235], v183, s[52:55], s83 offen offset:0 sc1
    buffer_load_dwordx4 a[236:239], v183, s[52:55], s83 offen offset:1024 sc1
    buffer_load_dwordx4 a[0:3], v182, s[52:55], s83 offen offset:0 sc1
    buffer_load_dwordx4 a[4:7], v182, s[52:55], s83 offen offset:1024 sc1
    buffer_load_dwordx4 a[8:11], v142, s[52:55], s83 offen offset:0 sc1
    s_add_u32 s83, s83, 5120
    buffer_load_dwordx4 a[12:15], v183, s[52:55], s83 offen offset:0 sc1
    buffer_load_dwordx4 a[16:19], v183, s[52:55], s83 offen offset:1024 sc1
    buffer_load_dwordx4 a[20:23], v182, s[52:55], s83 offen offset:0 sc1
    s_waitcnt vmcnt(8)
    v_cmp_ne_u32 vcc, v174, v51
    s_nop 1
    s_cbranch_vccnz L_slow_19
L_back_20:
    s_barrier
    s_add_u32 m0, s8, 0
    s_nop 0
    s_nop 0
    buffer_load_dwordx4 v176, s[52:55], s16 offen offset:0 sc1 lds
    buffer_load_dwordx4 v176, s[52:55], s16 offen offset:1024 sc1 lds
    buffer_load_dwordx4 v176, s[52:55], s16 offen offset:2048 sc1 lds
    buffer_load_dwordx4 v176, s[52:55], s16 offen offset:3072 sc1 lds
    s_add_u32 m0, s8, 1024
    s_nop 0
    buffer_load_dwordx4 v139, s[52:55], s16 offen offset:3072 sc1 lds
    s_add_u32 m0, s8, 5120
    s_nop 0
    buffer_load_dwordx4 v176, s[52:55], s17 offen offset:0 sc1 lds
    buffer_load_dwordx4 v176, s[52:55], s17 offen offset:1024 sc1 lds
    buffer_load_dwordx4 v176, s[52:55], s17 offen offset:2048 sc1 lds
L_conv_done:
    s_waitcnt vmcnt(6)
    ds_read_b64_tr_b16 v[52:53], v132 offset:0
    ds_read_b64_tr_b16 v[54:55], v132 offset:256
    ds_read_b64_tr_b16 v[56:57], v132 offset:1024
    ds_read_b64_tr_b16 v[58:59], v132 offset:1280
    s_waitcnt lgkmcnt(0)
    v_mfma_f32_32x32x16_bf16 v[2:17], v[184:187], v[52:55], 0
    s_waitcnt vmcnt(4)
    ds_read_b64_tr_b16 v[60:61], v132 offset:2048
    ds_read_b64_tr_b16 v[62:63], v132 offset:2304
    s_add_u32 m0, s8, 5120
    s_nop 0
    buffer_load_dwordx4 v176, s[52:55], s17 offen offset:3072 sc1 lds
    v_mfma_f32_32x32x16_bf16 v[18:33], v[188:191], v[52:55], 0
    ds_read_b64_tr_b16 v[64:65], v132 offset:3072
    ds_read_b64_tr_b16 v[66:67], v132 offset:3328
    v_mfma_f32_32x32x16_bf16 v[34:49], v[192:195], v[52:55], 0
    s_add_u32 m0, s8, 6144
    s_nop 0
    buffer_load_dwordx4 v139, s[52:55], s17 offen offset:3072 sc1 lds
    v_mfma_f32_32x32x16_bf16 v[2:17], v[196:199], v[56:59], v[2:17]
    v_mfma_f32_32x32x16_bf16 v[18:33], v[200:203], v[56:59], v[18:33]
    s_waitcnt vmcnt(4)
    ds_read_b64_tr_b16 v[68:69], v132 offset:4096
    ds_read_b64_tr_b16 v[70:71], v132 offset:4352
    s_waitcnt lgkmcnt(2)
    s_add_u32 m0, s8, 10240
    s_nop 0
    buffer_load_dwordx4 v176, s[52:55], s18 offen offset:0 sc1 lds
    v_mfma_f32_32x32x16_bf16 v[34:49], v[204:207], v[56:59], v[34:49]
    ds_read_b64_tr_b16 v[72:73], v132 offset:5120
    ds_read_b64_tr_b16 v[74:75], v132 offset:5376
    v_mfma_f32_32x32x16_bf16 v[2:17], v[208:211], v[60:63], v[2:17]
    buffer_load_dwordx4 v176, s[52:55], s18 offen offset:1024 sc1 lds
    v_mfma_f32_32x32x16_bf16 v[18:33], v[212:215], v[60:63], v[18:33]
    v_mfma_f32_32x32x16_bf16 v[34:49], v[216:219], v[60:63], v[34:49]
    s_waitcnt lgkmcnt(0)
    s_cmp_lg_u32 s33, 0
    s_cbranch_scc1 L_st_21
    s_nop 0
    s_mov_b32 s3, 0x3f803f80
    v_dot2_f32_bf16 v127, v52, v52, 0
    v_dot2_f32_bf16 v126, v52, s3, 0
    v_dot2_f32_bf16 v127, v53, v53, v127
    v_dot2_f32_bf16 v126, v53, s3, v126
    v_dot2_f32_bf16 v127, v54, v54, v127
    v_dot2_f32_bf16 v126, v54, s3, v126
    v_dot2_f32_bf16 v127, v55, v55, v127
    v_dot2_f32_bf16 v126, v55, s3, v126
    v_dot2_f32_bf16 v127, v56, v56, v127
    v_dot2_f32_bf16 v126, v56, s3, v126
    v_dot2_f32_bf16 v127, v57, v57, v127
    v_dot2_f32_bf16 v126, v57, s3, v126
    v_dot2_f32_bf16 v127, v58, v58, v127
    v_dot2_f32_bf16 v126, v58, s3, v126
    v_dot2_f32_bf16 v127, v59, v59, v127
    v_dot2_f32_bf16 v126, v59, s3, v126
    v_dot2_f32_bf16 v127, v60, v60, v127
    v_dot2_f32_bf16 v126, v60, s3, v126
    v_dot2_f32_bf16 v127, v61, v61, v127
    v_dot2_f32_bf16 v126, v61, s3, v126
    v_dot2_f32_bf16 v127, v62, v62, v127
    v_dot2_f32_bf16 v126, v62, s3, v126
    v_dot2_f32_bf16 v127, v63, v63, v127
    v_dot2_f32_bf16 v126, v63, s3, v126
    v_dot2_f32_bf16 v127, v64, v64, v127
    v_dot2_f32_bf16 v126, v64, s3, v126
    v_dot2_f32_bf16 v127, v65, v65, v127
    v_dot2_f32_bf16 v126, v65, s3, v126
    v_dot2_f32_bf16 v127, v66, v66, v127
    v_dot2_f32_bf16 v126, v66, s3, v126
    v_dot2_f32_bf16 v127, v67, v67, v127
    v_dot2_f32_bf16 v126, v67, s3, v126
    v_dot2_f32_bf16 v127, v68, v68, v127
    v_dot2_f32_bf16 v126, v68, s3, v126
    v_dot2_f32_bf16 v127, v69, v69, v127
    v_dot2_f32_bf16 v126, v69, s3, v126
    v_dot2_f32_bf16 v127, v70, v70, v127
    v_dot2_f32_bf16 v126, v70, s3, v126
    v_dot2_f32_bf16 v127, v71, v71, v127
    v_dot2_f32_bf16 v126, v71, s3, v126
    s_nop 2
    v_permlane32_swap_b32 v126, v127
    v_add_f32 v126, v126, v127
    v_or_b32 v126, 1, v126
L_st_21:
    buffer_store_dword v126, v180, s[52:55], s9 offen sc1
    s_add_u32 s9, s9, 65536
    v_mfma_f32_32x32x16_bf16 v[2:17], v[220:223], v[64:67], v[2:17]
    s_barrier
    s_cmp_lg_u32 s60, 0
    s_cbranch_scc1 L_pub_22
    s_mov_b64 exec, 15
    s_mov_b32 s3, 36864
    buffer_store_dword v174, v172, s[52:55], s3 offen sc1
    s_mov_b64 exec, -1
L_pub_22:
    v_mfma_f32_32x32x16_bf16 v[18:33], v[224:227], v[64:67], v[18:33]
    s_waitcnt vmcnt(5)
    ds_read_b64_tr_b16 v[76:77], v132 offset:6144
    ds_read_b64_tr_b16 v[78:79], v132 offset:6400
    s_add_u32 m0, s8, 4294965248
    s_nop 0
    buffer_load_dwordx4 v176, s[52:55], s18 offen offset:2048 sc1 lds
    v_mfma_f32_32x32x16_bf16 v[34:49], v[228:231], v[64:67], v[34:49]
    ds_read_b64_tr_b16 v[80:81], v132 offset:7168
    ds_read_b64_tr_b16 v[82:83], v132 offset:7424
    v_mfma_f32_32x32x16_bf16 v[2:17], v[232:235], v[68:71], v[2:17]
    s_barrier
    ds_read_b128 v[84:87], v181 offset:0
    buffer_load_dwordx4 v176, s[52:55], s18 offen offset:3072 sc1 lds
    v_mfma_f32_32x32x16_bf16 v[18:33], v[236:239], v[68:71], v[18:33]
    ds_read_b128 v[88:91], v181 offset:1024
    v_mfma_f32_32x32x16_bf16 v[34:49], v[240:243], v[68:71], v[34:49]
    ds_read_b128 v[92:95], v181 offset:2048
    s_add_u32 m0, s8, 4294966272
    s_nop 0
    buffer_load_dwordx4 v139, s[52:55], s18 offen offset:3072 sc1 lds
    v_mfma_f32_32x32x16_bf16 v[2:17], v[244:247], v[72:75], v[2:17]
    ds_read_b128 v[96:99], v181 offset:3072
    s_waitcnt lgkmcnt(4)
    v_mfma_f32_32x32x16_bf16 v[18:33], v[248:251], v[72:75], v[18:33]
    ds_read_b128 v[100:103], v181 offset:4096
    s_waitcnt vmcnt(6)
    ds_read_b64_tr_b16 v[52:53], v132 offset:8192
    ds_read_b64_tr_b16 v[54:55], v132 offset:8448
    s_add_u32 m0, s8, 3072
    s_nop 0
    buffer_load_dwordx4 v176, s[52:55], s19 offen offset:0 sc1 lds
    v_mfma_f32_32x32x16_bf16 v[34:49], v[252:255], v[72:75], v[34:49]
    ds_read_b128 v[104:107], v181 offset:5120
    ds_read_b64_tr_b16 v[56:57], v132 offset:9216
    ds_read_b64_tr_b16 v[58:59], v132 offset:9472
    s_waitcnt lgkmcnt(9)
    v_mfma_f32_32x32x16_bf16 v[2:17], v[84:87], v[76:79], v[2:17]
    ds_read_b128 v[108:111], v181 offset:6144
    buffer_load_dwordx4 v176, s[52:55], s19 offen offset:1024 sc1 lds
    s_waitcnt lgkmcnt(9)
    v_mfma_f32_32x32x16_bf16 v[18:33], v[88:91], v[76:79], v[18:33]
    ds_read_b128 v[112:115], v181 offset:7168
    s_waitcnt lgkmcnt(9)
    s_nop 0
    v_mfma_f32_32x32x16_bf16 v[34:49], v[92:95], v[76:79], v[34:49]
    ds_read_b128 v[84:87], v181 offset:8192
    buffer_load_dwordx4 v176, s[52:55], s19 offen offset:2048 sc1 lds
    v_accvgpr_read_b32 v144, a240
    v_accvgpr_read_b32 v145, a241
    s_waitcnt lgkmcnt(9)
    v_mfma_f32_32x32x16_bf16 v[2:17], v[96:99], v[80:83], v[2:17]
    ds_read_b128 v[88:91], v181 offset:9216
    v_add_f32 v144, v144, v145
    v_accvgpr_read_b32 v145, a242
    v_add_f32 v144, v144, v145
    v_accvgpr_read_b32 v145, a243
    s_waitcnt lgkmcnt(9)
    v_mfma_f32_32x32x16_bf16 v[18:33], v[100:103], v[80:83], v[18:33]
    ds_read_b128 v[92:95], v181 offset:10240
    s_waitcnt vmcnt(7)
    ds_read_b64_tr_b16 v[60:61], v132 offset:10240
    ds_read_b64_tr_b16 v[62:63], v132 offset:10496
    s_waitcnt lgkmcnt(7)
    v_mfma_f32_32x32x16_bf16 v[34:49], v[104:107], v[80:83], v[34:49]
    ds_read_b128 v[96:99], v181 offset:11264
    ds_read_b64_tr_b16 v[64:65], v132 offset:11264
    ds_read_b64_tr_b16 v[66:67], v132 offset:11520
    buffer_load_dwordx4 v176, s[52:55], s19 offen offset:3072 sc1 lds
    v_add_f32 v144, v144, v145
    s_waitcnt lgkmcnt(9)
    v_mfma_f32_32x32x16_bf16 v[2:17], v[108:111], v[52:55], v[2:17]
    ds_read_b128 v[100:103], v181 offset:12288
    v_accvgpr_read_b32 v145, a244
    v_add_f32 v144, v144, v145
    v_accvgpr_read_b32 v145, a245
    v_add_f32 v144, v144, v145
    s_waitcnt lgkmcnt(9)
    v_mfma_f32_32x32x16_bf16 v[18:33], v[112:115], v[52:55], v[18:33]
    ds_read_b128 v[104:107], v181 offset:13312
    s_add_u32 m0, s8, 4096
    s_nop 0
    buffer_load_dwordx4 v139, s[52:55], s19 offen offset:3072 sc1 lds
    v_accvgpr_read_b32 v145, a246
    v_add_f32 v144, v144, v145
    s_waitcnt lgkmcnt(9)
    v_mfma_f32_32x32x16_bf16 v[34:49], v[84:87], v[52:55], v[34:49]
    ds_read_b128 v[108:111], v181 offset:14336
    v_accvgpr_read_b32 v145, a247
    v_add_f32 v144, v144, v145
    v_accvgpr_read_b32 v145, a248
    v_add_f32 v144, v144, v145
    s_waitcnt lgkmcnt(9)
    s_nop 0
    v_mfma_f32_32x32x16_bf16 v[2:17], v[88:91], v[56:59], v[2:17]
    ds_read_b128 v[112:115], v181 offset:15360
    s_add_u32 s3, s86, 3145728
    buffer_store_dwordx4 a[252:255], v138, s[52:55], s3 offen sc1
    v_accvgpr_read_b32 v145, a249
    v_add_f32 v144, v144, v145
    s_waitcnt lgkmcnt(9)
    v_mfma_f32_32x32x16_bf16 v[18:33], v[92:95], v[56:59], v[18:33]
    ds_read_b128 v[84:87], v181 offset:16384
    s_waitcnt vmcnt(7)
    ds_read_b64_tr_b16 v[68:69], v132 offset:0
    ds_read_b64_tr_b16 v[70:71], v132 offset:256
    s_waitcnt lgkmcnt(7)
    v_mfma_f32_32x32x16_bf16 v[34:49], v[96:99], v[56:59], v[34:49]
    ds_read_b128 v[88:91], v181 offset:17408
    ds_read_b64_tr_b16 v[72:73], v132 offset:1024
    ds_read_b64_tr_b16 v[74:75], v132 offset:1280
    s_add_u32 s3, s86, 3147776
    buffer_store_dwordx4 a[252:255], v138, s[52:55], s3 offen sc1
    s_waitcnt lgkmcnt(9)
    s_nop 0
    v_mfma_f32_32x32x16_bf16 v[2:17], v[100:103], v[60:63], v[2:17]
    ds_read_b128 v[92:95], v181 offset:18432
    s_add_u32 s3, s86, 3149824
    buffer_store_dwordx4 a[252:255], v138, s[52:55], s3 offen sc1
    v_accvgpr_read_b32 v145, a250
    v_lshlrev_b32 v145, 16, v145
    s_waitcnt lgkmcnt(9)
    v_mfma_f32_32x32x16_bf16 v[18:33], v[104:107], v[60:63], v[18:33]
    ds_read_b128 v[96:99], v181 offset:19456
    v_add_u32 v143, 74176, v143
    ds_write2st64_b32 v143, v144, v145 offset0:0 offset1:2
    s_waitcnt lgkmcnt(10)
    v_mfma_f32_32x32x16_bf16 v[34:49], v[108:111], v[60:63], v[34:49]
    ds_read_b128 v[100:103], v181 offset:20480
    buffer_load_dwordx4 a[24:27], v182, s[52:55], s83 offen offset:1024 sc1
    s_waitcnt lgkmcnt(10)
    v_mfma_f32_32x32x16_bf16 v[2:17], v[112:115], v[64:67], v[2:17]
    ds_read_b128 v[104:107], v181 offset:21504
    s_waitcnt lgkmcnt(5)
    v_mfma_f32_32x32x16_bf16 v[18:33], v[84:87], v[64:67], v[18:33]
    ds_read_b128 v[108:111], v181 offset:22528
    s_waitcnt vmcnt(8)
    ds_read_b64_tr_b16 v[76:77], v132 offset:2048
    ds_read_b64_tr_b16 v[78:79], v132 offset:2304
    buffer_load_dwordx4 a[28:31], v142, s[52:55], s83 offen offset:0 sc1
    v_mfma_f32_32x32x16_bf16 v[34:49], v[88:91], v[64:67], v[34:49]
    ds_read_b128 v[112:115], v181 offset:23552
    ds_read_b64_tr_b16 v[80:81], v132 offset:3072
    ds_read_b64_tr_b16 v[82:83], v132 offset:3328
    buffer_load_dword v116, v180, s[52:55], s39 offen offset:0 sc1
    s_waitcnt lgkmcnt(10)
    s_nop 0
    v_mfma_f32_32x32x16_bf16 v[2:17], v[92:95], v[68:71], v[2:17]
    ds_read_b128 v[84:87], v181 offset:24576
    s_add_u32 s83, s83, 5120
    buffer_load_dwordx4 a[32:35], v183, s[52:55], s83 offen offset:0 sc1
    buffer_load_dword v117, v180, s[52:55], s39 offen offset:256 sc1
    s_waitcnt lgkmcnt(10)
    v_mfma_f32_32x32x16_bf16 v[18:33], v[96:99], v[68:71], v[18:33]
    ds_read_b128 v[88:91], v181 offset:25600
    buffer_load_dword v118, v180, s[52:55], s39 offen offset:512 sc1
    s_waitcnt lgkmcnt(9)
    v_mfma_f32_32x32x16_bf16 v[34:49], v[100:103], v[68:71], v[34:49]
    ds_read_b128 v[92:95], v181 offset:26624
    buffer_load_dwordx4 a[36:39], v183, s[52:55], s83 offen offset:1024 sc1
    buffer_load_dword v119, v180, s[52:55], s39 offen offset:768 sc1
    s_waitcnt lgkmcnt(9)
    v_mfma_f32_32x32x16_bf16 v[2:17], v[104:107], v[72:75], v[2:17]
    ds_read_b128 v[96:99], v181 offset:27648
    buffer_load_dword v120, v180, s[52:55], s39 offen offset:1024 sc1
    s_waitcnt lgkmcnt(9)
    v_mfma_f32_32x32x16_bf16 v[18:33], v[108:111], v[72:75], v[18:33]
    ds_read_b128 v[100:103], v181 offset:28672
    s_waitcnt vmcnt(14)
    ds_read_b64_tr_b16 v[52:53], v132 offset:4096
    ds_read_b64_tr_b16 v[54:55], v132 offset:4352
    s_waitcnt lgkmcnt(7)
    v_mfma_f32_32x32x16_bf16 v[34:49], v[112:115], v[72:75], v[34:49]
    ds_read_b128 v[104:107], v181 offset:29696
    ds_read_b64_tr_b16 v[56:57], v132 offset:5120
    ds_read_b64_tr_b16 v[58:59], v132 offset:5376
    buffer_load_dwordx4 a[40:43], v182, s[52:55], s83 offen offset:0 sc1
    buffer_load_dword v121, v180, s[52:55], s39 offen offset:1280 sc1
    s_waitcnt lgkmcnt(9)
    v_mfma_f32_32x32x16_bf16 v[2:17], v[84:87], v[76:79], v[2:17]
    s_barrier
    ds_read_b128 v[108:111], v181 offset:30720
    s_mov_b32 s3, 36864
    buffer_load_dword v51, v173, s[52:55], s3 offen sc1
    s_waitcnt lgkmcnt(9)
    v_mfma_f32_32x32x16_bf16 v[18:33], v[88:91], v[76:79], v[18:33]
    ds_read_b128 v[112:115], v181 offset:31744
    buffer_load_dwordx4 a[44:47], v182, s[52:55], s83 offen offset:1024 sc1
    buffer_load_dword v122, v180, s[52:55], s39 offen offset:1536 sc1
    s_waitcnt lgkmcnt(9)
    v_mfma_f32_32x32x16_bf16 v[34:49], v[92:95], v[76:79], v[34:49]
    ds_read_b128 v[84:87], v181 offset:32768
    s_waitcnt vmcnt(17)
    ds_read_b64_tr_b16 v[60:61], v132 offset:6144
    ds_read_b64_tr_b16 v[62:63], v132 offset:6400
    buffer_load_dwordx4 a[48:51], v142, s[52:55], s83 offen offset:0 sc1
    s_waitcnt lgkmcnt(11)
    v_mfma_f32_32x32x16_bf16 v[2:17], v[96:99], v[80:83], v[2:17]
    ds_read_b128 v[88:91], v181 offset:33792
    ds_read_b64_tr_b16 v[64:65], v132 offset:7168
    ds_read_b64_tr_b16 v[66:67], v132 offset:7424
    s_waitcnt lgkmcnt(8)
    s_nop 0
    buffer_load_dword v123, v180, s[52:55], s39 offen offset:1792 sc1
    v_mfma_f32_32x32x16_bf16 v[18:33], v[100:103], v[80:83], v[18:33]
    ds_read_b128 v[92:95], v181 offset:36864
    s_add_u32 s83, s83, 5120
    buffer_load_dwordx4 a[52:55], v183, s[52:55], s83 offen offset:0 sc1
    v_mfma_f32_32x32x16_bf16 v[34:49], v[104:107], v[80:83], v[34:49]
    ds_read_b128 v[96:99], v181 offset:39936
    s_waitcnt lgkmcnt(9)
    v_mfma_f32_32x32x16_bf16 v[2:17], v[108:111], v[52:55], v[2:17]
    ds_read_b128 v[100:103], v181 offset:34816
    buffer_load_dwordx4 a[56:59], v183, s[52:55], s83 offen offset:1024 sc1
    s_waitcnt lgkmcnt(9)
    v_mfma_f32_32x32x16_bf16 v[18:33], v[112:115], v[52:55], v[18:33]
    ds_read_b128 v[104:107], v181 offset:37888
    s_waitcnt lgkmcnt(9)
    v_mfma_f32_32x32x16_bf16 v[34:49], v[84:87], v[52:55], v[34:49]
    ds_read_b128 v[108:111], v181 offset:40960
    s_waitcnt lgkmcnt(5)
    buffer_load_dwordx4 a[60:63], v182, s[52:55], s83 offen offset:0 sc1
    v_mfma_f32_32x32x16_bf16 v[2:17], v[88:91], v[56:59], v[2:17]
    ds_read_b128 v[112:115], v181 offset:35840
    s_waitcnt lgkmcnt(5)
    v_mfma_f32_32x32x16_bf16 v[2:17], v[92:95], v[60:63], v[2:17]
    ds_read_b128 v[84:87], v181 offset:38912
    buffer_load_dwordx4 a[64:67], v182, s[52:55], s83 offen offset:1024 sc1
    s_waitcnt lgkmcnt(5)
    v_mfma_f32_32x32x16_bf16 v[2:17], v[96:99], v[64:67], v[2:17]
    ds_read_b128 v[88:91], v181 offset:41984
    s_waitcnt lgkmcnt(5)
    v_mfma_f32_32x32x16_bf16 v[18:33], v[100:103], v[56:59], v[18:33]
    s_waitcnt lgkmcnt(4)
    v_mfma_f32_32x32x16_bf16 v[18:33], v[104:107], v[60:63], v[18:33]
    s_nop 6
    ds_write_b128 v133, v[10:13] offset:0
    buffer_load_dwordx4 a[68:71], v142, s[52:55], s83 offen offset:0 sc1
    s_waitcnt lgkmcnt(4)
    v_mfma_f32_32x32x16_bf16 v[18:33], v[108:111], v[64:67], v[18:33]
    ds_write_b128 v133, v[14:17] offset:1024
    s_add_u32 s83, s83, 5120
    buffer_load_dwordx4 a[72:75], v183, s[52:55], s83 offen offset:0 sc1
    s_waitcnt lgkmcnt(4)
    v_mfma_f32_32x32x16_bf16 v[34:49], v[112:115], v[56:59], v[34:49]
    s_waitcnt lgkmcnt(3)
    v_mfma_f32_32x32x16_bf16 v[34:49], v[84:87], v[60:63], v[34:49]
    s_nop 4
    ds_write_b128 v133, v[26:29] offset:2048
    buffer_load_dwordx4 a[76:79], v183, s[52:55], s83 offen offset:1024 sc1
    s_waitcnt lgkmcnt(3)
    v_mfma_f32_32x32x16_bf16 v[34:49], v[88:91], v[64:67], v[34:49]
    ds_write_b128 v133, v[30:33] offset:3072
    ds_read_b128 v[68:71], v137 offset:0
    ds_read_b128 v[92:95], v137 offset:512
    ds_read_b128 v[72:75], v137 offset:32
    ds_read_b128 v[96:99], v137 offset:544
    ds_read_b128 v[76:79], v137 offset:128
    ds_read_b128 v[100:103], v137 offset:640
    ds_read_b128 v[80:83], v137 offset:160
    ds_read_b128 v[104:107], v137 offset:672
    ds_read_b128 v[84:87], v137 offset:256
    ds_read_b128 v[108:111], v137 offset:768
    ds_read_b128 v[88:91], v137 offset:288
    ds_read_b128 v[112:115], v137 offset:800
    ds_write_b128 v133, v[42:45] offset:4096
    ds_write_b128 v133, v[46:49] offset:5120
    s_waitcnt vmcnt(7)
    v_and_b32 v126, v116, v117
    v_bitop3_b32 v126, v126, v118, v119 bitop3:0x80
    v_bitop3_b32 v126, v126, v120, v121 bitop3:0x80
    v_bitop3_b32 v126, v126, v122, v123 bitop3:0x80
    v_and_b32 v126, 1, v126
    v_cmp_eq_u32 vcc, 0, v126
    s_nop 1
    s_cbranch_vccnz L_slow_23
L_back_24:
    v_add_f32 v116, v116, v117
    v_add_f32 v116, v116, v118
    v_add_f32 v116, v116, v119
    v_add_f32 v116, v116, v120
    v_add_f32 v116, v116, v121
    v_add_f32 v116, v116, v122
    v_add_f32 v116, v116, v123
    v_mov_b32 v117, v116
    v_mov_b32 v126, 0x3727c5ac
    s_nop 0
    v_permlane32_swap_b32 v116, v117
    v_mul_f32 v124, 0x3acccccd, v116
    v_fmac_f32 v126, 0x3acccccd, v117
    v_fma_f32 v126, -v124, v124, v126
    v_rsq_f32 v128, v126
    s_nop 0
    v_mul_f32 v126, v126, v128
    v_mul_f32 v130, v128, v128
    v_mul_f32 v130, v130, v128
    v_mul_f32 v130, 0xbdd2d3e8, v130
    v_mul_f32 v128, 0xc0135761, v128
    s_add_u32 s39, s39, 65536
    v_cmp_ne_u32 vcc, v174, v51
    s_nop 1
    s_cbranch_vccnz L_slow_25
L_back_26:
    s_waitcnt lgkmcnt(0)
    s_barrier
    ds_read_b128 v[10:13], v134 offset:0
    ds_read_b128 v[14:17], v134 offset:1024
    ds_read_b128 v[26:29], v134 offset:2048
    ds_read_b128 v[30:33], v134 offset:3072
    ds_read_b128 v[42:45], v134 offset:4096
    ds_read_b128 v[46:49], v134 offset:5120
    s_add_u32 m0, s8, 8192
    s_add_u32 s16, s16, 1310720
    buffer_load_dwordx4 v176, s[52:55], s16 offen offset:0 sc1 lds
    buffer_load_dwordx4 v176, s[52:55], s16 offen offset:1024 sc1 lds
    v_pk_fma_f32 v[2:3], v[68:69], v[124:125], v[2:3] op_sel_hi:[1,0,1] neg_lo:[0,1,0] neg_hi:[0,1,0]
    buffer_load_dwordx4 v176, s[52:55], s16 offen offset:2048 sc1 lds
    v_pk_fma_f32 v[4:5], v[70:71], v[124:125], v[4:5] op_sel_hi:[1,0,1] neg_lo:[0,1,0] neg_hi:[0,1,0]
    v_pk_fma_f32 v[6:7], v[72:73], v[124:125], v[6:7] op_sel_hi:[1,0,1] neg_lo:[0,1,0] neg_hi:[0,1,0]
    v_pk_fma_f32 v[8:9], v[74:75], v[124:125], v[8:9] op_sel_hi:[1,0,1] neg_lo:[0,1,0] neg_hi:[0,1,0]
    v_pk_fma_f32 v[2:3], v[92:93], v[126:127], v[2:3] op_sel_hi:[1,0,1]
    v_pk_fma_f32 v[4:5], v[94:95], v[126:127], v[4:5] op_sel_hi:[1,0,1]
    v_pk_fma_f32 v[6:7], v[96:97], v[126:127], v[6:7] op_sel_hi:[1,0,1]
    v_pk_fma_f32 v[8:9], v[98:99], v[126:127], v[8:9] op_sel_hi:[1,0,1]
    buffer_load_dwordx4 v176, s[52:55], s16 offen offset:3072 sc1 lds
    v_pk_fma_f32 v[18:19], v[76:77], v[124:125], v[18:19] op_sel_hi:[1,0,1] neg_lo:[0,1,0] neg_hi:[0,1,0]
    v_pk_fma_f32 v[20:21], v[78:79], v[124:125], v[20:21] op_sel_hi:[1,0,1] neg_lo:[0,1,0] neg_hi:[0,1,0]
    v_pk_fma_f32 v[22:23], v[80:81], v[124:125], v[22:23] op_sel_hi:[1,0,1] neg_lo:[0,1,0] neg_hi:[0,1,0]
    v_pk_fma_f32 v[24:25], v[82:83], v[124:125], v[24:25] op_sel_hi:[1,0,1] neg_lo:[0,1,0] neg_hi:[0,1,0]
    v_pk_fma_f32 v[18:19], v[100:101], v[126:127], v[18:19] op_sel_hi:[1,0,1]
    v_pk_fma_f32 v[20:21], v[102:103], v[126:127], v[20:21] op_sel_hi:[1,0,1]
    v_pk_fma_f32 v[22:23], v[104:105], v[126:127], v[22:23] op_sel_hi:[1,0,1]
    v_pk_fma_f32 v[24:25], v[106:107], v[126:127], v[24:25] op_sel_hi:[1,0,1]
    v_pk_fma_f32 v[34:35], v[84:85], v[124:125], v[34:35] op_sel_hi:[1,0,1] neg_lo:[0,1,0] neg_hi:[0,1,0]
    v_pk_fma_f32 v[36:37], v[86:87], v[124:125], v[36:37] op_sel_hi:[1,0,1] neg_lo:[0,1,0] neg_hi:[0,1,0]
    v_pk_fma_f32 v[38:39], v[88:89], v[124:125], v[38:39] op_sel_hi:[1,0,1] neg_lo:[0,1,0] neg_hi:[0,1,0]
    v_pk_fma_f32 v[40:41], v[90:91], v[124:125], v[40:41] op_sel_hi:[1,0,1] neg_lo:[0,1,0] neg_hi:[0,1,0]
    v_pk_fma_f32 v[34:35], v[108:109], v[126:127], v[34:35] op_sel_hi:[1,0,1]
    v_pk_fma_f32 v[36:37], v[110:111], v[126:127], v[36:37] op_sel_hi:[1,0,1]
    v_pk_fma_f32 v[38:39], v[112:113], v[126:127], v[38:39] op_sel_hi:[1,0,1]
    s_add_u32 m0, s8, 4294964224
    s_nop 0
    buffer_load_dwordx4 v139, s[52:55], s16 offen offset:3072 sc1 lds
    v_pk_fma_f32 v[40:41], v[114:115], v[126:127], v[40:41] op_sel_hi:[1,0,1]
    s_waitcnt lgkmcnt(4)
    v_pk_add_f32 v[2:3], v[2:3], v[10:11]
    v_pk_add_f32 v[4:5], v[4:5], v[12:13]
    v_pk_add_f32 v[6:7], v[6:7], v[14:15]
    v_pk_add_f32 v[8:9], v[8:9], v[16:17]
    v_pk_mul_f32 v[148:149], v[2:3], v[2:3]
    v_pk_mul_f32 v[150:151], v[4:5], v[4:5]
    v_pk_mul_f32 v[152:153], v[6:7], v[6:7]
    v_pk_mul_f32 v[154:155], v[8:9], v[8:9]
    v_pk_fma_f32 v[148:149], v[148:149], v[130:131], v[128:129] op_sel_hi:[1,0,0]
    v_pk_fma_f32 v[150:151], v[150:151], v[130:131], v[128:129] op_sel_hi:[1,0,0]
    v_pk_fma_f32 v[152:153], v[152:153], v[130:131], v[128:129] op_sel_hi:[1,0,0]
    v_pk_fma_f32 v[154:155], v[154:155], v[130:131], v[128:129] op_sel_hi:[1,0,0]
    s_add_u32 m0, s8, 1024
    s_add_u32 s17, s17, 1310720
    buffer_load_dwordx4 v176, s[52:55], s17 offen offset:0 sc1 lds
    v_pk_mul_f32 v[148:149], v[148:149], v[2:3]
    v_pk_mul_f32 v[150:151], v[150:151], v[4:5]
    v_pk_mul_f32 v[152:153], v[152:153], v[6:7]
    v_pk_mul_f32 v[154:155], v[154:155], v[8:9]
    v_exp_f32 v148, v148
    v_exp_f32 v149, v149
    v_exp_f32 v150, v150
    v_exp_f32 v151, v151
    v_exp_f32 v152, v152
    buffer_load_dwordx4 v176, s[52:55], s17 offen offset:1024 sc1 lds
    v_exp_f32 v153, v153
    v_exp_f32 v154, v154
    v_exp_f32 v155, v155
    v_pk_fma_f32 v[148:149], v[148:149], v[126:127], v[126:127] op_sel_hi:[1,0,0]
    v_pk_fma_f32 v[150:151], v[150:151], v[126:127], v[126:127] op_sel_hi:[1,0,0]
    v_pk_fma_f32 v[152:153], v[152:153], v[126:127], v[126:127] op_sel_hi:[1,0,0]
    v_pk_fma_f32 v[154:155], v[154:155], v[126:127], v[126:127] op_sel_hi:[1,0,0]
    v_rcp_f32 v148, v148
    v_rcp_f32 v149, v149
    buffer_load_dwordx4 v176, s[52:55], s17 offen offset:2048 sc1 lds
    v_rcp_f32 v150, v150
    v_rcp_f32 v151, v151
    v_rcp_f32 v152, v152
    v_rcp_f32 v153, v153
    v_rcp_f32 v154, v154
    v_rcp_f32 v155, v155
    v_pk_mul_f32 v[148:149], v[148:149], v[2:3]
    v_pk_mul_f32 v[150:151], v[150:151], v[4:5]
    v_pk_mul_f32 v[152:153], v[152:153], v[6:7]
    buffer_load_dwordx4 v176, s[52:55], s17 offen offset:3072 sc1 lds
    v_pk_mul_f32 v[154:155], v[154:155], v[8:9]
    v_cvt_pk_bf16_f32 v156, v148, v149
    v_cvt_pk_bf16_f32 v157, v150, v151
    v_cvt_pk_bf16_f32 v158, v152, v153
    v_cvt_pk_bf16_f32 v159, v154, v155
    buffer_store_dwordx4 v[156:159], v138, s[52:55], s86 offen offset:0 sc1
    s_waitcnt lgkmcnt(2)
    v_pk_add_f32 v[18:19], v[18:19], v[26:27]
    v_pk_add_f32 v[20:21], v[20:21], v[28:29]
    v_pk_add_f32 v[22:23], v[22:23], v[30:31]
    s_add_u32 m0, s8, 2048
    s_nop 0
    buffer_load_dwordx4 v139, s[52:55], s17 offen offset:3072 sc1 lds
    v_pk_add_f32 v[24:25], v[24:25], v[32:33]
    v_pk_mul_f32 v[148:149], v[18:19], v[18:19]
    v_pk_mul_f32 v[150:151], v[20:21], v[20:21]
    v_pk_mul_f32 v[152:153], v[22:23], v[22:23]
    v_pk_mul_f32 v[154:155], v[24:25], v[24:25]
    v_pk_fma_f32 v[148:149], v[148:149], v[130:131], v[128:129] op_sel_hi:[1,0,0]
    v_pk_fma_f32 v[150:151], v[150:151], v[130:131], v[128:129] op_sel_hi:[1,0,0]
    v_pk_fma_f32 v[152:153], v[152:153], v[130:131], v[128:129] op_sel_hi:[1,0,0]
    v_pk_fma_f32 v[154:155], v[154:155], v[130:131], v[128:129] op_sel_hi:[1,0,0]
    v_pk_mul_f32 v[148:149], v[148:149], v[18:19]
    v_pk_mul_f32 v[150:151], v[150:151], v[20:21]
    v_pk_mul_f32 v[152:153], v[152:153], v[22:23]
    v_pk_mul_f32 v[154:155], v[154:155], v[24:25]
    v_exp_f32 v148, v148
    s_add_u32 m0, s8, 6144
    s_add_u32 s18, s18, 1310720
    buffer_load_dwordx4 v176, s[52:55], s18 offen offset:0 sc1 lds
    v_exp_f32 v149, v149
    v_exp_f32 v150, v150
    v_exp_f32 v151, v151
    v_exp_f32 v152, v152
    v_exp_f32 v153, v153
    v_exp_f32 v154, v154
    buffer_load_dwordx4 v176, s[52:55], s18 offen offset:1024 sc1 lds
    v_exp_f32 v155, v155
    v_pk_fma_f32 v[148:149], v[148:149], v[126:127], v[126:127] op_sel_hi:[1,0,0]
    v_pk_fma_f32 v[150:151], v[150:151], v[126:127], v[126:127] op_sel_hi:[1,0,0]
    v_pk_fma_f32 v[152:153], v[152:153], v[126:127], v[126:127] op_sel_hi:[1,0,0]
    v_pk_fma_f32 v[154:155], v[154:155], v[126:127], v[126:127] op_sel_hi:[1,0,0]
    v_rcp_f32 v148, v148
    v_rcp_f32 v149, v149
    v_rcp_f32 v150, v150
    v_rcp_f32 v151, v151
    v_rcp_f32 v152, v152
    buffer_load_dwordx4 a[80:83], v182, s[52:55], s83 offen offset:0 sc1
    v_rcp_f32 v153, v153
    v_rcp_f32 v154, v154
    v_rcp_f32 v155, v155
    v_pk_mul_f32 v[148:149], v[148:149], v[18:19]
    v_pk_mul_f32 v[150:151], v[150:151], v[20:21]
    v_pk_mul_f32 v[152:153], v[152:153], v[22:23]
    v_pk_mul_f32 v[154:155], v[154:155], v[24:25]
    v_cvt_pk_bf16_f32 v160, v148, v149
    v_cvt_pk_bf16_f32 v161, v150, v151
    v_cvt_pk_bf16_f32 v162, v152, v153
    v_cvt_pk_bf16_f32 v163, v154, v155
    buffer_load_dwordx4 a[84:87], v182, s[52:55], s83 offen offset:1024 sc1
    buffer_store_dwordx4 v[160:163], v138, s[52:55], s86 offen offset:2048 sc1
    s_waitcnt lgkmcnt(0)
    s_nop 0
    v_pk_add_f32 v[34:35], v[34:35], v[42:43]
    v_pk_add_f32 v[36:37], v[36:37], v[44:45]
    v_pk_add_f32 v[38:39], v[38:39], v[46:47]
    v_pk_add_f32 v[40:41], v[40:41], v[48:49]
    v_pk_mul_f32 v[148:149], v[34:35], v[34:35]
    v_pk_mul_f32 v[150:151], v[36:37], v[36:37]
    v_pk_mul_f32 v[152:153], v[38:39], v[38:39]
    v_pk_mul_f32 v[154:155], v[40:41], v[40:41]
    buffer_load_dwordx4 a[88:91], v142, s[52:55], s83 offen offset:0 sc1
    v_pk_fma_f32 v[148:149], v[148:149], v[130:131], v[128:129] op_sel_hi:[1,0,0]
    v_pk_fma_f32 v[150:151], v[150:151], v[130:131], v[128:129] op_sel_hi:[1,0,0]
    v_pk_fma_f32 v[152:153], v[152:153], v[130:131], v[128:129] op_sel_hi:[1,0,0]
    v_pk_fma_f32 v[154:155], v[154:155], v[130:131], v[128:129] op_sel_hi:[1,0,0]
    v_pk_mul_f32 v[148:149], v[148:149], v[34:35]
    v_pk_mul_f32 v[150:151], v[150:151], v[36:37]
    v_pk_mul_f32 v[152:153], v[152:153], v[38:39]
    v_pk_mul_f32 v[154:155], v[154:155], v[40:41]
    v_exp_f32 v148, v148
    v_exp_f32 v149, v149
    v_exp_f32 v150, v150
    v_exp_f32 v151, v151
    s_add_u32 s83, s83, 5120
    buffer_load_dwordx4 a[92:95], v183, s[52:55], s83 offen offset:0 sc1
    v_exp_f32 v152, v152
    v_exp_f32 v153, v153
    v_exp_f32 v154, v154
    v_exp_f32 v155, v155
    v_pk_fma_f32 v[148:149], v[148:149], v[126:127], v[126:127] op_sel_hi:[1,0,0]
    v_pk_fma_f32 v[150:151], v[150:151], v[126:127], v[126:127] op_sel_hi:[1,0,0]
    v_pk_fma_f32 v[152:153], v[152:153], v[126:127], v[126:127] op_sel_hi:[1,0,0]
    v_pk_fma_f32 v[154:155], v[154:155], v[126:127], v[126:127] op_sel_hi:[1,0,0]
    v_rcp_f32 v148, v148
    buffer_load_dwordx4 a[96:99], v183, s[52:55], s83 offen offset:1024 sc1
    v_rcp_f32 v149, v149
    v_rcp_f32 v150, v150
    v_rcp_f32 v151, v151
    v_rcp_f32 v152, v152
    v_rcp_f32 v153, v153
    v_rcp_f32 v154, v154
    v_rcp_f32 v155, v155
    buffer_load_dwordx4 a[100:103], v182, s[52:55], s83 offen offset:0 sc1
    v_pk_mul_f32 v[148:149], v[148:149], v[34:35]
    v_pk_mul_f32 v[150:151], v[150:151], v[36:37]
    v_pk_mul_f32 v[152:153], v[152:153], v[38:39]
    v_pk_mul_f32 v[154:155], v[154:155], v[40:41]
    v_cvt_pk_bf16_f32 v164, v148, v149
    v_cvt_pk_bf16_f32 v165, v150, v151
    v_cvt_pk_bf16_f32 v166, v152, v153
    v_cvt_pk_bf16_f32 v167, v154, v155
    buffer_store_dwordx4 v[164:167], v138, s[52:55], s87 offen offset:0 sc1
    s_add_u32 s86, s86, 3145728
    s_add_u32 s87, s87, 3145728
    s_waitcnt vmcnt(19)
    ds_read_b64_tr_b16 v[68:69], v132 offset:8192
    ds_read_b64_tr_b16 v[70:71], v132 offset:8448
    ds_read_b64_tr_b16 v[72:73], v132 offset:9216
    ds_read_b64_tr_b16 v[74:75], v132 offset:9472
    s_waitcnt lgkmcnt(0)
    v_mfma_f32_32x32x16_bf16 v[2:17], v[184:187], v[68:71], 0
    s_waitcnt vmcnt(17)
    ds_read_b64_tr_b16 v[76:77], v132 offset:10240
    ds_read_b64_tr_b16 v[78:79], v132 offset:10496
    buffer_load_dwordx4 v176, s[52:55], s18 offen offset:2048 sc1 lds
    v_mfma_f32_32x32x16_bf16 v[18:33], v[188:191], v[68:71], 0
    ds_read_b64_tr_b16 v[80:81], v132 offset:11264
    ds_read_b64_tr_b16 v[82:83], v132 offset:11520
    v_mfma_f32_32x32x16_bf16 v[34:49], v[192:195], v[68:71], 0
    buffer_load_dwordx4 v176, s[52:55], s18 offen offset:3072 sc1 lds
    v_mfma_f32_32x32x16_bf16 v[2:17], v[196:199], v[72:75], v[2:17]
    v_mfma_f32_32x32x16_bf16 v[18:33], v[200:203], v[72:75], v[18:33]
    s_waitcnt vmcnt(17)
    ds_read_b64_tr_b16 v[52:53], v132 offset:0
    ds_read_b64_tr_b16 v[54:55], v132 offset:256
    s_waitcnt lgkmcnt(2)
    ds_read_b64_tr_b16 v[56:57], v132 offset:1024
    ds_read_b64_tr_b16 v[58:59], v132 offset:1280
    s_waitcnt lgkmcnt(0)
    s_cmp_lg_u32 s33, 0
    s_cbranch_scc1 L_st_27
    s_mov_b32 s3, 0x3f803f80
    v_dot2_f32_bf16 v127, v68, v68, 0
    v_dot2_f32_bf16 v126, v68, s3, 0
    v_dot2_f32_bf16 v127, v69, v69, v127
    v_dot2_f32_bf16 v126, v69, s3, v126
    v_dot2_f32_bf16 v127, v70, v70, v127
    v_dot2_f32_bf16 v126, v70, s3, v126
    v_dot2_f32_bf16 v127, v71, v71, v127
    v_dot2_f32_bf16 v126, v71, s3, v126
    v_dot2_f32_bf16 v127, v72, v72, v127
    v_dot2_f32_bf16 v126, v72, s3, v126
    v_dot2_f32_bf16 v127, v73, v73, v127
    v_dot2_f32_bf16 v126, v73, s3, v126
    v_dot2_f32_bf16 v127, v74, v74, v127
    v_dot2_f32_bf16 v126, v74, s3, v126
    v_dot2_f32_bf16 v127, v75, v75, v127
    v_dot2_f32_bf16 v126, v75, s3, v126
    v_dot2_f32_bf16 v127, v76, v76, v127
    v_dot2_f32_bf16 v126, v76, s3, v126
    v_dot2_f32_bf16 v127, v77, v77, v127
    v_dot2_f32_bf16 v126, v77, s3, v126
    v_dot2_f32_bf16 v127, v78, v78, v127
    v_dot2_f32_bf16 v126, v78, s3, v126
    v_dot2_f32_bf16 v127, v79, v79, v127
    v_dot2_f32_bf16 v126, v79, s3, v126
    v_dot2_f32_bf16 v127, v80, v80, v127
    v_dot2_f32_bf16 v126, v80, s3, v126
    v_dot2_f32_bf16 v127, v81, v81, v127
    v_dot2_f32_bf16 v126, v81, s3, v126
    v_dot2_f32_bf16 v127, v82, v82, v127
    v_dot2_f32_bf16 v126, v82, s3, v126
    v_dot2_f32_bf16 v127, v83, v83, v127
    v_dot2_f32_bf16 v126, v83, s3, v126
    v_dot2_f32_bf16 v127, v52, v52, v127
    v_dot2_f32_bf16 v126, v52, s3, v126
    v_dot2_f32_bf16 v127, v53, v53, v127
    v_dot2_f32_bf16 v126, v53, s3, v126
    v_dot2_f32_bf16 v127, v54, v54, v127
    v_dot2_f32_bf16 v126, v54, s3, v126
    v_dot2_f32_bf16 v127, v55, v55, v127
    v_dot2_f32_bf16 v126, v55, s3, v126
    s_nop 2
    v_permlane32_swap_b32 v126, v127
    v_add_f32 v126, v126, v127
    v_or_b32 v126, 1, v126
L_st_27:
    buffer_store_dword v126, v180, s[52:55], s9 offen sc1
    v_mfma_f32_32x32x16_bf16 v[34:49], v[204:207], v[72:75], v[34:49]
    s_waitcnt vmcnt(16)
    ds_read_b64_tr_b16 v[60:61], v132 offset:2048
    ds_read_b64_tr_b16 v[62:63], v132 offset:2304
    s_add_u32 m0, s8, 7168
    s_nop 0
    buffer_load_dwordx4 v139, s[52:55], s18 offen offset:3072 sc1 lds
    v_mfma_f32_32x32x16_bf16 v[2:17], v[208:211], v[76:79], v[2:17]
    ds_read_b64_tr_b16 v[64:65], v132 offset:3072
    ds_read_b64_tr_b16 v[66:67], v132 offset:3328
    v_mfma_f32_32x32x16_bf16 v[18:33], v[212:215], v[76:79], v[18:33]
    s_add_u32 m0, s8, 11264
    s_add_u32 s19, s19, 1310720
    buffer_load_dwordx4 v176, s[52:55], s19 offen offset:0 sc1 lds
    v_mfma_f32_32x32x16_bf16 v[34:49], v[216:219], v[76:79], v[34:49]
    v_mfma_f32_32x32x16_bf16 v[2:17], v[220:223], v[80:83], v[2:17]
    s_waitcnt vmcnt(15)
    ds_read_b64_tr_b16 v[68:69], v132 offset:4096
    ds_read_b64_tr_b16 v[70:71], v132 offset:4352
    s_add_u32 m0, s8, 4294966272
    s_nop 0
    buffer_load_dwordx4 v176, s[52:55], s19 offen offset:1024 sc1 lds
    v_mfma_f32_32x32x16_bf16 v[18:33], v[224:227], v[80:83], v[18:33]
    ds_read_b64_tr_b16 v[72:73], v132 offset:5120
    ds_read_b64_tr_b16 v[74:75], v132 offset:5376
    v_mfma_f32_32x32x16_bf16 v[34:49], v[228:231], v[80:83], v[34:49]
    s_waitcnt lgkmcnt(4)
    buffer_load_dwordx4 v176, s[52:55], s19 offen offset:2048 sc1 lds
    v_mfma_f32_32x32x16_bf16 v[2:17], v[232:235], v[52:55], v[2:17]
    ds_read_b128 v[84:87], v181 offset:0
    v_mfma_f32_32x32x16_bf16 v[18:33], v[236:239], v[52:55], v[18:33]
    ds_read_b128 v[88:91], v181 offset:1024
    s_waitcnt vmcnt(15)
    ds_read_b64_tr_b16 v[76:77], v132 offset:6144
    ds_read_b64_tr_b16 v[78:79], v132 offset:6400
    buffer_load_dwordx4 v176, s[52:55], s19 offen offset:3072 sc1 lds
    v_mfma_f32_32x32x16_bf16 v[34:49], v[240:243], v[52:55], v[34:49]
    ds_read_b128 v[92:95], v181 offset:2048
    ds_read_b64_tr_b16 v[80:81], v132 offset:7168
    ds_read_b64_tr_b16 v[82:83], v132 offset:7424
    s_waitcnt lgkmcnt(7)
    s_add_u32 m0, s8, 0
    s_nop 0
    buffer_load_dwordx4 v139, s[52:55], s19 offen offset:3072 sc1 lds
    v_mfma_f32_32x32x16_bf16 v[2:17], v[244:247], v[56:59], v[2:17]
    ds_read_b128 v[96:99], v181 offset:3072
    v_mfma_f32_32x32x16_bf16 v[18:33], v[248:251], v[56:59], v[18:33]
    ds_read_b128 v[100:103], v181 offset:4096
    v_mfma_f32_32x32x16_bf16 v[34:49], v[252:255], v[56:59], v[34:49]
    ds_read_b128 v[104:107], v181 offset:5120
    buffer_load_dwordx4 a[104:107], v182, s[52:55], s83 offen offset:1024 sc1
    s_waitcnt lgkmcnt(9)
    v_mfma_f32_32x32x16_bf16 v[2:17], v[84:87], v[60:63], v[2:17]
    ds_read_b128 v[108:111], v181 offset:6144
    v_and_b32 v178, 15, v1
    s_lshl_b32 s12, s10, 10
    v_add_u32 v240, s12, v176
    v_xor_b32 v241, 1024, v240
    s_waitcnt lgkmcnt(9)
    v_mfma_f32_32x32x16_bf16 v[18:33], v[88:91], v[60:63], v[18:33]
    ds_read_b128 v[112:115], v181 offset:7168
    s_waitcnt lgkmcnt(5)
    buffer_load_dwordx4 a[108:111], v142, s[52:55], s83 offen offset:0 sc1
    s_lshl_b32 s80, s69, 2
    s_add_u32 s80, s80, s60
    v_mfma_f32_32x32x16_bf16 v[34:49], v[92:95], v[60:63], v[34:49]
    ds_read_b128 v[84:87], v181 offset:8192
    s_mul_i32 s80, s80, 24576
    s_add_u32 s80, s80, 11534336
    s_xor_b32 s12, s60, 1
    s_waitcnt lgkmcnt(5)
    s_nop 0
    v_mfma_f32_32x32x16_bf16 v[2:17], v[96:99], v[64:67], v[2:17]
    ds_read_b128 v[88:91], v181 offset:9216
    s_add_u32 s83, s83, 5120
    buffer_load_dwordx4 a[112:115], v183, s[52:55], s83 offen offset:0 sc1
    s_mul_i32 s12, s12, 6144
    s_add_u32 s12, s12, 77824
    s_waitcnt lgkmcnt(5)
    v_mfma_f32_32x32x16_bf16 v[18:33], v[100:103], v[64:67], v[18:33]
    ds_read_b128 v[92:95], v181 offset:10240
    v_add_u32 v243, s12, v176
    s_xor_b32 s12, s60, 2
    s_mul_i32 s12, s12, 6144
    s_add_u32 s12, s12, 79872
    s_waitcnt lgkmcnt(5)
    v_mfma_f32_32x32x16_bf16 v[34:49], v[104:107], v[64:67], v[34:49]
    ds_read_b128 v[96:99], v181 offset:11264
    buffer_load_dwordx4 a[116:119], v183, s[52:55], s83 offen offset:1024 sc1
    v_add_u32 v244, s12, v176
    s_xor_b32 s12, s60, 3
    s_mul_i32 s12, s12, 6144
    s_waitcnt lgkmcnt(5)
    v_mfma_f32_32x32x16_bf16 v[2:17], v[108:111], v[68:71], v[2:17]
    ds_read_b128 v[100:103], v181 offset:12288
    s_waitcnt vmcnt(13)
    s_barrier
    s_cmp_lg_u32 s60, 0
    s_cbranch_scc1 L_pub_28
    s_mov_b32 exec_hi, 0
    s_mov_b32 s3, 458752
    buffer_store_dword v174, v135, s[52:55], s3 offen sc1
    s_mov_b64 exec, -1
L_pub_28:
    s_waitcnt lgkmcnt(5)
    v_mfma_f32_32x32x16_bf16 v[18:33], v[112:115], v[68:71], v[18:33]
    ds_read_b128 v[104:107], v181 offset:13312
    buffer_load_dwordx4 a[120:123], v182, s[52:55], s83 offen offset:0 sc1
    s_add_u32 s12, s12, 81920
    v_add_u32 v245, s12, v176
    v_add_u32 v246, 77824, v133
    s_waitcnt lgkmcnt(5)
    v_mfma_f32_32x32x16_bf16 v[34:49], v[84:87], v[68:71], v[34:49]
    ds_read_b128 v[108:111], v181 offset:14336
    buffer_load_dwordx4 a[124:127], v182, s[52:55], s83 offen offset:1024 sc1
    s_lshl_b32 s12, s10, 12
    s_add_u32 s12, s12, 102400
    v_add_u32 v249, s12, v176
    s_waitcnt lgkmcnt(5)
    v_mfma_f32_32x32x16_bf16 v[2:17], v[88:91], v[72:75], v[2:17]
    ds_read_b128 v[112:115], v181 offset:15360
    s_lshl_b32 s82, s60, 10
    v_add_u32 v247, s82, v249
    s_xor_b32 s12, s10, 1
    s_lshl_b32 s12, s12, 12
    s_waitcnt lgkmcnt(5)
    v_mfma_f32_32x32x16_bf16 v[18:33], v[92:95], v[72:75], v[18:33]
    ds_read_b128 v[84:87], v181 offset:16384
    s_waitcnt vmcnt(13)
    ds_read_b64_tr_b16 v[52:53], v132 offset:8192
    ds_read_b64_tr_b16 v[54:55], v132 offset:8448
    buffer_load_dwordx4 a[128:131], v142, s[52:55], s83 offen offset:0 sc1
    s_waitcnt lgkmcnt(7)
    v_mfma_f32_32x32x16_bf16 v[34:49], v[96:99], v[72:75], v[34:49]
    ds_read_b128 v[88:91], v181 offset:17408
    ds_read_b64_tr_b16 v[56:57], v132 offset:9216
    ds_read_b64_tr_b16 v[58:59], v132 offset:9472
    s_add_u32 s12, s12, s82
    s_add_u32 s12, s12, 102400
    s_waitcnt lgkmcnt(9)
    v_mfma_f32_32x32x16_bf16 v[2:17], v[100:103], v[76:79], v[2:17]
    ds_read_b128 v[92:95], v181 offset:18432
    s_add_u32 s83, s83, 5120
    buffer_load_dwordx4 a[132:135], v183, s[52:55], s83 offen offset:0 sc1
    v_add_u32 v248, s12, v176
    s_and_b32 s15, s70, 1
    s_waitcnt lgkmcnt(9)
    v_mfma_f32_32x32x16_bf16 v[18:33], v[104:107], v[76:79], v[18:33]
    ds_read_b128 v[96:99], v181 offset:19456
    s_lshl_b32 s13, s15, 4
    s_lshl_b32 s12, s11, 5
    s_add_u32 s13, s13, s12
    s_xor_b32 s15, s15, 1
    s_waitcnt lgkmcnt(9)
    v_mfma_f32_32x32x16_bf16 v[34:49], v[108:111], v[76:79], v[34:49]
    ds_read_b128 v[100:103], v181 offset:20480
    buffer_load_dwordx4 a[136:139], v183, s[52:55], s83 offen offset:1024 sc1
    buffer_load_dword v116, v180, s[52:55], s39 offen offset:0 sc1
    s_waitcnt lgkmcnt(9)
    v_mfma_f32_32x32x16_bf16 v[2:17], v[112:115], v[80:83], v[2:17]
    ds_read_b128 v[104:107], v181 offset:21504
    buffer_load_dword v117, v180, s[52:55], s39 offen offset:256 sc1
    s_waitcnt lgkmcnt(9)
    v_mfma_f32_32x32x16_bf16 v[18:33], v[84:87], v[80:83], v[18:33]
    ds_read_b128 v[108:111], v181 offset:22528
    s_waitcnt vmcnt(15)
    ds_read_b64_tr_b16 v[60:61], v132 offset:10240
    ds_read_b64_tr_b16 v[62:63], v132 offset:10496
    s_waitcnt lgkmcnt(7)
    v_mfma_f32_32x32x16_bf16 v[34:49], v[88:91], v[80:83], v[34:49]
    ds_read_b128 v[112:115], v181 offset:23552
    ds_read_b64_tr_b16 v[64:65], v132 offset:11264
    ds_read_b64_tr_b16 v[66:67], v132 offset:11520
    buffer_load_dwordx4 a[140:143], v182, s[52:55], s83 offen offset:0 sc1
    buffer_load_dword v118, v180, s[52:55], s39 offen offset:512 sc1
    s_waitcnt lgkmcnt(9)
    v_mfma_f32_32x32x16_bf16 v[2:17], v[92:95], v[52:55], v[2:17]
    ds_read_b128 v[84:87], v181 offset:24576
    s_waitcnt lgkmcnt(9)
    v_mfma_f32_32x32x16_bf16 v[18:33], v[96:99], v[52:55], v[18:33]
    ds_read_b128 v[88:91], v181 offset:25600
    buffer_load_dwordx4 a[144:147], v182, s[52:55], s83 offen offset:1024 sc1
    buffer_load_dword v119, v180, s[52:55], s39 offen offset:768 sc1
    s_waitcnt lgkmcnt(9)
    v_mfma_f32_32x32x16_bf16 v[34:49], v[100:103], v[52:55], v[34:49]
    ds_read_b128 v[92:95], v181 offset:26624
    buffer_load_dword v120, v180, s[52:55], s39 offen offset:1024 sc1
    s_waitcnt lgkmcnt(9)
    v_mfma_f32_32x32x16_bf16 v[2:17], v[104:107], v[56:59], v[2:17]
    ds_read_b128 v[96:99], v181 offset:27648
    buffer_load_dwordx4 a[148:151], v142, s[52:55], s83 offen offset:0 sc1
    buffer_load_dword v121, v180, s[52:55], s39 offen offset:1280 sc1
    s_waitcnt lgkmcnt(9)
    v_mfma_f32_32x32x16_bf16 v[18:33], v[108:111], v[56:59], v[18:33]
    ds_read_b128 v[100:103], v181 offset:28672
    s_waitcnt vmcnt(20)
    ds_read_b64_tr_b16 v[68:69], v132 offset:0
    ds_read_b64_tr_b16 v[70:71], v132 offset:256
    s_waitcnt lgkmcnt(7)
    s_nop 0
    v_mfma_f32_32x32x16_bf16 v[34:49], v[112:115], v[56:59], v[34:49]
    ds_read_b128 v[104:107], v181 offset:29696
    ds_read_b64_tr_b16 v[72:73], v132 offset:1024
    ds_read_b64_tr_b16 v[74:75], v132 offset:1280
    s_add_u32 s83, s83, 5120
    buffer_load_dwordx4 a[152:155], v183, s[52:55], s83 offen offset:0 sc1
    s_waitcnt lgkmcnt(9)
    v_mfma_f32_32x32x16_bf16 v[2:17], v[84:87], v[60:63], v[2:17]
    ds_read_b128 v[108:111], v181 offset:30720
    buffer_load_dword v122, v180, s[52:55], s39 offen offset:1536 sc1
    s_waitcnt lgkmcnt(9)
    v_mfma_f32_32x32x16_bf16 v[18:33], v[88:91], v[60:63], v[18:33]
    ds_read_b128 v[112:115], v181 offset:31744
    buffer_load_dwordx4 a[156:159], v183, s[52:55], s83 offen offset:1024 sc1
    buffer_load_dword v123, v180, s[52:55], s39 offen offset:1792 sc1
    s_waitcnt lgkmcnt(9)
    v_mfma_f32_32x32x16_bf16 v[34:49], v[92:95], v[60:63], v[34:49]
    ds_read_b128 v[84:87], v181 offset:32768
    s_waitcnt vmcnt(22)
    ds_read_b64_tr_b16 v[76:77], v132 offset:2048
    ds_read_b64_tr_b16 v[78:79], v132 offset:2304
    buffer_load_dwordx4 a[160:163], v182, s[52:55], s83 offen offset:0 sc1
    s_waitcnt lgkmcnt(11)
    v_mfma_f32_32x32x16_bf16 v[2:17], v[96:99], v[64:67], v[2:17]
    ds_read_b128 v[88:91], v181 offset:33792
    ds_read_b64_tr_b16 v[80:81], v132 offset:3072
    ds_read_b64_tr_b16 v[82:83], v132 offset:3328
    s_lshl_b32 s15, s15, 6
    v_lshrrev_b32 v168, 4, v1
    s_waitcnt lgkmcnt(13)
    v_mfma_f32_32x32x16_bf16 v[18:33], v[100:103], v[64:67], v[18:33]
    ds_read_b128 v[92:95], v181 offset:36864
    s_waitcnt lgkmcnt(9)
    v_bfe_u32 v169, v1, 2, 2
    v_and_b32 v170, 3, v1
    v_lshl_add_u32 v175, v168, 3, s13
    v_mfma_f32_32x32x16_bf16 v[34:49], v[104:107], v[64:67], v[34:49]
    ds_read_b128 v[96:99], v181 offset:39936
    buffer_load_dwordx4 a[164:167], v182, s[52:55], s83 offen offset:1024 sc1
    v_lshl_add_u32 v177, v168, 2, s15
    s_lshl_b32 s12, s10, 5
    s_add_u32 s12, s12, 143360
    s_waitcnt lgkmcnt(9)
    v_mfma_f32_32x32x16_bf16 v[2:17], v[108:111], v[68:71], v[2:17]
    ds_read_b128 v[100:103], v181 offset:34816
    v_lshl_add_u32 v170, v170, 3, s12
    v_add_u32 v250, v175, v169
    v_lshl_add_u32 v250, v250, 6, v170
    v_add_u32 v251, v177, v169
    s_waitcnt lgkmcnt(9)
    s_nop 0
    v_mfma_f32_32x32x16_bf16 v[18:33], v[112:115], v[68:71], v[18:33]
    ds_read_b128 v[104:107], v181 offset:37888
    buffer_load_dwordx4 a[168:171], v142, s[52:55], s83 offen offset:0 sc1
    v_lshl_add_u32 v251, v251, 6, v170
    s_mul_i32 s12, s70, 160
    v_lshl_add_u32 v175, v175, 1, s12
    s_waitcnt lgkmcnt(9)
    v_mfma_f32_32x32x16_bf16 v[34:49], v[84:87], v[68:71], v[34:49]
    ds_read_b128 v[108:111], v181 offset:40960
    s_waitcnt lgkmcnt(5)
    v_lshl_add_u32 v177, v177, 1, s12
    global_load_dwordx4 v[236:239], v175, s[30:31]
    global_load_dwordx2 v[234:235], v177, s[30:31]
    v_mfma_f32_32x32x16_bf16 v[2:17], v[88:91], v[72:75], v[2:17]
    ds_read_b128 v[112:115], v181 offset:35840
    s_add_u32 s83, s83, 5120
    buffer_load_dwordx4 a[172:175], v183, s[52:55], s83 offen offset:0 sc1
    s_lshl_b32 s12, s69, 1
    s_add_u32 s12, s12, s10
    s_waitcnt lgkmcnt(5)
    v_mfma_f32_32x32x16_bf16 v[2:17], v[92:95], v[76:79], v[2:17]
    ds_read_b128 v[84:87], v181 offset:38912
    s_mul_i32 s84, s12, 20480
    v_mul_u32_u24 v178, 1280, v178
    v_add_u32 v252, v178, v175
    v_add_u32 v253, v178, v177
    s_waitcnt lgkmcnt(5)
    v_mfma_f32_32x32x16_bf16 v[2:17], v[96:99], v[80:83], v[2:17]
    ds_read_b128 v[88:91], v181 offset:41984
    s_mov_b32 s3, 458752
    buffer_load_dword v51, v136, s[52:55], s3 offen sc1
    s_lshl_b32 s12, s11, 3
    s_lshl_b32 s90, 0x00ff00ff, s12
    s_waitcnt lgkmcnt(5)
    v_mfma_f32_32x32x16_bf16 v[18:33], v[100:103], v[72:75], v[18:33]
    buffer_load_dwordx4 a[176:179], v183, s[52:55], s83 offen offset:1024 sc1
    s_mov_b32 s91, s90
    s_mul_i32 s81, s69, 40960
    s_mul_i32 s12, s70, 5120
    s_add_u32 s81, s81, s12
    s_waitcnt lgkmcnt(4)
    v_mfma_f32_32x32x16_bf16 v[18:33], v[104:107], v[76:79], v[18:33]
    ds_write_b128 v133, v[10:13] offset:0
    buffer_load_dwordx4 a[180:183], v182, s[52:55], s83 offen offset:0 sc1
    s_add_u32 s81, s81, 8388608
    s_waitcnt vmcnt(9)
    v_and_b32 v126, v116, v117
    s_waitcnt lgkmcnt(4)
    v_mfma_f32_32x32x16_bf16 v[18:33], v[108:111], v[80:83], v[18:33]
    ds_write_b128 v133, v[14:17] offset:1024
    buffer_load_dwordx4 a[184:187], v182, s[52:55], s83 offen offset:1024 sc1
    v_bitop3_b32 v126, v126, v118, v119 bitop3:0x80
    v_bitop3_b32 v126, v126, v120, v121 bitop3:0x80
    v_bitop3_b32 v126, v126, v122, v123 bitop3:0x80
    s_waitcnt lgkmcnt(4)
    v_mfma_f32_32x32x16_bf16 v[34:49], v[112:115], v[72:75], v[34:49]
    v_and_b32 v126, 1, v126
    v_cmp_eq_u32 vcc, 0, v126
    s_nop 1
    s_cbranch_vccnz L_slow_29
L_back_30:
    v_add_f32 v116, v116, v117
    v_add_f32 v116, v116, v118
    v_add_f32 v116, v116, v119
    s_waitcnt lgkmcnt(3)
    v_mfma_f32_32x32x16_bf16 v[34:49], v[84:87], v[76:79], v[34:49]
    ds_write_b128 v133, v[26:29] offset:2048
    buffer_load_dwordx4 a[188:191], v142, s[52:55], s83 offen offset:0 sc1
    v_add_f32 v116, v116, v120
    v_add_f32 v116, v116, v121
    v_add_f32 v116, v116, v122
    s_waitcnt lgkmcnt(3)
    v_mfma_f32_32x32x16_bf16 v[34:49], v[88:91], v[80:83], v[34:49]
    ds_write_b128 v133, v[30:33] offset:3072
    v_add_f32 v116, v116, v123
    v_mov_b32 v117, v116
    v_mov_b32 v126, 0x3727c5ac
    s_nop 0
    ds_read_b128 v[68:71], v137 offset:0
    ds_read_b128 v[92:95], v137 offset:512
    ds_read_b128 v[72:75], v137 offset:32
    ds_read_b128 v[96:99], v137 offset:544
    ds_read_b128 v[76:79], v137 offset:128
    ds_read_b128 v[100:103], v137 offset:640
    ds_read_b128 v[80:83], v137 offset:160
    ds_read_b128 v[104:107], v137 offset:672
    ds_read_b128 v[84:87], v137 offset:256
    ds_read_b128 v[108:111], v137 offset:768
    ds_read_b128 v[88:91], v137 offset:288
    ds_read_b128 v[112:115], v137 offset:800
    ds_write_b128 v133, v[42:45] offset:4096
    ds_write_b128 v133, v[46:49] offset:5120
    v_permlane32_swap_b32 v116, v117
    v_mul_f32 v124, 0x3acccccd, v116
    v_fmac_f32 v126, 0x3acccccd, v117
    v_fma_f32 v126, -v124, v124, v126
    v_rsq_f32 v128, v126
    s_nop 0
    v_mul_f32 v126, v126, v128
    v_mul_f32 v130, v128, v128
    v_mul_f32 v130, v130, v128
    v_mul_f32 v130, 0xbdd2d3e8, v130
    v_mul_f32 v128, 0xc0135761, v128
    s_waitcnt lgkmcnt(0)
    s_barrier
    ds_read_b128 v[10:13], v134 offset:0
    ds_read_b128 v[14:17], v134 offset:1024
    ds_read_b128 v[26:29], v134 offset:2048
    ds_read_b128 v[30:33], v134 offset:3072
    ds_read_b128 v[42:45], v134 offset:4096
    ds_read_b128 v[46:49], v134 offset:5120
    v_pk_fma_f32 v[2:3], v[68:69], v[124:125], v[2:3] op_sel_hi:[1,0,1] neg_lo:[0,1,0] neg_hi:[0,1,0]
    v_pk_fma_f32 v[4:5], v[70:71], v[124:125], v[4:5] op_sel_hi:[1,0,1] neg_lo:[0,1,0] neg_hi:[0,1,0]
    v_pk_fma_f32 v[6:7], v[72:73], v[124:125], v[6:7] op_sel_hi:[1,0,1] neg_lo:[0,1,0] neg_hi:[0,1,0]
    v_pk_fma_f32 v[8:9], v[74:75], v[124:125], v[8:9] op_sel_hi:[1,0,1] neg_lo:[0,1,0] neg_hi:[0,1,0]
    v_pk_fma_f32 v[2:3], v[92:93], v[126:127], v[2:3] op_sel_hi:[1,0,1]
    v_pk_fma_f32 v[4:5], v[94:95], v[126:127], v[4:5] op_sel_hi:[1,0,1]
    v_pk_fma_f32 v[6:7], v[96:97], v[126:127], v[6:7] op_sel_hi:[1,0,1]
    v_pk_fma_f32 v[8:9], v[98:99], v[126:127], v[8:9] op_sel_hi:[1,0,1]
    v_pk_fma_f32 v[18:19], v[76:77], v[124:125], v[18:19] op_sel_hi:[1,0,1] neg_lo:[0,1,0] neg_hi:[0,1,0]
    v_pk_fma_f32 v[20:21], v[78:79], v[124:125], v[20:21] op_sel_hi:[1,0,1] neg_lo:[0,1,0] neg_hi:[0,1,0]
    v_pk_fma_f32 v[22:23], v[80:81], v[124:125], v[22:23] op_sel_hi:[1,0,1] neg_lo:[0,1,0] neg_hi:[0,1,0]
    v_pk_fma_f32 v[24:25], v[82:83], v[124:125], v[24:25] op_sel_hi:[1,0,1] neg_lo:[0,1,0] neg_hi:[0,1,0]
    v_pk_fma_f32 v[18:19], v[100:101], v[126:127], v[18:19] op_sel_hi:[1,0,1]
    v_pk_fma_f32 v[20:21], v[102:103], v[126:127], v[20:21] op_sel_hi:[1,0,1]
    v_pk_fma_f32 v[22:23], v[104:105], v[126:127], v[22:23] op_sel_hi:[1,0,1]
    v_pk_fma_f32 v[24:25], v[106:107], v[126:127], v[24:25] op_sel_hi:[1,0,1]
    v_pk_fma_f32 v[34:35], v[84:85], v[124:125], v[34:35] op_sel_hi:[1,0,1] neg_lo:[0,1,0] neg_hi:[0,1,0]
    v_pk_fma_f32 v[36:37], v[86:87], v[124:125], v[36:37] op_sel_hi:[1,0,1] neg_lo:[0,1,0] neg_hi:[0,1,0]
    v_pk_fma_f32 v[38:39], v[88:89], v[124:125], v[38:39] op_sel_hi:[1,0,1] neg_lo:[0,1,0] neg_hi:[0,1,0]
    v_pk_fma_f32 v[40:41], v[90:91], v[124:125], v[40:41] op_sel_hi:[1,0,1] neg_lo:[0,1,0] neg_hi:[0,1,0]
    v_pk_fma_f32 v[34:35], v[108:109], v[126:127], v[34:35] op_sel_hi:[1,0,1]
    v_pk_fma_f32 v[36:37], v[110:111], v[126:127], v[36:37] op_sel_hi:[1,0,1]
    v_pk_fma_f32 v[38:39], v[112:113], v[126:127], v[38:39] op_sel_hi:[1,0,1]
    v_pk_fma_f32 v[40:41], v[114:115], v[126:127], v[40:41] op_sel_hi:[1,0,1]
    s_waitcnt lgkmcnt(4)
    s_nop 0
    v_pk_add_f32 v[2:3], v[2:3], v[10:11]
    v_pk_add_f32 v[4:5], v[4:5], v[12:13]
    v_pk_add_f32 v[6:7], v[6:7], v[14:15]
    v_pk_add_f32 v[8:9], v[8:9], v[16:17]
    v_pk_mul_f32 v[148:149], v[2:3], v[2:3]
    v_pk_mul_f32 v[150:151], v[4:5], v[4:5]
    v_pk_mul_f32 v[152:153], v[6:7], v[6:7]
    v_pk_mul_f32 v[154:155], v[8:9], v[8:9]
    v_pk_fma_f32 v[148:149], v[148:149], v[130:131], v[128:129] op_sel_hi:[1,0,0]
    v_pk_fma_f32 v[150:151], v[150:151], v[130:131], v[128:129] op_sel_hi:[1,0,0]
    v_pk_fma_f32 v[152:153], v[152:153], v[130:131], v[128:129] op_sel_hi:[1,0,0]
    v_pk_fma_f32 v[154:155], v[154:155], v[130:131], v[128:129] op_sel_hi:[1,0,0]
    v_pk_mul_f32 v[148:149], v[148:149], v[2:3]
    v_pk_mul_f32 v[150:151], v[150:151], v[4:5]
    v_pk_mul_f32 v[152:153], v[152:153], v[6:7]
    v_pk_mul_f32 v[154:155], v[154:155], v[8:9]
    v_exp_f32 v148, v148
    v_exp_f32 v149, v149
    v_exp_f32 v150, v150
    v_exp_f32 v151, v151
    v_exp_f32 v152, v152
    v_exp_f32 v153, v153
    v_exp_f32 v154, v154
    v_exp_f32 v155, v155
    v_pk_fma_f32 v[148:149], v[148:149], v[126:127], v[126:127] op_sel_hi:[1,0,0]
    v_pk_fma_f32 v[150:151], v[150:151], v[126:127], v[126:127] op_sel_hi:[1,0,0]
    v_pk_fma_f32 v[152:153], v[152:153], v[126:127], v[126:127] op_sel_hi:[1,0,0]
    v_pk_fma_f32 v[154:155], v[154:155], v[126:127], v[126:127] op_sel_hi:[1,0,0]
    v_rcp_f32 v148, v148
    v_rcp_f32 v149, v149
    v_rcp_f32 v150, v150
    v_rcp_f32 v151, v151
    v_rcp_f32 v152, v152
    v_rcp_f32 v153, v153
    v_rcp_f32 v154, v154
    s_waitcnt vmcnt(4)
    v_cmp_ne_u32 vcc, v174, v51
    s_nop 1
    s_cbranch_vccnz L_slow_31
L_back_32:
    v_rcp_f32 v155, v155
    s_add_u32 s14, s80, 0
    s_nop 0
    buffer_load_dwordx4 v[184:187], v240, s[52:55], s14 offen offset:0 sc1
    v_pk_mul_f32 v[148:149], v[148:149], v[2:3]
    v_pk_mul_f32 v[150:151], v[150:151], v[4:5]
    v_pk_mul_f32 v[152:153], v[152:153], v[6:7]
    v_pk_mul_f32 v[154:155], v[154:155], v[8:9]
    v_cvt_pk_bf16_f32 v156, v148, v149
    v_cvt_pk_bf16_f32 v157, v150, v151
    buffer_load_dwordx4 v[188:191], v241, s[52:55], s14 offen offset:0 sc1
    v_cvt_pk_bf16_f32 v158, v152, v153
    v_cvt_pk_bf16_f32 v159, v154, v155
    v_min_u32 v156, -2, v156
    buffer_store_dwordx4 v[156:159], v138, s[52:55], s86 offen offset:0 sc1
    s_waitcnt lgkmcnt(2)
    v_pk_add_f32 v[18:19], v[18:19], v[26:27]
    v_pk_add_f32 v[20:21], v[20:21], v[28:29]
    v_pk_add_f32 v[22:23], v[22:23], v[30:31]
    v_pk_add_f32 v[24:25], v[24:25], v[32:33]
    v_pk_mul_f32 v[148:149], v[18:19], v[18:19]
    buffer_load_dwordx4 v[192:195], v240, s[52:55], s14 offen offset:2048 sc1
    v_pk_mul_f32 v[150:151], v[20:21], v[20:21]
    v_pk_mul_f32 v[152:153], v[22:23], v[22:23]
    v_pk_mul_f32 v[154:155], v[24:25], v[24:25]
    v_pk_fma_f32 v[148:149], v[148:149], v[130:131], v[128:129] op_sel_hi:[1,0,0]
    v_pk_fma_f32 v[150:151], v[150:151], v[130:131], v[128:129] op_sel_hi:[1,0,0]
    v_pk_fma_f32 v[152:153], v[152:153], v[130:131], v[128:129] op_sel_hi:[1,0,0]
    v_pk_fma_f32 v[154:155], v[154:155], v[130:131], v[128:129] op_sel_hi:[1,0,0]
    v_pk_mul_f32 v[148:149], v[148:149], v[18:19]
    v_pk_mul_f32 v[150:151], v[150:151], v[20:21]
    v_pk_mul_f32 v[152:153], v[152:153], v[22:23]
    v_pk_mul_f32 v[154:155], v[154:155], v[24:25]
    v_exp_f32 v148, v148
    v_exp_f32 v149, v149
    buffer_load_dwordx4 v[196:199], v241, s[52:55], s14 offen offset:2048 sc1
    v_exp_f32 v150, v150
    v_exp_f32 v151, v151
    v_exp_f32 v152, v152
    v_exp_f32 v153, v153
    v_exp_f32 v154, v154
    v_exp_f32 v155, v155
    v_pk_fma_f32 v[148:149], v[148:149], v[126:127], v[126:127] op_sel_hi:[1,0,0]
    v_pk_fma_f32 v[150:151], v[150:151], v[126:127], v[126:127] op_sel_hi:[1,0,0]
    v_pk_fma_f32 v[152:153], v[152:153], v[126:127], v[126:127] op_sel_hi:[1,0,0]
    s_add_u32 s14, s80, 4096
    buffer_load_dwordx4 v[200:203], v240, s[52:55], s14 offen offset:0 sc1
    v_pk_fma_f32 v[154:155], v[154:155], v[126:127], v[126:127] op_sel_hi:[1,0,0]
    v_rcp_f32 v148, v148
    v_rcp_f32 v149, v149
    v_rcp_f32 v150, v150
    v_rcp_f32 v151, v151
    v_rcp_f32 v152, v152
    v_rcp_f32 v153, v153
    v_rcp_f32 v154, v154
    buffer_load_dwordx4 v[204:207], v241, s[52:55], s14 offen offset:0 sc1
    v_rcp_f32 v155, v155
    v_pk_mul_f32 v[148:149], v[148:149], v[18:19]
    v_pk_mul_f32 v[150:151], v[150:151], v[20:21]
    v_pk_mul_f32 v[152:153], v[152:153], v[22:23]
    v_pk_mul_f32 v[154:155], v[154:155], v[24:25]
    v_cvt_pk_bf16_f32 v160, v148, v149
    v_cvt_pk_bf16_f32 v161, v150, v151
    v_cvt_pk_bf16_f32 v162, v152, v153
    v_cvt_pk_bf16_f32 v163, v154, v155
    v_min_u32 v160, -2, v160
    buffer_store_dwordx4 v[160:163], v138, s[52:55], s86 offen offset:2048 sc1
    s_waitcnt lgkmcnt(0)
    v_pk_add_f32 v[34:35], v[34:35], v[42:43]
    buffer_load_dwordx4 v[208:211], v240, s[52:55], s14 offen offset:2048 sc1
    v_pk_add_f32 v[36:37], v[36:37], v[44:45]
    v_pk_add_f32 v[38:39], v[38:39], v[46:47]
    v_pk_add_f32 v[40:41], v[40:41], v[48:49]
    v_pk_mul_f32 v[148:149], v[34:35], v[34:35]
    v_pk_mul_f32 v[150:151], v[36:37], v[36:37]
    v_pk_mul_f32 v[152:153], v[38:39], v[38:39]
    v_pk_mul_f32 v[154:155], v[40:41], v[40:41]
    v_pk_fma_f32 v[148:149], v[148:149], v[130:131], v[128:129] op_sel_hi:[1,0,0]
    v_pk_fma_f32 v[150:151], v[150:151], v[130:131], v[128:129] op_sel_hi:[1,0,0]
    v_pk_fma_f32 v[152:153], v[152:153], v[130:131], v[128:129] op_sel_hi:[1,0,0]
    buffer_load_dwordx4 v[212:215], v241, s[52:55], s14 offen offset:2048 sc1
    v_pk_fma_f32 v[154:155], v[154:155], v[130:131], v[128:129] op_sel_hi:[1,0,0]
    v_pk_mul_f32 v[148:149], v[148:149], v[34:35]
    v_pk_mul_f32 v[150:151], v[150:151], v[36:37]
    v_pk_mul_f32 v[152:153], v[152:153], v[38:39]
    v_pk_mul_f32 v[154:155], v[154:155], v[40:41]
    v_exp_f32 v148, v148
    v_exp_f32 v149, v149
    v_exp_f32 v150, v150
    v_exp_f32 v151, v151
    v_exp_f32 v152, v152
    s_add_u32 s14, s80, 8192
    buffer_load_dwordx4 v[216:219], v240, s[52:55], s14 offen offset:0 sc1
    v_exp_f32 v153, v153
    v_exp_f32 v154, v154
    v_exp_f32 v155, v155
    v_pk_fma_f32 v[148:149], v[148:149], v[126:127], v[126:127] op_sel_hi:[1,0,0]
    v_pk_fma_f32 v[150:151], v[150:151], v[126:127], v[126:127] op_sel_hi:[1,0,0]
    v_pk_fma_f32 v[152:153], v[152:153], v[126:127], v[126:127] op_sel_hi:[1,0,0]
    v_pk_fma_f32 v[154:155], v[154:155], v[126:127], v[126:127] op_sel_hi:[1,0,0]
    v_rcp_f32 v148, v148
    v_rcp_f32 v149, v149
    buffer_load_dwordx4 v[220:223], v241, s[52:55], s14 offen offset:0 sc1
    v_rcp_f32 v150, v150
    v_rcp_f32 v151, v151
    v_rcp_f32 v152, v152
    v_rcp_f32 v153, v153
    v_rcp_f32 v154, v154
    v_rcp_f32 v155, v155
    v_pk_mul_f32 v[148:149], v[148:149], v[34:35]
    v_pk_mul_f32 v[150:151], v[150:151], v[36:37]
    v_pk_mul_f32 v[152:153], v[152:153], v[38:39]
    buffer_load_dwordx4 v[224:227], v240, s[52:55], s14 offen offset:2048 sc1
    v_pk_mul_f32 v[154:155], v[154:155], v[40:41]
    v_cvt_pk_bf16_f32 v164, v148, v149
    v_cvt_pk_bf16_f32 v165, v150, v151
    v_cvt_pk_bf16_f32 v166, v152, v153
    v_cvt_pk_bf16_f32 v167, v154, v155
    v_min_u32 v164, -2, v164
    buffer_store_dwordx4 v[164:167], v138, s[52:55], s87 offen offset:0 sc1
    s_waitcnt vmcnt(12)
    v_mfma_f32_16x16x32_bf16 v[2:5], a[192:195], v[184:187], 0
    v_mfma_f32_16x16x32_bf16 v[6:9], a[196:199], v[184:187], 0
    buffer_load_dwordx4 v[228:231], v241, s[52:55], s14 offen offset:2048 sc1
    v_mfma_f32_16x16x32_bf16 v[10:13], a[200:203], v[184:187], 0
    v_mfma_f32_16x16x32_bf16 v[14:17], a[204:207], v[184:187], 0
    v_mfma_f32_16x16x32_bf16 v[18:21], a[208:211], v[184:187], 0
    v_mfma_f32_16x16x32_bf16 v[22:25], a[192:195], v[188:191], 0
    s_add_u32 s14, s80, 12288
    buffer_load_dwordx4 v[84:87], v240, s[52:55], s14 offen offset:0 sc1
    v_mfma_f32_16x16x32_bf16 v[26:29], a[196:199], v[188:191], 0
    s_waitcnt vmcnt(11)
    v_mfma_f32_16x16x32_bf16 v[30:33], a[200:203], v[188:191], 0
    v_mfma_f32_16x16x32_bf16 v[34:37], a[204:207], v[188:191], 0
    v_mfma_f32_16x16x32_bf16 v[38:41], a[208:211], v[188:191], 0
    buffer_load_dwordx4 v[88:91], v241, s[52:55], s14 offen offset:0 sc1
    v_mfma_f32_16x16x32_bf16 v[2:5], a[212:215], v[192:195], v[2:5]
    v_mfma_f32_16x16x32_bf16 v[6:9], a[216:219], v[192:195], v[6:9]
    v_mfma_f32_16x16x32_bf16 v[10:13], a[220:223], v[192:195], v[10:13]
    v_mfma_f32_16x16x32_bf16 v[14:17], a[224:227], v[192:195], v[14:17]
    buffer_load_dwordx4 v[92:95], v240, s[52:55], s14 offen offset:2048 sc1
    v_mfma_f32_16x16x32_bf16 v[18:21], a[228:231], v[192:195], v[18:21]
    v_mfma_f32_16x16x32_bf16 v[22:25], a[212:215], v[196:199], v[22:25]
    v_mfma_f32_16x16x32_bf16 v[26:29], a[216:219], v[196:199], v[26:29]
    s_waitcnt vmcnt(11)
    buffer_load_dwordx4 v[96:99], v241, s[52:55], s14 offen offset:2048 sc1
    v_mfma_f32_16x16x32_bf16 v[30:33], a[220:223], v[196:199], v[30:33]
    v_mfma_f32_16x16x32_bf16 v[34:37], a[224:227], v[196:199], v[34:37]
    v_mfma_f32_16x16x32_bf16 v[38:41], a[228:231], v[196:199], v[38:41]
    v_mfma_f32_16x16x32_bf16 v[2:5], a[232:235], v[200:203], v[2:5]
    v_mfma_f32_16x16x32_bf16 v[6:9], a[236:239], v[200:203], v[6:9]
    s_add_u32 s14, s80, 16384
    buffer_load_dwordx4 v[100:103], v240, s[52:55], s14 offen offset:0 sc1
    v_mfma_f32_16x16x32_bf16 v[10:13], a[0:3], v[200:203], v[10:13]
    v_mfma_f32_16x16x32_bf16 v[14:17], a[4:7], v[200:203], v[14:17]
    v_mfma_f32_16x16x32_bf16 v[18:21], a[8:11], v[200:203], v[18:21]
    v_mfma_f32_16x16x32_bf16 v[22:25], a[232:235], v[204:207], v[22:25]
    buffer_load_dwordx4 v[104:107], v241, s[52:55], s14 offen offset:0 sc1
    v_mfma_f32_16x16x32_bf16 v[26:29], a[236:239], v[204:207], v[26:29]
    s_waitcnt vmcnt(11)
    v_mfma_f32_16x16x32_bf16 v[30:33], a[0:3], v[204:207], v[30:33]
    v_mfma_f32_16x16x32_bf16 v[34:37], a[4:7], v[204:207], v[34:37]
    v_mfma_f32_16x16x32_bf16 v[38:41], a[8:11], v[204:207], v[38:41]
    buffer_load_dwordx4 v[108:111], v240, s[52:55], s14 offen offset:2048 sc1
    v_mfma_f32_16x16x32_bf16 v[2:5], a[12:15], v[208:211], v[2:5]
    v_mfma_f32_16x16x32_bf16 v[6:9], a[16:19], v[208:211], v[6:9]
    v_mfma_f32_16x16x32_bf16 v[10:13], a[20:23], v[208:211], v[10:13]
    v_mfma_f32_16x16x32_bf16 v[14:17], a[24:27], v[208:211], v[14:17]
    buffer_load_dwordx4 v[112:115], v241, s[52:55], s14 offen offset:2048 sc1
    v_mfma_f32_16x16x32_bf16 v[18:21], a[28:31], v[208:211], v[18:21]
    v_mfma_f32_16x16x32_bf16 v[22:25], a[12:15], v[212:215], v[22:25]
    v_mfma_f32_16x16x32_bf16 v[26:29], a[16:19], v[212:215], v[26:29]
    s_waitcnt vmcnt(11)
    s_add_u32 s14, s80, 20480
    buffer_load_dwordx4 v[116:119], v240, s[52:55], s14 offen offset:0 sc1
    v_mfma_f32_16x16x32_bf16 v[30:33], a[20:23], v[212:215], v[30:33]
    v_mfma_f32_16x16x32_bf16 v[34:37], a[24:27], v[212:215], v[34:37]
    v_mfma_f32_16x16x32_bf16 v[38:41], a[28:31], v[212:215], v[38:41]
    v_mfma_f32_16x16x32_bf16 v[2:5], a[32:35], v[216:219], v[2:5]
    v_mfma_f32_16x16x32_bf16 v[6:9], a[36:39], v[216:219], v[6:9]
    buffer_load_dwordx4 v[120:123], v241, s[52:55], s14 offen offset:0 sc1
    v_mfma_f32_16x16x32_bf16 v[10:13], a[40:43], v[216:219], v[10:13]
    v_mfma_f32_16x16x32_bf16 v[14:17], a[44:47], v[216:219], v[14:17]
    v_mfma_f32_16x16x32_bf16 v[18:21], a[48:51], v[216:219], v[18:21]
    v_mfma_f32_16x16x32_bf16 v[22:25], a[32:35], v[220:223], v[22:25]
    buffer_load_dwordx4 v[124:127], v240, s[52:55], s14 offen offset:2048 sc1
    v_mfma_f32_16x16x32_bf16 v[26:29], a[36:39], v[220:223], v[26:29]
    s_waitcnt vmcnt(11)
    v_mfma_f32_16x16x32_bf16 v[30:33], a[40:43], v[220:223], v[30:33]
    v_mfma_f32_16x16x32_bf16 v[34:37], a[44:47], v[220:223], v[34:37]
    v_mfma_f32_16x16x32_bf16 v[38:41], a[48:51], v[220:223], v[38:41]
    buffer_load_dwordx4 v[128:131], v241, s[52:55], s14 offen offset:2048 sc1
    v_mfma_f32_16x16x32_bf16 v[2:5], a[52:55], v[224:227], v[2:5]
    v_mfma_f32_16x16x32_bf16 v[6:9], a[56:59], v[224:227], v[6:9]
    v_mfma_f32_16x16x32_bf16 v[10:13], a[60:63], v[224:227], v[10:13]
    v_mfma_f32_16x16x32_bf16 v[14:17], a[64:67], v[224:227], v[14:17]
    s_add_u32 m0, s82, 143360
    s_add_u32 s3, s81, s82
    buffer_load_dwordx4 v176, s[52:55], s3 offen sc1 lds
    v_mfma_f32_16x16x32_bf16 v[18:21], a[68:71], v[224:227], v[18:21]
    v_mfma_f32_16x16x32_bf16 v[22:25], a[52:55], v[228:231], v[22:25]
    v_mfma_f32_16x16x32_bf16 v[26:29], a[56:59], v[228:231], v[26:29]
    s_waitcnt vmcnt(11)
    s_mov_b32 m0, 147456
    s_add_u32 s3, s81, 4096
    buffer_load_dwordx4 v176, s[52:55], s3 offen sc1 lds
    s_add_u32 s81, s81, 1310720
    v_mfma_f32_16x16x32_bf16 v[30:33], a[60:63], v[228:231], v[30:33]
    v_mfma_f32_16x16x32_bf16 v[34:37], a[64:67], v[228:231], v[34:37]
    v_mfma_f32_16x16x32_bf16 v[38:41], a[68:71], v[228:231], v[38:41]
    v_mfma_f32_16x16x32_bf16 v[2:5], a[72:75], v[84:87], v[2:5]
    s_add_u32 m0, s82, 148480
    s_add_u32 s3, s81, s82
    buffer_load_dwordx4 v176, s[52:55], s3 offen sc1 lds
    v_mfma_f32_16x16x32_bf16 v[6:9], a[76:79], v[84:87], v[6:9]
    v_mfma_f32_16x16x32_bf16 v[10:13], a[80:83], v[84:87], v[10:13]
    v_mfma_f32_16x16x32_bf16 v[14:17], a[84:87], v[84:87], v[14:17]
    v_mfma_f32_16x16x32_bf16 v[18:21], a[88:91], v[84:87], v[18:21]
    s_mov_b32 m0, 152576
    s_add_u32 s3, s81, 4096
    buffer_load_dwordx4 v176, s[52:55], s3 offen sc1 lds
    v_mfma_f32_16x16x32_bf16 v[22:25], a[72:75], v[88:91], v[22:25]
    v_mfma_f32_16x16x32_bf16 v[26:29], a[76:79], v[88:91], v[26:29]
    s_waitcnt vmcnt(12)
    v_mfma_f32_16x16x32_bf16 v[30:33], a[80:83], v[88:91], v[30:33]
    v_mfma_f32_16x16x32_bf16 v[34:37], a[84:87], v[88:91], v[34:37]
    v_mfma_f32_16x16x32_bf16 v[38:41], a[88:91], v[88:91], v[38:41]
    v_mfma_f32_16x16x32_bf16 v[2:5], a[92:95], v[92:95], v[2:5]
    v_mfma_f32_16x16x32_bf16 v[6:9], a[96:99], v[92:95], v[6:9]
    v_mfma_f32_16x16x32_bf16 v[10:13], a[100:103], v[92:95], v[10:13]
    v_mfma_f32_16x16x32_bf16 v[14:17], a[104:107], v[92:95], v[14:17]
    v_mfma_f32_16x16x32_bf16 v[18:21], a[108:111], v[92:95], v[18:21]
    v_mfma_f32_16x16x32_bf16 v[22:25], a[92:95], v[96:99], v[22:25]
    v_mfma_f32_16x16x32_bf16 v[26:29], a[96:99], v[96:99], v[26:29]
    s_waitcnt vmcnt(10)
    v_mfma_f32_16x16x32_bf16 v[30:33], a[100:103], v[96:99], v[30:33]
    v_mfma_f32_16x16x32_bf16 v[34:37], a[104:107], v[96:99], v[34:37]
    v_mfma_f32_16x16x32_bf16 v[38:41], a[108:111], v[96:99], v[38:41]
    v_mfma_f32_16x16x32_bf16 v[2:5], a[112:115], v[100:103], v[2:5]
    v_mfma_f32_16x16x32_bf16 v[6:9], a[116:119], v[100:103], v[6:9]
    s_waitcnt vmcnt(8)
    s_add_u32 s14, s80, 3145728
    buffer_load_dwordx4 v[184:187], v240, s[52:55], s14 offen offset:0 sc1
    v_mfma_f32_16x16x32_bf16 v[10:13], a[120:123], v[100:103], v[10:13]
    v_mfma_f32_16x16x32_bf16 v[14:17], a[124:127], v[100:103], v[14:17]
    v_mfma_f32_16x16x32_bf16 v[18:21], a[128:131], v[100:103], v[18:21]
    s_waitcnt vmcnt(7)
    buffer_load_dwordx4 v[188:191], v241, s[52:55], s14 offen offset:0 sc1
    v_mfma_f32_16x16x32_bf16 v[22:25], a[112:115], v[104:107], v[22:25]
    v_mfma_f32_16x16x32_bf16 v[26:29], a[116:119], v[104:107], v[26:29]
    v_mfma_f32_16x16x32_bf16 v[30:33], a[120:123], v[104:107], v[30:33]
    s_waitcnt vmcnt(6)
    buffer_load_dwordx4 v[192:195], v240, s[52:55], s14 offen offset:2048 sc1
    v_mfma_f32_16x16x32_bf16 v[34:37], a[124:127], v[104:107], v[34:37]
    v_mfma_f32_16x16x32_bf16 v[38:41], a[128:131], v[104:107], v[38:41]
    v_mfma_f32_16x16x32_bf16 v[10:13], a[140:143], v[108:111], v[10:13]
    v_mfma_f32_16x16x32_bf16 v[10:13], a[160:163], v[116:119], v[10:13]
    v_mfma_f32_16x16x32_bf16 v[10:13], a[180:183], v[124:127], v[10:13]
    buffer_load_dwordx4 v[196:199], v241, s[52:55], s14 offen offset:2048 sc1
    v_mfma_f32_16x16x32_bf16 v[14:17], a[144:147], v[108:111], v[14:17]
    v_mfma_f32_16x16x32_bf16 v[14:17], a[164:167], v[116:119], v[14:17]
    v_mfma_f32_16x16x32_bf16 v[14:17], a[184:187], v[124:127], v[14:17]
    v_mfma_f32_16x16x32_bf16 v[22:25], a[132:135], v[112:115], v[22:25]
    s_add_u32 s14, s80, 3149824
    buffer_load_dwordx4 v[200:203], v240, s[52:55], s14 offen offset:0 sc1
    v_mfma_f32_16x16x32_bf16 v[22:25], a[152:155], v[120:123], v[22:25]
    ds_write_b128 v243, v[10:13] offset:0
    v_mfma_f32_16x16x32_bf16 v[22:25], a[172:175], v[128:131], v[22:25]
    v_mfma_f32_16x16x32_bf16 v[26:29], a[136:139], v[112:115], v[26:29]
    buffer_load_dwordx4 v[204:207], v241, s[52:55], s14 offen offset:0 sc1
    v_mfma_f32_16x16x32_bf16 v[26:29], a[156:159], v[120:123], v[26:29]
    ds_write_b128 v243, v[14:17] offset:1024
    v_mfma_f32_16x16x32_bf16 v[26:29], a[176:179], v[128:131], v[26:29]
    v_mfma_f32_16x16x32_bf16 v[30:33], a[140:143], v[112:115], v[30:33]
    buffer_load_dwordx4 v[208:211], v240, s[52:55], s14 offen offset:2048 sc1
    v_mfma_f32_16x16x32_bf16 v[30:33], a[160:163], v[120:123], v[30:33]
    ds_write_b128 v244, v[22:25] offset:0
    v_mfma_f32_16x16x32_bf16 v[30:33], a[180:183], v[128:131], v[30:33]
    v_mfma_f32_16x16x32_bf16 v[34:37], a[144:147], v[112:115], v[34:37]
    buffer_load_dwordx4 v[212:215], v241, s[52:55], s14 offen offset:2048 sc1
    v_mfma_f32_16x16x32_bf16 v[34:37], a[164:167], v[120:123], v[34:37]
    ds_write_b128 v244, v[26:29] offset:1024
    v_mfma_f32_16x16x32_bf16 v[34:37], a[184:187], v[128:131], v[34:37]
    v_mfma_f32_16x16x32_bf16 v[18:21], a[148:151], v[108:111], v[18:21]
    s_add_u32 s14, s80, 3153920
    buffer_load_dwordx4 v[216:219], v240, s[52:55], s14 offen offset:0 sc1
    v_mfma_f32_16x16x32_bf16 v[18:21], a[168:171], v[116:119], v[18:21]
    ds_write_b128 v245, v[30:33] offset:0
    v_mfma_f32_16x16x32_bf16 v[18:21], a[188:191], v[124:127], v[18:21]
    v_mfma_f32_16x16x32_bf16 v[38:41], a[148:151], v[112:115], v[38:41]
    buffer_load_dwordx4 v[220:223], v241, s[52:55], s14 offen offset:0 sc1
    v_mfma_f32_16x16x32_bf16 v[38:41], a[168:171], v[120:123], v[38:41]
    ds_write_b128 v245, v[34:37] offset:1024
    v_mfma_f32_16x16x32_bf16 v[38:41], a[188:191], v[128:131], v[38:41]
    v_mfma_f32_16x16x32_bf16 v[2:5], a[132:135], v[108:111], v[2:5]
    buffer_load_dwordx4 v[224:227], v240, s[52:55], s14 offen offset:2048 sc1
    v_mfma_f32_16x16x32_bf16 v[2:5], a[152:155], v[116:119], v[2:5]
    ds_write_b128 v247, v[18:21] offset:0
    v_mfma_f32_16x16x32_bf16 v[2:5], a[172:175], v[124:127], v[2:5]
    v_mfma_f32_16x16x32_bf16 v[6:9], a[136:139], v[108:111], v[6:9]
    v_mfma_f32_16x16x32_bf16 v[6:9], a[156:159], v[116:119], v[6:9]
    s_nop 0
    ds_write_b128 v248, v[38:41] offset:0
    buffer_load_dwordx4 v[228:231], v241, s[52:55], s14 offen offset:2048 sc1
    v_mfma_f32_16x16x32_bf16 v[6:9], a[176:179], v[124:127], v[6:9]
    s_waitcnt vmcnt(10)
    v_max_u32 v82, v184, v188
    v_cmp_eq_u32 vcc, -1, v82
    s_nop 1
    s_cbranch_vccnz L_slow_33
L_back_34:
    v_mfma_f32_16x16x32_bf16 v[42:45], a[192:195], v[184:187], 0
    s_add_u32 s14, s80, 3158016
    buffer_load_dwordx4 v[84:87], v240, s[52:55], s14 offen offset:0 sc1
    v_mfma_f32_16x16x32_bf16 v[46:49], a[196:199], v[184:187], 0
    v_lshlrev_b32 v158, 16, v234
    v_mfma_f32_16x16x32_bf16 v[50:53], a[200:203], v[184:187], 0
    v_and_b32 v159, 0xffff0000, v234
    v_lshlrev_b32 v160, 16, v235
    v_mfma_f32_16x16x32_bf16 v[54:57], a[204:207], v[184:187], 0
    v_and_b32 v161, 0xffff0000, v235
    v_lshlrev_b32 v162, 16, v236
    v_mfma_f32_16x16x32_bf16 v[58:61], a[208:211], v[184:187], 0
    buffer_load_dwordx4 v[88:91], v241, s[52:55], s14 offen offset:0 sc1
    v_mfma_f32_16x16x32_bf16 v[62:65], a[192:195], v[188:191], 0
    v_and_b32 v163, 0xffff0000, v236
    v_add_f32 v2, v2, v162
    v_mfma_f32_16x16x32_bf16 v[66:69], a[196:199], v[188:191], 0
    s_waitcnt vmcnt(10)
    v_max_u32 v82, v192, v196
    v_cmp_eq_u32 vcc, -1, v82
    v_mfma_f32_16x16x32_bf16 v[70:73], a[200:203], v[188:191], 0
    v_add_f32 v3, v3, v163
    v_lshlrev_b32 v162, 16, v237
    v_mfma_f32_16x16x32_bf16 v[74:77], a[204:207], v[188:191], 0
    s_cbranch_vccnz L_slow_35
L_back_36:
    buffer_load_dwordx4 v[92:95], v240, s[52:55], s14 offen offset:2048 sc1
    v_mfma_f32_16x16x32_bf16 v[78:81], a[208:211], v[188:191], 0
    v_and_b32 v163, 0xffff0000, v237
    v_add_f32 v4, v4, v162
    v_mfma_f32_16x16x32_bf16 v[42:45], a[212:215], v[192:195], v[42:45]
    v_add_f32 v5, v5, v163
    v_lshlrev_b32 v162, 16, v238
    v_mfma_f32_16x16x32_bf16 v[46:49], a[216:219], v[192:195], v[46:49]
    v_and_b32 v163, 0xffff0000, v238
    v_add_f32 v6, v6, v162
    v_mfma_f32_16x16x32_bf16 v[50:53], a[220:223], v[192:195], v[50:53]
    buffer_load_dwordx4 v[96:99], v241, s[52:55], s14 offen offset:2048 sc1
    v_mfma_f32_16x16x32_bf16 v[54:57], a[224:227], v[192:195], v[54:57]
    v_add_f32 v7, v7, v163
    v_lshlrev_b32 v162, 16, v239
    v_mfma_f32_16x16x32_bf16 v[58:61], a[228:231], v[192:195], v[58:61]
    v_and_b32 v163, 0xffff0000, v239
    v_add_f32 v8, v8, v162
    v_mfma_f32_16x16x32_bf16 v[62:65], a[212:215], v[196:199], v[62:65]
    v_add_f32 v9, v9, v163
    s_waitcnt lgkmcnt(0)
    s_barrier
    ds_read_b64_tr_b16 v[152:153], v250 offset:0
    ds_read_b64_tr_b16 v[154:155], v250 offset:256
    v_mfma_f32_16x16x32_bf16 v[66:69], a[216:219], v[196:199], v[66:69]
    s_waitcnt vmcnt(10)
    v_max_u32 v82, v200, v204
    v_cmp_eq_u32 vcc, -1, v82
    s_add_u32 s14, s80, 3162112
    buffer_load_dwordx4 v[100:103], v240, s[52:55], s14 offen offset:0 sc1
    v_mfma_f32_16x16x32_bf16 v[70:73], a[220:223], v[196:199], v[70:73]
    ds_read_b64_tr_b16 v[156:157], v251 offset:0
    ds_read_b128 v[10:13], v246 offset:0
    v_mfma_f32_16x16x32_bf16 v[74:77], a[224:227], v[196:199], v[74:77]
    s_cbranch_vccnz L_slow_37
L_back_38:
    buffer_load_dwordx4 v[104:107], v241, s[52:55], s14 offen offset:0 sc1
    v_mfma_f32_16x16x32_bf16 v[78:81], a[228:231], v[196:199], v[78:81]
    ds_read_b128 v[14:17], v246 offset:1024
    ds_read_b128 v[18:21], v246 offset:2048
    v_mfma_f32_16x16x32_bf16 v[42:45], a[232:235], v[200:203], v[42:45]
    ds_read_b128 v[22:25], v246 offset:3072
    ds_read_b128 v[26:29], v246 offset:4096
    v_mfma_f32_16x16x32_bf16 v[46:49], a[236:239], v[200:203], v[46:49]
    ds_read_b128 v[30:33], v246 offset:5120
    ds_read_b128 v[34:37], v249 offset:0
    v_mfma_f32_16x16x32_bf16 v[50:53], a[0:3], v[200:203], v[50:53]
    buffer_load_dwordx4 v[108:111], v240, s[52:55], s14 offen offset:2048 sc1
    v_mfma_f32_16x16x32_bf16 v[54:57], a[4:7], v[200:203], v[54:57]
    ds_read_b128 v[38:41], v249 offset:1024
    ds_read_b128 v[144:147], v249 offset:2048
    v_mfma_f32_16x16x32_bf16 v[58:61], a[8:11], v[200:203], v[58:61]
    ds_read_b128 v[148:151], v249 offset:3072
    v_mfma_f32_16x16x32_bf16 v[62:65], a[232:235], v[204:207], v[62:65]
    v_mfma_f32_16x16x32_bf16 v[66:69], a[236:239], v[204:207], v[66:69]
    s_waitcnt vmcnt(11)
    v_max_u32 v82, v208, v212
    v_cmp_eq_u32 vcc, -1, v82
    buffer_load_dwordx4 v[112:115], v241, s[52:55], s14 offen offset:2048 sc1
    v_mfma_f32_16x16x32_bf16 v[70:73], a[0:3], v[204:207], v[70:73]
    s_waitcnt lgkmcnt(10)
    v_lshlrev_b32 v162, 16, v152
    v_mfma_f32_16x16x32_bf16 v[74:77], a[4:7], v[204:207], v[74:77]
    s_cbranch_vccnz L_slow_39
L_back_40:
    v_mfma_f32_16x16x32_bf16 v[78:81], a[8:11], v[204:207], v[78:81]
    v_and_b32 v163, 0xffff0000, v152
    v_add_f32 v2, v2, v162
    v_mfma_f32_16x16x32_bf16 v[42:45], a[12:15], v[208:211], v[42:45]
    s_add_u32 s14, s80, 3166208
    buffer_load_dwordx4 v[116:119], v240, s[52:55], s14 offen offset:0 sc1
    v_mfma_f32_16x16x32_bf16 v[46:49], a[16:19], v[208:211], v[46:49]
    v_add_f32 v3, v3, v163
    v_lshlrev_b32 v162, 16, v153
    v_mfma_f32_16x16x32_bf16 v[50:53], a[20:23], v[208:211], v[50:53]
    v_and_b32 v163, 0xffff0000, v153
    v_add_f32 v4, v4, v162
    v_mfma_f32_16x16x32_bf16 v[54:57], a[24:27], v[208:211], v[54:57]
    v_add_f32 v5, v5, v163
    v_lshlrev_b32 v162, 16, v154
    v_mfma_f32_16x16x32_bf16 v[58:61], a[28:31], v[208:211], v[58:61]
    buffer_load_dwordx4 v[120:123], v241, s[52:55], s14 offen offset:0 sc1
    v_mfma_f32_16x16x32_bf16 v[62:65], a[12:15], v[212:215], v[62:65]
    v_and_b32 v163, 0xffff0000, v154
    v_add_f32 v6, v6, v162
    v_mfma_f32_16x16x32_bf16 v[66:69], a[16:19], v[212:215], v[66:69]
    s_waitcnt vmcnt(12)
    v_max_u32 v82, v216, v220
    v_cmp_eq_u32 vcc, -1, v82
    v_mfma_f32_16x16x32_bf16 v[70:73], a[20:23], v[212:215], v[70:73]
    v_add_f32 v7, v7, v163
    v_lshlrev_b32 v162, 16, v155
    v_mfma_f32_16x16x32_bf16 v[74:77], a[24:27], v[212:215], v[74:77]
    s_cbranch_vccnz L_slow_41
L_back_42:
    buffer_load_dwordx4 v[124:127], v240, s[52:55], s14 offen offset:2048 sc1
    v_mfma_f32_16x16x32_bf16 v[78:81], a[28:31], v[212:215], v[78:81]
    v_and_b32 v163, 0xffff0000, v155
    v_add_f32 v8, v8, v162
    v_mfma_f32_16x16x32_bf16 v[42:45], a[32:35], v[216:219], v[42:45]
    v_add_f32 v9, v9, v163
    v_lshlrev_b32 v162, 16, v156
    v_mfma_f32_16x16x32_bf16 v[46:49], a[36:39], v[216:219], v[46:49]
    v_and_b32 v163, 0xffff0000, v156
    v_add_f32 v158, v158, v162
    v_mfma_f32_16x16x32_bf16 v[50:53], a[40:43], v[216:219], v[50:53]
    buffer_load_dwordx4 v[128:131], v241, s[52:55], s14 offen offset:2048 sc1
    v_mfma_f32_16x16x32_bf16 v[54:57], a[44:47], v[216:219], v[54:57]
    v_add_f32 v159, v159, v163
    v_lshlrev_b32 v162, 16, v157
    v_mfma_f32_16x16x32_bf16 v[58:61], a[48:51], v[216:219], v[58:61]
    v_and_b32 v163, 0xffff0000, v157
    v_add_f32 v160, v160, v162
    v_mfma_f32_16x16x32_bf16 v[62:65], a[32:35], v[220:223], v[62:65]
    v_add_f32 v161, v161, v163
    s_waitcnt lgkmcnt(8)
    v_mfma_f32_16x16x32_bf16 v[66:69], a[36:39], v[220:223], v[66:69]
    s_waitcnt vmcnt(12)
    v_max_u32 v82, v224, v228
    v_cmp_eq_u32 vcc, -1, v82
    v_mfma_f32_16x16x32_bf16 v[70:73], a[40:43], v[220:223], v[70:73]
    v_add_f32 v2, v2, v10
    v_add_f32 v3, v3, v11
    v_mfma_f32_16x16x32_bf16 v[74:77], a[44:47], v[220:223], v[74:77]
    s_cbranch_vccnz L_slow_43
L_back_44:
    v_mfma_f32_16x16x32_bf16 v[78:81], a[48:51], v[220:223], v[78:81]
    v_add_f32 v4, v4, v12
    v_add_f32 v5, v5, v13
    v_mfma_f32_16x16x32_bf16 v[42:45], a[52:55], v[224:227], v[42:45]
    v_add_f32 v6, v6, v14
    v_add_f32 v7, v7, v15
    v_mfma_f32_16x16x32_bf16 v[46:49], a[56:59], v[224:227], v[46:49]
    v_add_f32 v8, v8, v16
    v_add_f32 v9, v9, v17
    v_mfma_f32_16x16x32_bf16 v[50:53], a[60:63], v[224:227], v[50:53]
    s_waitcnt lgkmcnt(6)
    v_add_f32 v2, v2, v18
    v_mfma_f32_16x16x32_bf16 v[54:57], a[64:67], v[224:227], v[54:57]
    v_add_f32 v3, v3, v19
    v_add_f32 v4, v4, v20
    v_mfma_f32_16x16x32_bf16 v[58:61], a[68:71], v[224:227], v[58:61]
    v_add_f32 v5, v5, v21
    v_add_f32 v6, v6, v22
    v_mfma_f32_16x16x32_bf16 v[62:65], a[52:55], v[228:231], v[62:65]
    v_add_f32 v7, v7, v23
    v_add_f32 v8, v8, v24
    v_mfma_f32_16x16x32_bf16 v[66:69], a[56:59], v[228:231], v[66:69]
    s_waitcnt vmcnt(10)
    v_max_u32 v82, v84, v88
    v_cmp_eq_u32 vcc, -1, v82
    v_mfma_f32_16x16x32_bf16 v[70:73], a[60:63], v[228:231], v[70:73]
    v_add_f32 v9, v9, v25
    s_waitcnt lgkmcnt(4)
    v_mfma_f32_16x16x32_bf16 v[74:77], a[64:67], v[228:231], v[74:77]
    s_cbranch_vccnz L_slow_45
L_back_46:
    v_mfma_f32_16x16x32_bf16 v[78:81], a[68:71], v[228:231], v[78:81]
    v_add_f32 v2, v2, v26
    v_add_f32 v3, v3, v27
    v_mfma_f32_16x16x32_bf16 v[42:45], a[72:75], v[84:87], v[42:45]
    v_add_f32 v4, v4, v28
    v_add_f32 v5, v5, v29
    v_mfma_f32_16x16x32_bf16 v[46:49], a[76:79], v[84:87], v[46:49]
    v_add_f32 v6, v6, v30
    v_add_f32 v7, v7, v31
    v_mfma_f32_16x16x32_bf16 v[50:53], a[80:83], v[84:87], v[50:53]
    v_add_f32 v8, v8, v32
    v_add_f32 v9, v9, v33
    v_mfma_f32_16x16x32_bf16 v[54:57], a[84:87], v[84:87], v[54:57]
    s_nop 0
    v_cvt_pk_bf16_f32 v164, v2, v3
    v_cvt_pk_bf16_f32 v165, v4, v5
    v_mfma_f32_16x16x32_bf16 v[58:61], a[88:91], v[84:87], v[58:61]
    v_cvt_pk_bf16_f32 v166, v6, v7
    v_cvt_pk_bf16_f32 v167, v8, v9
    v_mfma_f32_16x16x32_bf16 v[62:65], a[72:75], v[88:91], v[62:65]
    buffer_store_dwordx4 v[164:167], v252, s[56:59], s84 offen
    s_waitcnt lgkmcnt(0)
    v_mfma_f32_16x16x32_bf16 v[66:69], a[76:79], v[88:91], v[66:69]
    s_waitcnt vmcnt(9)
    v_max_u32 v82, v92, v96
    v_cmp_eq_u32 vcc, -1, v82
    v_mfma_f32_16x16x32_bf16 v[70:73], a[80:83], v[88:91], v[70:73]
    v_add_f32 v158, v158, v34
    v_add_f32 v159, v159, v35
    v_mfma_f32_16x16x32_bf16 v[74:77], a[84:87], v[88:91], v[74:77]
    s_cbranch_vccnz L_slow_47
L_back_48:
    v_mfma_f32_16x16x32_bf16 v[78:81], a[88:91], v[88:91], v[78:81]
    v_add_f32 v160, v160, v36
    v_add_f32 v161, v161, v37
    v_mfma_f32_16x16x32_bf16 v[42:45], a[92:95], v[92:95], v[42:45]
    v_add_f32 v158, v158, v38
    v_add_f32 v159, v159, v39
    v_mfma_f32_16x16x32_bf16 v[46:49], a[96:99], v[92:95], v[46:49]
    v_add_f32 v160, v160, v40
    v_add_f32 v161, v161, v41
    v_mfma_f32_16x16x32_bf16 v[50:53], a[100:103], v[92:95], v[50:53]
    v_add_f32 v158, v158, v144
    v_add_f32 v159, v159, v145
    v_mfma_f32_16x16x32_bf16 v[54:57], a[104:107], v[92:95], v[54:57]
    v_add_f32 v160, v160, v146
    v_add_f32 v161, v161, v147
    v_mfma_f32_16x16x32_bf16 v[58:61], a[108:111], v[92:95], v[58:61]
    v_add_f32 v158, v158, v148
    v_add_f32 v159, v159, v149
    v_mfma_f32_16x16x32_bf16 v[62:65], a[92:95], v[96:99], v[62:65]
    v_add_f32 v160, v160, v150
    v_add_f32 v161, v161, v151
    v_mfma_f32_16x16x32_bf16 v[66:69], a[96:99], v[96:99], v[66:69]
    s_waitcnt vmcnt(7)
    v_max_u32 v82, v100, v104
    v_cmp_eq_u32 vcc, -1, v82
    v_mfma_f32_16x16x32_bf16 v[70:73], a[100:103], v[96:99], v[70:73]
    v_cvt_pk_bf16_f32 v162, v158, v159
    v_cvt_pk_bf16_f32 v163, v160, v161
    v_mfma_f32_16x16x32_bf16 v[74:77], a[104:107], v[96:99], v[74:77]
    s_cbranch_vccnz L_slow_49
L_back_50:
    v_mfma_f32_16x16x32_bf16 v[78:81], a[108:111], v[96:99], v[78:81]
    s_mov_b64 exec, s[90:91]
    buffer_store_dwordx2 v[162:163], v253, s[56:59], s84 offen
    s_mov_b64 exec, -1
    s_add_u32 s84, s84, 1310720
    v_mfma_f32_16x16x32_bf16 v[42:45], a[112:115], v[100:103], v[42:45]
    v_mfma_f32_16x16x32_bf16 v[46:49], a[116:119], v[100:103], v[46:49]
    s_waitcnt vmcnt(6)
    v_max_u32 v82, v108, v112
    v_cmp_eq_u32 vcc, -1, v82
    v_mfma_f32_16x16x32_bf16 v[50:53], a[120:123], v[100:103], v[50:53]
    v_mfma_f32_16x16x32_bf16 v[54:57], a[124:127], v[100:103], v[54:57]
    s_cbranch_vccnz L_slow_51
L_back_52:
    v_mfma_f32_16x16x32_bf16 v[58:61], a[128:131], v[100:103], v[58:61]
    s_waitcnt vmcnt(4)
    v_max_u32 v82, v116, v120
    v_cmp_eq_u32 vcc, -1, v82
    v_mfma_f32_16x16x32_bf16 v[62:65], a[112:115], v[104:107], v[62:65]
    v_mfma_f32_16x16x32_bf16 v[66:69], a[116:119], v[104:107], v[66:69]
    s_cbranch_vccnz L_slow_53
L_back_54:
    v_mfma_f32_16x16x32_bf16 v[70:73], a[120:123], v[104:107], v[70:73]
    s_waitcnt vmcnt(2)
    v_max_u32 v82, v124, v128
    v_cmp_eq_u32 vcc, -1, v82
    v_mfma_f32_16x16x32_bf16 v[74:77], a[124:127], v[104:107], v[74:77]
    v_mfma_f32_16x16x32_bf16 v[78:81], a[128:131], v[104:107], v[78:81]
    s_cbranch_vccnz L_slow_55
L_back_56:
    v_mfma_f32_16x16x32_bf16 v[50:53], a[140:143], v[108:111], v[50:53]
    v_mfma_f32_16x16x32_bf16 v[50:53], a[160:163], v[116:119], v[50:53]
    v_mfma_f32_16x16x32_bf16 v[50:53], a[180:183], v[124:127], v[50:53]
    v_mfma_f32_16x16x32_bf16 v[54:57], a[144:147], v[108:111], v[54:57]
    v_mfma_f32_16x16x32_bf16 v[54:57], a[164:167], v[116:119], v[54:57]
    v_mfma_f32_16x16x32_bf16 v[54:57], a[184:187], v[124:127], v[54:57]
    v_mfma_f32_16x16x32_bf16 v[62:65], a[132:135], v[112:115], v[62:65]
    v_mfma_f32_16x16x32_bf16 v[62:65], a[152:155], v[120:123], v[62:65]
    s_nop 2
    ds_write_b128 v243, v[50:53] offset:32768
    v_mfma_f32_16x16x32_bf16 v[62:65], a[172:175], v[128:131], v[62:65]
    v_mfma_f32_16x16x32_bf16 v[66:69], a[136:139], v[112:115], v[66:69]
    v_mfma_f32_16x16x32_bf16 v[66:69], a[156:159], v[120:123], v[66:69]
    ds_write_b128 v243, v[54:57] offset:33792
    v_mfma_f32_16x16x32_bf16 v[66:69], a[176:179], v[128:131], v[66:69]
    v_mfma_f32_16x16x32_bf16 v[70:73], a[140:143], v[112:115], v[70:73]
    v_mfma_f32_16x16x32_bf16 v[70:73], a[160:163], v[120:123], v[70:73]
    s_nop 1
    ds_write_b128 v244, v[62:65] offset:32768
    v_mfma_f32_16x16x32_bf16 v[70:73], a[180:183], v[128:131], v[70:73]
    v_mfma_f32_16x16x32_bf16 v[74:77], a[144:147], v[112:115], v[74:77]
    v_mfma_f32_16x16x32_bf16 v[74:77], a[164:167], v[120:123], v[74:77]
    ds_write_b128 v244, v[66:69] offset:33792
    v_mfma_f32_16x16x32_bf16 v[74:77], a[184:187], v[128:131], v[74:77]
    v_mfma_f32_16x16x32_bf16 v[58:61], a[148:151], v[108:111], v[58:61]
    v_mfma_f32_16x16x32_bf16 v[58:61], a[168:171], v[116:119], v[58:61]
    s_nop 1
    ds_write_b128 v245, v[70:73] offset:32768
    v_mfma_f32_16x16x32_bf16 v[58:61], a[188:191], v[124:127], v[58:61]
    v_mfma_f32_16x16x32_bf16 v[78:81], a[148:151], v[112:115], v[78:81]
    v_mfma_f32_16x16x32_bf16 v[78:81], a[168:171], v[120:123], v[78:81]
    ds_write_b128 v245, v[74:77] offset:33792
    v_mfma_f32_16x16x32_bf16 v[78:81], a[188:191], v[128:131], v[78:81]
    v_mfma_f32_16x16x32_bf16 v[42:45], a[132:135], v[108:111], v[42:45]
    v_mfma_f32_16x16x32_bf16 v[42:45], a[152:155], v[116:119], v[42:45]
    s_nop 1
    ds_write_b128 v247, v[58:61] offset:32768
    v_mfma_f32_16x16x32_bf16 v[42:45], a[172:175], v[124:127], v[42:45]
    v_mfma_f32_16x16x32_bf16 v[46:49], a[136:139], v[108:111], v[46:49]
    v_mfma_f32_16x16x32_bf16 v[46:49], a[156:159], v[116:119], v[46:49]
    ds_write_b128 v248, v[78:81] offset:32768
    v_mfma_f32_16x16x32_bf16 v[46:49], a[176:179], v[124:127], v[46:49]
    v_lshlrev_b32 v158, 16, v234
    v_and_b32 v159, 0xffff0000, v234
    v_lshlrev_b32 v160, 16, v235
    v_and_b32 v161, 0xffff0000, v235
    v_lshlrev_b32 v162, 16, v236
    v_and_b32 v163, 0xffff0000, v236
    v_pk_add_f32 v[42:43], v[42:43], v[162:163]
    v_lshlrev_b32 v162, 16, v237
    v_and_b32 v163, 0xffff0000, v237
    v_pk_add_f32 v[44:45], v[44:45], v[162:163]
    v_lshlrev_b32 v162, 16, v238
    v_and_b32 v163, 0xffff0000, v238
    v_pk_add_f32 v[46:47], v[46:47], v[162:163]
    v_lshlrev_b32 v162, 16, v239
    v_and_b32 v163, 0xffff0000, v239
    v_pk_add_f32 v[48:49], v[48:49], v[162:163]
    s_waitcnt lgkmcnt(0)
    s_barrier
    s_nop 0
    ds_read_b64_tr_b16 v[152:153], v250 offset:5120
    ds_read_b64_tr_b16 v[154:155], v250 offset:5376
    ds_read_b64_tr_b16 v[156:157], v251 offset:5120
    ds_read_b128 v[50:53], v246 offset:32768
    ds_read_b128 v[54:57], v246 offset:33792
    ds_read_b128 v[58:61], v246 offset:34816
    ds_read_b128 v[62:65], v246 offset:35840
    ds_read_b128 v[66:69], v246 offset:36864
    ds_read_b128 v[70:73], v246 offset:37888
    ds_read_b128 v[74:77], v249 offset:32768
    ds_read_b128 v[78:81], v249 offset:33792
    ds_read_b128 v[144:147], v249 offset:34816
    ds_read_b128 v[148:151], v249 offset:35840
    s_waitcnt lgkmcnt(10)
    v_lshlrev_b32 v162, 16, v152
    v_and_b32 v163, 0xffff0000, v152
    v_pk_add_f32 v[42:43], v[42:43], v[162:163]
    v_lshlrev_b32 v162, 16, v153
    v_and_b32 v163, 0xffff0000, v153
    v_pk_add_f32 v[44:45], v[44:45], v[162:163]
    v_lshlrev_b32 v162, 16, v154
    v_and_b32 v163, 0xffff0000, v154
    v_pk_add_f32 v[46:47], v[46:47], v[162:163]
    v_lshlrev_b32 v162, 16, v155
    v_and_b32 v163, 0xffff0000, v155
    v_pk_add_f32 v[48:49], v[48:49], v[162:163]
    v_lshlrev_b32 v162, 16, v156
    v_and_b32 v163, 0xffff0000, v156
    v_pk_add_f32 v[158:159], v[158:159], v[162:163]
    v_lshlrev_b32 v162, 16, v157
    v_and_b32 v163, 0xffff0000, v157
    v_pk_add_f32 v[160:161], v[160:161], v[162:163]
    s_waitcnt lgkmcnt(8)
    v_pk_add_f32 v[42:43], v[42:43], v[50:51]
    v_pk_add_f32 v[44:45], v[44:45], v[52:53]
    v_pk_add_f32 v[46:47], v[46:47], v[54:55]
    v_pk_add_f32 v[48:49], v[48:49], v[56:57]
    s_waitcnt lgkmcnt(6)
    v_pk_add_f32 v[42:43], v[42:43], v[58:59]
    v_pk_add_f32 v[44:45], v[44:45], v[60:61]
    v_pk_add_f32 v[46:47], v[46:47], v[62:63]
    v_pk_add_f32 v[48:49], v[48:49], v[64:65]
    s_waitcnt lgkmcnt(4)
    v_pk_add_f32 v[42:43], v[42:43], v[66:67]
    v_pk_add_f32 v[44:45], v[44:45], v[68:69]
    v_pk_add_f32 v[46:47], v[46:47], v[70:71]
    v_pk_add_f32 v[48:49], v[48:49], v[72:73]
    v_cvt_pk_bf16_f32 v164, v42, v43
    v_cvt_pk_bf16_f32 v165, v44, v45
    v_cvt_pk_bf16_f32 v166, v46, v47
    v_cvt_pk_bf16_f32 v167, v48, v49
    buffer_store_dwordx4 v[164:167], v252, s[56:59], s84 offen
    s_waitcnt lgkmcnt(0)
    s_nop 0
    v_pk_add_f32 v[158:159], v[158:159], v[74:75]
    v_pk_add_f32 v[160:161], v[160:161], v[76:77]
    v_pk_add_f32 v[158:159], v[158:159], v[78:79]
    v_pk_add_f32 v[160:161], v[160:161], v[80:81]
    v_pk_add_f32 v[158:159], v[158:159], v[144:145]
    v_pk_add_f32 v[160:161], v[160:161], v[146:147]
    v_pk_add_f32 v[158:159], v[158:159], v[148:149]
    v_pk_add_f32 v[160:161], v[160:161], v[150:151]
    v_cvt_pk_bf16_f32 v162, v158, v159
    v_cvt_pk_bf16_f32 v163, v160, v161
    s_mov_b64 exec, s[90:91]
    buffer_store_dwordx2 v[162:163], v253, s[56:59], s84 offen
    s_mov_b64 exec, -1
    s_add_u32 s84, s84, 1310720
    s_xor_b32 s3, s60, 3
    s_or_b32 s3, s3, s61
    s_cmp_lg_u32 s3, 0
    s_cbranch_scc1 L_noep
    v_mov_b32 v2, 0
    v_mov_b32 v3, s71
    s_mov_b64 exec, 1
    buffer_store_dword v3, v2, s[52:55], 0 offen sc1
    s_mov_b64 exec, -1
L_noep:
L_end:
    s_endpgm
L_fail:
    v_mov_b32 v2, 0
    v_mov_b32 v3, 0xdead
    global_store_dword v2, v3, s[34:35]
    s_endpgm
L_w3body:
    s_mov_b32 s44, s24
    s_mov_b32 s45, s25
    s_mov_b32 s46, 1966080
    s_mov_b32 s47, 0x20000
    s_mov_b32 s48, s28
    s_mov_b32 s49, s29
    s_mov_b32 s50, 1966080
    s_mov_b32 s51, 0x20000
    s_min_u32 s73, s61, 239
    s_mul_i32 s20, s73, 171
    s_lshr_b32 s20, s20, 12
    s_mul_i32 s21, s20, 24
    s_sub_u32 s21, s73, s21
    s_mul_i32 s22, s73, 205
    s_lshr_b32 s22, s22, 10
    s_mul_i32 s23, s22, 5
    s_sub_u32 s23, s73, s23
    v_mul_u32_u24 v9, 3072, v8
    v_lshl_add_u32 v9, v10, 4, v9
    v_lshrrev_b32 v11, 4, v1
    v_mul_u32_u24 v7, 1280, v11
    v_and_b32 v60, 15, v1
    v_lshl_add_u32 v7, v60, 4, v7
    s_mul_i32 s82, s20, 196608
    s_lshl_b32 s75, s21, 7
    s_add_u32 s82, s82, s75
    s_mul_i32 s91, s22, 40960
    s_lshl_b32 s75, s23, 8
    s_add_u32 s91, s91, s75
    s_mul_i32 s28, s20, 6144
    s_lshl_b32 s77, s21, 8
    s_add_u32 s28, s28, s77
    s_add_u32 s28, s28, 65536
    v_bfe_u32 v56, v1, 2, 2
    v_bfe_u32 v59, v1, 4, 1
    v_lshl_add_u32 v54, v59, 3, v56
    v_lshlrev_b32 v54, 6, v54
    v_lshl_add_u32 v54, v57, 3, v54
    v_lshrrev_b32 v58, 5, v1
    v_mul_u32_u24 v58, 5120, v58
    v_add_u32 v54, v54, v58
    v_add_u32 v54, 77824, v54
    v_lshlrev_b32 v55, 12, v60
    v_lshl_add_u32 v55, v11, 4, v55
    v_lshrrev_b32 v58, 5, v1
    v_lshl_add_u32 v58, v58, 3, v56
    v_lshlrev_b32 v58, 7, v58
    v_lshl_add_u32 v58, v59, 5, v58
    v_lshl_add_u32 v58, v57, 3, v58
    v_add_u32 v58, 88064, v58
    v_lshrrev_b32 v70, 2, v1
    v_mul_u32_u24 v70, 4224, v70
    v_lshl_add_u32 v70, v57, 4, v70
    v_add_u32 v70, 52480, v70
    v_mov_b32 v72, 0
    v_mov_b32 v73, 0
    v_mov_b32 v74, 0
    v_mov_b32 v75, 0
    v_mov_b32 v76, 0
    v_mov_b32 v77, 0
    v_mov_b32 v78, 0
    v_mov_b32 v79, 0
    s_mov_b64 exec, 0xffffff
    ds_write_b128 v70, v[72:75]
    s_mov_b64 exec, -1
    s_mul_i32 s72, s63, 655360
    s_lshl_b32 s73, s62, 6
    s_add_u32 s72, s72, s73
    s_add_u32 s92, s72, 1048576
    s_mul_i32 s93, s61, 512
    s_add_u32 s93, s93, 262144
    s_lshl_b32 s90, s61, 9
    s_add_u32 s90, s90, 131072
    v_lshlrev_b32 v176, 4, v1
    v_lshlrev_b32 v180, 2, v1
    v_mov_b32 v120, v54
    v_mov_b32 v121, v55
    s_and_b32 s3, s2, 7
    s_lshr_b32 s72, s2, 3
    s_lshr_b32 s67, s3, 1
    s_lshl_b32 s67, s67, 2
    s_lshr_b32 s73, s72, 3
    s_add_u32 s67, s67, s73
    s_and_b32 s68, s3, 1
    s_lshl_b32 s68, s68, 3
    s_and_b32 s74, s72, 7
    s_add_u32 s68, s68, s74
    s_lshr_b32 s67, s3, 2
    s_lshl_b32 s67, s67, 3
    s_lshr_b32 s75, s72, 2
    s_add_u32 s67, s67, s75
    s_and_b32 s68, s3, 3
    s_lshl_b32 s68, s68, 2
    s_and_b32 s75, s72, 3
    s_add_u32 s68, s68, s75
    s_lshr_b32 s69, s3, 1
    s_lshl_b32 s69, s69, 3
    s_lshr_b32 s73, s72, 2
    s_add_u32 s69, s69, s73
    s_and_b32 s70, s3, 1
    s_lshl_b32 s70, s70, 2
    s_and_b32 s74, s72, 3
    s_add_u32 s70, s70, s74
    s_mov_b32 s56, s32
    s_mov_b32 s57, s33
    s_mov_b32 s58, 2621440
    s_mov_b32 s59, 0x20000
    s_lshr_b32 s72, s60, 1
    s_and_b32 s73, s60, 1
    v_and_b32 v52, 15, v1
    v_lshrrev_b32 v53, 4, v1
    v_and_b32 v54, 1, v1
    v_mul_u32_u24 v55, 4576, v54
    v_lshl_add_u32 v55, v53, 4, v55
    v_lshrrev_b32 v56, 1, v52
    v_lshl_add_u32 v166, v56, 6, v55
    v_xor_b32 v56, s73, v56
    v_lshl_add_u32 v164, v56, 6, v55
    v_xor_b32 v54, 1, v54
    v_mul_u32_u24 v56, 4220, v54
    v_lshl_add_u32 v56, v52, 2, v56
    v_lshlrev_b32 v57, 4, v53
    v_sub_u32 v56, v56, v57
    s_mul_i32 s74, s72, 9152
    s_lshl_b32 s75, s73, 8
    s_add_u32 s74, s74, s75
    s_add_u32 s74, s74, 25024
    v_add_u32 v164, s74, v164
    s_mul_i32 s74, s72, 8448
    s_sub_u32 s74, s74, s75
    s_add_u32 s74, s74, 52788
    v_add_u32 v165, s74, v56
    s_lshl_b32 s75, s60, 7
    s_add_u32 s74, s75, 43328
    v_add_u32 v166, s74, v166
    s_sub_u32 s74, 69812, s75
    v_add_u32 v167, s74, v56
    v_lshlrev_b32 v168, 7, v53
    v_lshl_add_u32 v168, v52, 2, v168
    v_mul_u32_u24 v169, 81920, v53
    v_lshl_add_u32 v169, v52, 2, v169
    v_lshlrev_b32 v176, 4, v1
    s_lshl_b32 s74, s60, 12
    v_add_u32 v170, s74, v176
    v_xor_b32 v171, 4096, v170
    s_lshl_b32 s74, s72, 10
    s_lshl_b32 s75, s73, 3
    s_add_u32 s74, s74, s75
    v_add_u32 v148, s74, v176
    s_mul_i32 s76, s72, 3
    s_xor_b32 s76, s76, s66
    s_add_u32 s74, s64, s72
    s_lshl_b32 s75, s73, 6
    s_lshl_b32 s84, s74, 12
    s_add_u32 s84, s84, s75
    s_add_u32 s84, s84, 1048576
    s_lshl_b32 s85, s65, 12
    s_add_u32 s85, s85, s75
    s_lshl_b32 s75, s76, 9
    s_add_u32 s85, s85, s75
    s_add_u32 s85, s85, 1048576
    s_mul_i32 s75, s73, 40960
    s_add_u32 s75, s75, 8388608
    s_lshl_b32 s88, s74, 6
    s_add_u32 s88, s88, s75
    s_lshl_b32 s89, s65, 6
    s_add_u32 s89, s89, s75
    s_mul_i32 s75, s76, 327680
    s_add_u32 s89, s89, s75
    s_mul_i32 s32, s68, 40
    s_mul_i32 s74, s73, 20
    s_add_u32 s32, s32, s74
    s_mul_i32 s32, s32, 3072
    s_add_u32 s32, s32, 4194304
    s_mov_b32 s80, s32
    s_mul_i32 s75, s73, 43008
    s_add_u32 s75, s75, 77824
    s_lshl_b32 s74, s72, 10
    s_add_u32 s81, s75, s74
    v_add_u32 v149, s74, v176
    s_lshl_b32 s74, s73, 8
    v_xor_b32 v175, s74, v176
    v_add_u32 v181, s75, v175
    s_mul_i32 s74, s70, 80
    s_add_u32 s75, s74, 79
    s_lshr_b32 s74, s74, 7
    s_lshr_b32 s75, s75, 7
    s_sub_u32 s75, s75, s74
    s_mul_i32 s76, s60, 60
    s_add_u32 s74, s74, s76
    v_min_u32 v54, 23, v1
    v_lshrrev_b32 v55, 1, v54
    v_mul_u32_u24 v55, 5, v55
    v_and_b32 v54, s75, v54
    v_add3_u32 v54, v54, v55, s74
    v_lshlrev_b32 v178, 9, v54
    s_lshl_b32 s74, s61, 9
    v_lshl_add_u32 v177, v1, 2, s74
    s_min_u32 s74, s61, 239
    s_mul_i32 s22, s74, 205
    s_lshr_b32 s22, s22, 10
    s_mul_i32 s23, s22, 5
    s_sub_u32 s23, s74, s23
    v_lshrrev_b32 v54, 5, v1
    v_bfe_u32 v55, v1, 2, 2
    v_bfe_u32 v56, v1, 4, 1
    v_and_b32 v57, 3, v1
    v_lshlrev_b32 v54, 4, v54
    v_lshl_add_u32 v54, v56, 2, v54
    v_add_u32 v54, v54, v55
    v_lshlrev_b32 v54, 8, v54
    s_lshl_b32 s74, s60, 6
    s_add_u32 s74, s74, 16384
    v_add_u32 v54, s74, v54
    s_lshl_b32 s78, s23, 2
    s_add_u32 s78, s78, s60
    s_mul_i32 s79, s78, 205
    s_lshr_b32 s79, s79, 10
    s_mul_i32 s74, s79, 5
    s_sub_u32 s74, s78, s74
    s_cmp_eq_u32 s74, 2
    s_cselect_b32 s75, 8, 16
    s_cselect_b32 s76, 32, 8
    s_cselect_b32 s77, 240, 1
    v_mad_u32_u24 v128, v57, s75, v54
    v_add_u32 v129, s76, v128
    s_lshl_b32 s78, s79, 1
    s_cmp_ge_u32 s74, 3
    s_addc_u32 s78, s78, 0
    s_cmp_ge_u32 s74, 3
    s_cselect_b32 s79, 3, 0
    s_sub_u32 s74, s74, s79
    s_lshl_b32 s74, s74, 1
    s_mul_i32 s78, s78, 48
    s_add_u32 s78, s78, s22
    s_mul_i32 s78, s78, 5
    s_add_u32 s78, s78, s74
    s_add_u32 s78, s78, 6144
    s_add_u32 s79, s78, s77
    s_lshl_b32 s78, s78, 10
    s_lshl_b32 s79, s79, 10
    v_add_u32 v130, s78, v176
    v_add_u32 v131, s79, v176
    s_lshl_b32 s74, s73, 11
    v_add_u32 v183, s74, v176
    v_xor_b32 v182, 2048, v183
    v_add_u32 v142, 4096, v176
    s_lshl_b32 s83, s70, 2
    s_add_u32 s83, s83, s60
    s_mul_i32 s83, s83, 61440
    s_add_u32 s83, s83, 6291456
    s_lshl_b32 s74, s61, 4
    v_lshl_add_u32 v172, v1, 2, s74
    v_lshlrev_b32 v173, 4, v0
    v_mov_b32 v54, v120
    v_mov_b32 v55, v121
    s_waitcnt vmcnt(11)
    ds_read_b64_tr_b16 v[80:81], v54 offset:0
    ds_read_b64_tr_b16 v[82:83], v54 offset:256
    ds_read_b64_tr_b16 v[84:85], v54 offset:32
    ds_read_b64_tr_b16 v[86:87], v54 offset:288
    ds_read_b64_tr_b16 v[88:89], v54 offset:1024
    ds_read_b64_tr_b16 v[90:91], v54 offset:1280
    ds_read_b64_tr_b16 v[92:93], v54 offset:1056
    ds_read_b64_tr_b16 v[94:95], v54 offset:1312
    ds_read_b64_tr_b16 v[96:97], v54 offset:2048
    ds_read_b64_tr_b16 v[98:99], v54 offset:2304
    ds_read_b64_tr_b16 v[100:101], v54 offset:2080
    ds_read_b64_tr_b16 v[102:103], v54 offset:2336
    ds_read_b64_tr_b16 v[104:105], v54 offset:3072
    ds_read_b64_tr_b16 v[106:107], v54 offset:3328
    ds_read_b64_tr_b16 v[108:109], v54 offset:3104
    ds_read_b64_tr_b16 v[110:111], v54 offset:3360
    ds_read_b64_tr_b16 v[112:113], v54 offset:4096
    ds_read_b64_tr_b16 v[114:115], v54 offset:4352
    ds_read_b64_tr_b16 v[116:117], v54 offset:4128
    ds_read_b64_tr_b16 v[118:119], v54 offset:4384
    s_mov_b32 exec_hi, 0
    buffer_store_dwordx4 v[72:75], v176, s[52:55], s93 offen sc1
    s_mov_b32 exec_hi, 0
    buffer_store_dwordx4 v[72:75], v176, s[52:55], s90 offen sc1
    s_mov_b32 exec_lo, 3
    s_lshl_b32 s3, s61, 4
    s_add_u32 s3, s3, 32768
    buffer_store_dwordx4 v[72:75], v55, s[52:55], s3 offen sc1
    s_mov_b64 exec, -1
    s_waitcnt lgkmcnt(15)
    buffer_store_dwordx4 v[80:83], v55, s[52:55], s92 offen sc1
    s_add_u32 s92, s92, 65536
    buffer_store_dwordx4 v[84:87], v55, s[52:55], s92 offen sc1
    s_add_u32 s92, s92, 65536
    s_waitcnt lgkmcnt(14)
    buffer_store_dwordx4 v[88:91], v55, s[52:55], s92 offen sc1
    s_add_u32 s92, s92, 65536
    s_waitcnt lgkmcnt(12)
    buffer_store_dwordx4 v[92:95], v55, s[52:55], s92 offen sc1
    s_add_u32 s92, s92, 65536
    s_waitcnt lgkmcnt(10)
    buffer_store_dwordx4 v[96:99], v55, s[52:55], s92 offen sc1
    s_add_u32 s92, s92, 65536
    s_waitcnt lgkmcnt(8)
    buffer_store_dwordx4 v[100:103], v55, s[52:55], s92 offen sc1
    s_add_u32 s92, s92, 65536
    s_waitcnt lgkmcnt(6)
    buffer_store_dwordx4 v[104:107], v55, s[52:55], s92 offen sc1
    s_add_u32 s92, s92, 65536
    s_waitcnt lgkmcnt(4)
    buffer_store_dwordx4 v[108:111], v55, s[52:55], s92 offen sc1
    s_add_u32 s92, s92, 65536
    s_waitcnt lgkmcnt(2)
    buffer_store_dwordx4 v[112:115], v55, s[52:55], s92 offen sc1
    s_add_u32 s92, s92, 65536
    s_waitcnt lgkmcnt(0)
    buffer_store_dwordx4 v[116:119], v55, s[52:55], s92 offen sc1
    s_mov_b32 m0, 88064
    s_nop 0
    s_nop 0
    buffer_load_dwordx4 v9, s[44:47], s82 offen offset:0 lds
    s_add_u32 s82, s82, 23552
    buffer_load_dwordx4 v9, s[44:47], s82 offen offset:1024 lds
    s_add_u32 s82, s82, 23552
    buffer_load_dwordx4 v9, s[44:47], s82 offen offset:2048 lds
    s_add_u32 s82, s82, 23552
    buffer_load_dwordx4 v9, s[44:47], s82 offen offset:3072 lds
    s_mov_b32 m0, 92160
    s_add_u32 s82, s82, 27648
    buffer_load_dwordx4 v9, s[44:47], s82 offen offset:0 lds
    s_add_u32 s82, s82, 23552
    buffer_load_dwordx4 v9, s[44:47], s82 offen offset:1024 lds
    s_add_u32 s82, s82, 23552
    buffer_load_dwordx4 v9, s[44:47], s82 offen offset:2048 lds
    s_add_u32 s82, s82, 23552
    buffer_load_dwordx4 v9, s[44:47], s82 offen offset:3072 lds
    s_mov_b32 m0, 16384
    s_nop 0
    s_nop 0
    buffer_load_dwordx4 v7, s[48:51], s91 offen offset:0 lds
    s_add_u32 s91, s91, 4096
    buffer_load_dwordx4 v7, s[48:51], s91 offen offset:1024 lds
    s_add_u32 s91, s91, 4096
    buffer_load_dwordx4 v7, s[48:51], s91 offen offset:2048 lds
    s_add_u32 s91, s91, 4096
    buffer_load_dwordx4 v7, s[48:51], s91 offen offset:3072 lds
    s_mov_b32 m0, 20480
    s_add_u32 s91, s91, 8192
    buffer_load_dwordx4 v7, s[48:51], s91 offen offset:0 lds
    s_add_u32 s91, s91, 4096
    buffer_load_dwordx4 v7, s[48:51], s91 offen offset:1024 lds
    s_add_u32 s91, s91, 4096
    buffer_load_dwordx4 v7, s[48:51], s91 offen offset:2048 lds
    s_add_u32 s91, s91, 4096
    buffer_load_dwordx4 v7, s[48:51], s91 offen offset:3072 lds
    s_mov_b32 s72, 0x3f803f80
    s_waitcnt vmcnt(29)
    s_nop 0
    v_dot2_f32_bf16 v76, v12, v12, v76
    v_dot2_f32_bf16 v78, v12, s72, v78
    v_dot2_f32_bf16 v77, v13, v13, v77
    v_dot2_f32_bf16 v79, v13, s72, v79
    v_dot2_f32_bf16 v76, v14, v14, v76
    v_dot2_f32_bf16 v78, v14, s72, v78
    v_dot2_f32_bf16 v77, v15, v15, v77
    v_dot2_f32_bf16 v79, v15, s72, v79
    v_dot2_f32_bf16 v76, v16, v16, v76
    v_dot2_f32_bf16 v78, v16, s72, v78
    v_dot2_f32_bf16 v77, v17, v17, v77
    v_dot2_f32_bf16 v79, v17, s72, v79
    v_dot2_f32_bf16 v76, v18, v18, v76
    v_dot2_f32_bf16 v78, v18, s72, v78
    v_dot2_f32_bf16 v77, v19, v19, v77
    v_dot2_f32_bf16 v79, v19, s72, v79
    v_dot2_f32_bf16 v76, v20, v20, v76
    v_dot2_f32_bf16 v78, v20, s72, v78
    v_dot2_f32_bf16 v77, v21, v21, v77
    v_dot2_f32_bf16 v79, v21, s72, v79
    v_dot2_f32_bf16 v76, v22, v22, v76
    v_dot2_f32_bf16 v78, v22, s72, v78
    v_dot2_f32_bf16 v77, v23, v23, v77
    v_dot2_f32_bf16 v79, v23, s72, v79
    v_dot2_f32_bf16 v76, v24, v24, v76
    v_dot2_f32_bf16 v78, v24, s72, v78
    v_dot2_f32_bf16 v77, v25, v25, v77
    v_dot2_f32_bf16 v79, v25, s72, v79
    v_dot2_f32_bf16 v76, v26, v26, v76
    v_dot2_f32_bf16 v78, v26, s72, v78
    v_dot2_f32_bf16 v77, v27, v27, v77
    v_dot2_f32_bf16 v79, v27, s72, v79
    v_dot2_f32_bf16 v76, v28, v28, v76
    v_dot2_f32_bf16 v78, v28, s72, v78
    v_dot2_f32_bf16 v77, v29, v29, v77
    v_dot2_f32_bf16 v79, v29, s72, v79
    v_dot2_f32_bf16 v76, v30, v30, v76
    v_dot2_f32_bf16 v78, v30, s72, v78
    v_dot2_f32_bf16 v77, v31, v31, v77
    v_dot2_f32_bf16 v79, v31, s72, v79
    v_dot2_f32_bf16 v76, v32, v32, v76
    v_dot2_f32_bf16 v78, v32, s72, v78
    v_dot2_f32_bf16 v77, v33, v33, v77
    v_dot2_f32_bf16 v79, v33, s72, v79
    v_dot2_f32_bf16 v76, v34, v34, v76
    v_dot2_f32_bf16 v78, v34, s72, v78
    v_dot2_f32_bf16 v77, v35, v35, v77
    v_dot2_f32_bf16 v79, v35, s72, v79
    v_dot2_f32_bf16 v76, v36, v36, v76
    v_dot2_f32_bf16 v78, v36, s72, v78
    v_dot2_f32_bf16 v77, v37, v37, v77
    v_dot2_f32_bf16 v79, v37, s72, v79
    v_dot2_f32_bf16 v76, v38, v38, v76
    v_dot2_f32_bf16 v78, v38, s72, v78
    v_dot2_f32_bf16 v77, v39, v39, v77
    v_dot2_f32_bf16 v79, v39, s72, v79
    v_dot2_f32_bf16 v76, v40, v40, v76
    v_dot2_f32_bf16 v78, v40, s72, v78
    v_dot2_f32_bf16 v77, v41, v41, v77
    v_dot2_f32_bf16 v79, v41, s72, v79
    v_dot2_f32_bf16 v76, v42, v42, v76
    v_dot2_f32_bf16 v78, v42, s72, v78
    v_dot2_f32_bf16 v77, v43, v43, v77
    v_dot2_f32_bf16 v79, v43, s72, v79
    v_dot2_f32_bf16 v76, v44, v44, v76
    v_dot2_f32_bf16 v78, v44, s72, v78
    v_dot2_f32_bf16 v77, v45, v45, v77
    v_dot2_f32_bf16 v79, v45, s72, v79
    v_dot2_f32_bf16 v76, v46, v46, v76
    v_dot2_f32_bf16 v78, v46, s72, v78
    v_dot2_f32_bf16 v77, v47, v47, v77
    v_dot2_f32_bf16 v79, v47, s72, v79
    v_dot2_f32_bf16 v76, v48, v48, v76
    v_dot2_f32_bf16 v78, v48, s72, v78
    v_dot2_f32_bf16 v77, v49, v49, v77
    v_dot2_f32_bf16 v79, v49, s72, v79
    v_dot2_f32_bf16 v76, v50, v50, v76
    v_dot2_f32_bf16 v78, v50, s72, v78
    v_dot2_f32_bf16 v77, v51, v51, v77
    v_dot2_f32_bf16 v79, v51, s72, v79
    v_readfirstlane_b32 s71, v250
    s_nop 0
    v_add_f32 v76, v76, v77
    v_add_f32 v78, v78, v79
    s_nop 0
    v_add_f32_dpp v76, v76, v76 quad_perm:[1,0,3,2] row_mask:0xf bank_mask:0xf
    v_add_f32_dpp v78, v78, v78 quad_perm:[1,0,3,2] row_mask:0xf bank_mask:0xf
    s_nop 0
    v_add_f32_dpp v76, v76, v76 quad_perm:[2,3,0,1] row_mask:0xf bank_mask:0xf
    v_add_f32_dpp v78, v78, v78 quad_perm:[2,3,0,1] row_mask:0xf bank_mask:0xf
    s_nop 0
    v_add_f32_dpp v76, v76, v76 row_half_mirror row_mask:0xf bank_mask:0xf
    v_add_f32_dpp v78, v78, v78 row_half_mirror row_mask:0xf bank_mask:0xf
    s_mul_i32 s71, s71, 0x9e3779b1
    s_add_u32 s71, s71, 0x7f4a7c15
    s_bitset1_b32 s71, 0
    v_mul_f32 v78, 0x3acccccd, v78
    v_mov_b32 v77, 0x3727c5ac
    v_fmac_f32 v77, 0x3acccccd, v76
    v_fma_f32 v77, -v78, v78, v77
    v_rsq_f32 v12, v77
    v_mov_b32_dpp v79, v78 row_shl:8 row_mask:0xf bank_mask:0xf
    s_nop 0
    v_mov_b32_dpp v13, v12 row_shl:8 row_mask:0xf bank_mask:0xf
    v_cvt_pk_bf16_f32 v14, v78, v79
    v_mov_b32 v15, s71
    s_lshl_b32 s29, s61, 6
    s_add_u32 s29, s29, 16384
    s_mov_b32 exec_lo, 0x00010001
    s_mov_b32 exec_hi, 0x00010001
    buffer_store_dwordx4 v[12:15], v1, s[52:55], s29 offen sc1
    s_mov_b64 exec, -1
    s_waitcnt vmcnt(17)
    s_mov_b32 exec_hi, 0
    buffer_store_dword v15, v180, s[52:55], s90 offen sc1
    s_mov_b64 exec, -1
    s_cmp_ge_u32 s20, 5
    s_cselect_b32 s76, 20, 0
    s_lshl_b32 s77, s20, 2
    s_sub_u32 s77, s77, s76
    s_lshl_b32 s72, s21, 1
    s_add_u32 s72, s72, 0
    s_mul_i32 s73, s72, 171
    s_lshr_b32 s73, s73, 9
    s_lshr_b32 s74, s73, 2
    s_mul_i32 s74, s74, 5
    s_sub_u32 s74, s77, s74
    s_mul_i32 s73, s73, 117
    s_add_u32 s72, s72, s73
    s_add_u32 s72, s72, 4096
    s_add_u32 s73, s74, 0
    s_add_u32 s75, s73, 20
    s_min_u32 s73, s73, s75
    s_add_u32 s73, s73, s76
    s_mul_i32 s73, s73, 3
    s_add_u32 s73, s73, s72
    s_lshl_b32 s40, s73, 10
    s_add_u32 s73, s74, 1
    s_add_u32 s75, s73, 20
    s_min_u32 s73, s73, s75
    s_add_u32 s73, s73, s76
    s_mul_i32 s73, s73, 3
    s_add_u32 s73, s73, s72
    s_lshl_b32 s42, s73, 10
    s_add_u32 s73, s74, 2
    s_add_u32 s75, s73, 20
    s_min_u32 s73, s73, s75
    s_add_u32 s73, s73, s76
    s_mul_i32 s73, s73, 3
    s_add_u32 s73, s73, s72
    s_lshl_b32 s44, s73, 10
    s_add_u32 s73, s74, 3
    s_add_u32 s75, s73, 20
    s_min_u32 s73, s73, s75
    s_add_u32 s73, s73, s76
    s_mul_i32 s73, s73, 3
    s_add_u32 s73, s73, s72
    s_lshl_b32 s46, s73, 10
    s_lshl_b32 s72, s21, 1
    s_add_u32 s72, s72, 1
    s_mul_i32 s73, s72, 171
    s_lshr_b32 s73, s73, 9
    s_lshr_b32 s74, s73, 2
    s_mul_i32 s74, s74, 5
    s_sub_u32 s74, s77, s74
    s_mul_i32 s73, s73, 117
    s_add_u32 s72, s72, s73
    s_add_u32 s72, s72, 4096
    s_add_u32 s73, s74, 0
    s_add_u32 s75, s73, 20
    s_min_u32 s73, s73, s75
    s_add_u32 s73, s73, s76
    s_mul_i32 s73, s73, 3
    s_add_u32 s73, s73, s72
    s_lshl_b32 s41, s73, 10
    s_add_u32 s73, s74, 1
    s_add_u32 s75, s73, 20
    s_min_u32 s73, s73, s75
    s_add_u32 s73, s73, s76
    s_mul_i32 s73, s73, 3
    s_add_u32 s73, s73, s72
    s_lshl_b32 s43, s73, 10
    s_add_u32 s73, s74, 2
    s_add_u32 s75, s73, 20
    s_min_u32 s73, s73, s75
    s_add_u32 s73, s73, s76
    s_mul_i32 s73, s73, 3
    s_add_u32 s73, s73, s72
    s_lshl_b32 s45, s73, 10
    s_add_u32 s73, s74, 3
    s_add_u32 s75, s73, 20
    s_min_u32 s73, s73, s75
    s_add_u32 s73, s73, s76
    s_mul_i32 s73, s73, 3
    s_add_u32 s73, s73, s72
    s_lshl_b32 s47, s73, 10
    s_lshr_b32 s10, s60, 1
    s_and_b32 s11, s60, 1
    v_lshrrev_b32 v144, 5, v1
    v_bfe_u32 v145, v1, 2, 2
    v_bfe_u32 v146, v1, 4, 1
    v_and_b32 v147, 3, v1
    v_lshlrev_b32 v138, 10, v146
    v_and_b32 v132, 15, v1
    v_lshl_add_u32 v138, v132, 4, v138
    v_lshl_add_u32 v138, v144, 8, v138
    s_lshl_b32 s12, s67, 1
    s_add_u32 s12, s12, s10
    s_mul_i32 s86, s12, 48
    s_mul_i32 s13, s68, 3
    s_add_u32 s86, s86, s13
    s_lshl_b32 s86, s86, 11
    s_lshl_b32 s13, s11, 9
    s_add_u32 s86, s86, s13
    s_add_u32 s86, s86, 11534336
    s_add_u32 s87, s86, 4096
    v_lshl_add_u32 v132, v144, 3, v145
    v_lshlrev_b32 v132, 6, v132
    v_lshl_add_u32 v132, v146, 5, v132
    v_lshl_add_u32 v132, v147, 3, v132
    s_mul_i32 s8, s60, 12288
    s_add_u32 s8, s8, 25024
    v_add_u32 v132, s8, v132
    s_lshl_b32 s12, s67, 4
    s_add_u32 s12, s12, s68
    s_lshl_b32 s12, s12, 7
    v_lshl_add_u32 v135, v1, 2, s12
    s_lshr_b32 s12, s69, 1
    s_lshl_b32 s12, s12, 11
    v_and_b32 v136, 15, v1
    v_lshl_add_u32 v136, v136, 7, s12
    s_mul_i32 s12, s60, 6144
    v_add_u32 v133, s12, v176
    s_xor_b32 s12, s60, 1
    s_mul_i32 s12, s12, 6144
    v_add_u32 v134, s12, v176
    s_lshl_b32 s12, s11, 6
    s_add_u32 s12, s12, 74176
    v_lshl_add_u32 v137, v144, 4, s12
    v_min_u32 v144, 19, v1
    v_lshrrev_b32 v145, 1, v144
    v_mul_u32_u24 v145, 22, v145
    v_add_u32 v144, v144, v145
    s_mul_i32 s13, s68, 3
    s_lshr_b32 s13, s13, 1
    s_lshl_b32 s13, s13, 9
    s_add_u32 s13, s13, 131200
    v_lshl_add_u32 v140, v144, 9, s13
    v_add_u32 v139, 1024, v176
    v_min_u32 v143, 95, v0
    v_lshlrev_b32 v143, 2, v143
    s_lshl_b32 s12, s67, 1
    s_add_u32 s12, s12, s10
    s_mul_i32 s15, s12, 40960
    s_mul_i32 s13, s11, 20480
    s_add_u32 s15, s15, s13
    s_add_u32 s15, s15, 8388608
    s_lshr_b32 s33, s68, 2
    s_add_u32 s13, s33, 0
    s_and_b32 s13, s13, 3
    s_mul_i32 s13, s13, 5120
    s_add_u32 s16, s15, s13
    s_add_u32 s13, s33, 1
    s_and_b32 s13, s13, 3
    s_mul_i32 s13, s13, 5120
    s_add_u32 s17, s15, s13
    s_add_u32 s13, s33, 2
    s_and_b32 s13, s13, 3
    s_mul_i32 s13, s13, 5120
    s_add_u32 s18, s15, s13
    s_add_u32 s13, s33, 3
    s_and_b32 s13, s13, 3
    s_mul_i32 s13, s13, 5120
    s_add_u32 s19, s15, s13
    s_lshl_b32 s39, s12, 11
    s_add_u32 s39, s39, 262144
    s_lshl_b32 s13, s33, 9
    s_add_u32 s9, s39, s13
    s_lshl_b32 s13, s11, 8
    s_add_u32 s9, s9, s13
    s_and_b32 s33, s68, 3
    s_lshl_b32 s13, s33, 28
    s_add_u32 s9, s9, s13
    s_mul_i32 s14, s68, 384
    s_add_u32 s14, s14, 65536
    s_mul_i32 s13, s68, 192
    v_lshrrev_b32 v141, 1, v143
    v_add_u32 v141, s13, v141
    v_lshlrev_b32 v180, 2, v1
    s_lshl_b32 s3, s60, 10
    s_add_u32 s3, s3, 1048576
    s_lshl_b32 s4, s64, 12
    s_add_u32 s4, s4, s3
    s_add_u32 s5, s4, 4096
    s_lshl_b32 s6, s65, 12
    s_add_u32 s6, s6, s3
    s_lshl_b32 s7, s60, 12
    s_add_u32 s7, s7, 16384
    s_lshr_b32 s3, s61, 6
    s_lshl_b32 s3, s3, 9
    s_add_u32 s3, s3, 131072
    v_lshl_add_u32 v122, v1, 11, s3
    v_mov_b32 v2, 24576
    ds_write_b32 v2, v15
    v_mov_b32 v174, v15
    s_mov_b32 s93, 0x8000
    s_sleep 4
    buffer_load_dword v20, v122, s[52:55], 0 offen sc1
    s_waitcnt vmcnt(3)
    ds_read_b64_tr_b16 v[184:185], v58 offset:0
    ds_read_b64_tr_b16 v[186:187], v58 offset:512
    ds_read_b64_tr_b16 v[188:189], v58 offset:64
    ds_read_b64_tr_b16 v[190:191], v58 offset:576
    ds_read_b64_tr_b16 v[192:193], v58 offset:2048
    ds_read_b64_tr_b16 v[194:195], v58 offset:2560
    ds_read_b64_tr_b16 v[196:197], v58 offset:2112
    ds_read_b64_tr_b16 v[198:199], v58 offset:2624
    ds_read_b64_tr_b16 v[200:201], v58 offset:4096
    ds_read_b64_tr_b16 v[202:203], v58 offset:4608
    ds_read_b64_tr_b16 v[204:205], v58 offset:4160
    ds_read_b64_tr_b16 v[206:207], v58 offset:4672
    ds_read_b64_tr_b16 v[208:209], v58 offset:6144
    ds_read_b64_tr_b16 v[210:211], v58 offset:6656
    ds_read_b64_tr_b16 v[212:213], v58 offset:6208
    ds_read_b64_tr_b16 v[214:215], v58 offset:6720
    s_mov_b32 s3, 0x3f803f80
    v_mov_b32 v70, 0
    v_mov_b32 v71, 0
    s_waitcnt lgkmcnt(14)
    s_nop 0
    buffer_store_dwordx4 v[184:187], v176, s[52:55], s40 offen sc1
    v_dot2_f32_bf16 v70, v184, s3, v70
    v_dot2_f32_bf16 v70, v185, s3, v70
    v_dot2_f32_bf16 v70, v186, s3, v70
    v_dot2_f32_bf16 v70, v187, s3, v70
    s_waitcnt lgkmcnt(12)
    s_nop 0
    buffer_store_dwordx4 v[188:191], v176, s[52:55], s41 offen sc1
    v_dot2_f32_bf16 v71, v188, s3, v71
    v_dot2_f32_bf16 v71, v189, s3, v71
    v_dot2_f32_bf16 v71, v190, s3, v71
    v_dot2_f32_bf16 v71, v191, s3, v71
    s_waitcnt lgkmcnt(10)
    s_nop 0
    buffer_store_dwordx4 v[192:195], v176, s[52:55], s42 offen sc1
    v_dot2_f32_bf16 v70, v192, s3, v70
    v_dot2_f32_bf16 v70, v193, s3, v70
    v_dot2_f32_bf16 v70, v194, s3, v70
    v_dot2_f32_bf16 v70, v195, s3, v70
    s_waitcnt lgkmcnt(8)
    s_nop 0
    buffer_store_dwordx4 v[196:199], v176, s[52:55], s43 offen sc1
    v_dot2_f32_bf16 v71, v196, s3, v71
    v_dot2_f32_bf16 v71, v197, s3, v71
    v_dot2_f32_bf16 v71, v198, s3, v71
    v_dot2_f32_bf16 v71, v199, s3, v71
    s_waitcnt lgkmcnt(6)
    s_nop 0
    buffer_store_dwordx4 v[200:203], v176, s[52:55], s44 offen sc1
    v_dot2_f32_bf16 v70, v200, s3, v70
    v_dot2_f32_bf16 v70, v201, s3, v70
    v_dot2_f32_bf16 v70, v202, s3, v70
    v_dot2_f32_bf16 v70, v203, s3, v70
    s_waitcnt lgkmcnt(4)
    s_nop 0
    buffer_store_dwordx4 v[204:207], v176, s[52:55], s45 offen sc1
    v_dot2_f32_bf16 v71, v204, s3, v71
    v_dot2_f32_bf16 v71, v205, s3, v71
    v_dot2_f32_bf16 v71, v206, s3, v71
    v_dot2_f32_bf16 v71, v207, s3, v71
    s_waitcnt lgkmcnt(2)
    s_nop 0
    buffer_store_dwordx4 v[208:211], v176, s[52:55], s46 offen sc1
    v_dot2_f32_bf16 v70, v208, s3, v70
    v_dot2_f32_bf16 v70, v209, s3, v70
    v_dot2_f32_bf16 v70, v210, s3, v70
    v_dot2_f32_bf16 v70, v211, s3, v70
    s_waitcnt lgkmcnt(0)
    s_nop 0
    buffer_store_dwordx4 v[212:215], v176, s[52:55], s47 offen sc1
    v_dot2_f32_bf16 v71, v212, s3, v71
    v_dot2_f32_bf16 v71, v213, s3, v71
    v_dot2_f32_bf16 v71, v214, s3, v71
    v_dot2_f32_bf16 v71, v215, s3, v71
    s_nop 2
    v_permlane32_swap_b32 v70, v71
    v_add_f32 v70, v70, v71
    buffer_store_dword v70, v180, s[52:55], s28 offen sc1
    s_waitcnt vmcnt(9)
    v_cmp_ne_u32 vcc, v15, v20
    s_nop 1
    s_cbranch_vccnz L_slow_1
L_back_2:
    s_barrier
    buffer_load_dwordx4 v[216:219], v176, s[52:55], s7 offen offset:0 sc1
    buffer_load_dwordx4 v[220:223], v176, s[52:55], s7 offen offset:1024 sc1
    buffer_load_dwordx4 v[224:227], v176, s[52:55], s7 offen offset:2048 sc1
    buffer_load_dwordx4 v[228:231], v176, s[52:55], s7 offen offset:3072 sc1
    buffer_load_dword v232, v180, s[52:55], s4 offen offset:0 sc1
    buffer_load_dword v233, v180, s[52:55], s4 offen offset:256 sc1
    buffer_load_dword v234, v180, s[52:55], s4 offen offset:512 sc1
    buffer_load_dword v235, v180, s[52:55], s4 offen offset:768 sc1
    buffer_load_dword v236, v180, s[52:55], s5 offen offset:0 sc1
    buffer_load_dword v237, v180, s[52:55], s5 offen offset:256 sc1
    buffer_load_dword v238, v180, s[52:55], s5 offen offset:512 sc1
    buffer_load_dword v239, v180, s[52:55], s5 offen offset:768 sc1
    buffer_load_dword v240, v180, s[52:55], s6 offen offset:0 sc1
    buffer_load_dword v241, v180, s[52:55], s6 offen offset:256 sc1
    buffer_load_dword v242, v180, s[52:55], s6 offen offset:512 sc1
    buffer_load_dword v243, v180, s[52:55], s6 offen offset:768 sc1
    s_waitcnt vmcnt(16)
    s_mov_b32 exec_hi, 0
    buffer_store_dword v15, v180, s[52:55], s90 offen offset:128 sc1
    s_mov_b64 exec, -1
    s_waitcnt vmcnt(1)
    s_branch L_join
L_conv_odd:
    s_nop 0
    ds_read_b128 a[32:35], v164 offset:0
    ds_read_b64 a[60:61], v165 offset:1728
    ds_read_b64 a[62:63], v165 offset:1736
    ds_read_b64 a[52:53], v165 offset:1216
    ds_read_b64 a[54:55], v165 offset:1224
    ds_read_b64 a[44:45], v165 offset:704
    ds_read_b64 a[46:47], v165 offset:712
    ds_read_b64 a[36:37], v165 offset:192
    ds_read_b64 a[38:39], v165 offset:200
    ds_read_b128 a[40:43], v164 offset:512
    ds_read_b128 a[48:51], v164 offset:1024
    ds_read_b128 a[56:59], v164 offset:1536
    ds_read_b128 a[0:3], v166 offset:0
    s_waitcnt lgkmcnt(6)
    v_mfma_f32_16x16x32_bf16 v[14:17], a[32:35], a[60:63], 0
    s_nop 0
    ds_read_b64 a[20:21], v167 offset:1088
    buffer_load_dword v154, v168, s[52:55], s84 offen offset:0 sc1
    v_mfma_f32_16x16x32_bf16 v[10:13], a[32:35], a[52:55], 0
    ds_read_b64 a[22:23], v167 offset:1096
    buffer_load_dword v155, v168, s[52:55], s84 offen offset:512 sc1
    v_mfma_f32_16x16x32_bf16 v[6:9], a[32:35], a[44:47], 0
    ds_read_b64 a[12:13], v167 offset:576
    v_accvgpr_write_b32 a252, -1
    s_waitcnt lgkmcnt(6)
    s_nop 0
    v_mfma_f32_16x16x32_bf16 v[2:5], a[32:35], a[36:39], 0
    ds_read_b64 a[14:15], v167 offset:584
    buffer_load_dword v156, v168, s[52:55], s84 offen offset:1024 sc1
    v_mfma_f32_16x16x32_bf16 v[14:17], a[40:43], a[52:55], v[14:17]
    ds_read_b128 a[8:11], v166 offset:512
    buffer_load_dword v157, v168, s[52:55], s84 offen offset:1536 sc1
    v_mfma_f32_16x16x32_bf16 v[10:13], a[40:43], a[44:47], v[10:13]
    ds_read_b64 a[4:5], v167 offset:64
    v_accvgpr_write_b32 a253, -1
    v_mfma_f32_16x16x32_bf16 v[6:9], a[40:43], a[36:39], v[6:9]
    ds_read_b64 a[6:7], v167 offset:72
    ds_read_b128 a[16:19], v166 offset:1024
    buffer_load_dword v158, v168, s[52:55], s85 offen offset:0 sc1
    s_waitcnt lgkmcnt(6)
    v_mfma_f32_16x16x32_bf16 v[14:17], a[48:51], a[44:47], v[14:17]
    s_nop 0
    ds_read_b64 a[28:29], v167 offset:1600
    buffer_store_dwordx4 v[108:111], v130, s[52:55], 0 offen sc1
    v_mfma_f32_16x16x32_bf16 v[10:13], a[48:51], a[36:39], v[10:13]
    ds_read_b64 a[30:31], v167 offset:1608
    ds_read_b128 a[24:27], v166 offset:1536
    v_mfma_f32_16x16x32_bf16 v[14:17], a[56:59], a[36:39], v[14:17]
    ds_read_b128 a[64:67], v164 offset:64
    v_accvgpr_write_b32 a254, -1
    v_mfma_f32_16x16x32_bf16 v[22:25], a[0:3], a[20:23], 0
    ds_read_b64 a[92:93], v165 offset:1664
    buffer_store_dwordx4 v[112:115], v131, s[52:55], 0 offen sc1
    s_waitcnt lgkmcnt(6)
    v_mfma_f32_16x16x32_bf16 v[18:21], a[0:3], a[12:15], 0
    s_nop 0
    ds_read_b64 a[94:95], v165 offset:1672
    ds_read_b64 a[84:85], v165 offset:1152
    v_mfma_f32_16x16x32_bf16 v[22:25], a[8:11], a[12:15], v[22:25]
    ds_read_b64 a[86:87], v165 offset:1160
    ds_read_b64 a[76:77], v165 offset:640
    v_mfma_f32_16x16x32_bf16 v[18:21], a[8:11], a[4:7], v[18:21]
    ds_read_b64 a[78:79], v165 offset:648
    ds_read_b64 a[68:69], v165 offset:128
    s_waitcnt lgkmcnt(8)
    v_mfma_f32_16x16x32_bf16 v[22:25], a[16:19], a[4:7], v[22:25]
    ds_read_b64 a[70:71], v165 offset:136
    ds_read_b128 a[72:75], v164 offset:576
    v_mfma_f32_16x16x32_bf16 v[42:45], a[16:19], a[28:31], 0
    ds_read_b128 a[80:83], v164 offset:1088
    v_accvgpr_write_b32 a255, -1
    v_mfma_f32_16x16x32_bf16 v[42:45], a[24:27], a[20:23], v[42:45]
    ds_read_b128 a[88:91], v164 offset:1600
    v_mfma_f32_16x16x32_bf16 v[46:49], a[24:27], a[28:31], 0
    ds_read_b128 a[96:99], v166 offset:64
    s_waitcnt lgkmcnt(6)
    v_mfma_f32_16x16x32_bf16 v[14:17], a[64:67], a[92:95], v[14:17]
    ds_read_b64 a[116:117], v167 offset:1024
    v_mfma_f32_16x16x32_bf16 v[10:13], a[64:67], a[84:87], v[10:13]
    ds_read_b64 a[118:119], v167 offset:1032
    s_waitcnt vmcnt(7)
    v_cmp_ne_u32 vcc, v174, v50
    s_nop 1
    s_cbranch_vccnz L_slow_5
L_back_6:
    v_mfma_f32_16x16x32_bf16 v[6:9], a[64:67], a[76:79], v[6:9]
    ds_read_b64 a[108:109], v167 offset:512
    buffer_load_dwordx4 v[184:187], v175, s[52:55], s80 offen offset:0 sc1
    s_waitcnt lgkmcnt(6)
    v_mfma_f32_16x16x32_bf16 v[2:5], a[64:67], a[68:71], v[2:5]
    ds_read_b64 a[110:111], v167 offset:520
    v_mfma_f32_16x16x32_bf16 v[14:17], a[72:75], a[84:87], v[14:17]
    s_nop 0
    ds_read_b128 a[104:107], v166 offset:576
    buffer_load_dwordx4 v[188:191], v175, s[52:55], s80 offen offset:1024 sc1
    v_mfma_f32_16x16x32_bf16 v[10:13], a[72:75], a[76:79], v[10:13]
    ds_read_b64 a[100:101], v167 offset:0
    v_mfma_f32_16x16x32_bf16 v[6:9], a[72:75], a[68:71], v[6:9]
    ds_read_b64 a[102:103], v167 offset:8
    ds_read_b128 a[112:115], v166 offset:1088
    s_waitcnt lgkmcnt(6)
    v_mfma_f32_16x16x32_bf16 v[14:17], a[80:83], a[76:79], v[14:17]
    ds_read_b64 a[124:125], v167 offset:1536
    v_mfma_f32_16x16x32_bf16 v[10:13], a[80:83], a[68:71], v[10:13]
    s_nop 0
    ds_read_b64 a[126:127], v167 offset:1544
    ds_read_b128 a[120:123], v166 offset:1600
    buffer_load_dwordx4 v[192:195], v175, s[52:55], s80 offen offset:2048 sc1
    v_mfma_f32_16x16x32_bf16 v[14:17], a[88:91], a[68:71], v[14:17]
    ds_read_b128 a[128:131], v164 offset:128
    v_mfma_f32_16x16x32_bf16 v[22:25], a[96:99], a[116:119], v[22:25]
    ds_read_b64 a[156:157], v165 offset:1600
    s_waitcnt lgkmcnt(6)
    s_nop 0
    v_mfma_f32_16x16x32_bf16 v[18:21], a[96:99], a[108:111], v[18:21]
    ds_read_b64 a[158:159], v165 offset:1608
    ds_read_b64 a[148:149], v165 offset:1088
    v_mfma_f32_16x16x32_bf16 v[22:25], a[104:107], a[108:111], v[22:25]
    ds_read_b64 a[150:151], v165 offset:1096
    ds_read_b64 a[140:141], v165 offset:576
    buffer_load_dwordx4 v[196:199], v175, s[52:55], s80 offen offset:3072 sc1
    v_mfma_f32_16x16x32_bf16 v[18:21], a[104:107], a[100:103], v[18:21]
    ds_read_b64 a[142:143], v165 offset:584
    ds_read_b64 a[132:133], v165 offset:64
    s_waitcnt lgkmcnt(8)
    v_mfma_f32_16x16x32_bf16 v[22:25], a[112:115], a[100:103], v[22:25]
    s_nop 0
    ds_read_b64 a[134:135], v165 offset:72
    ds_read_b128 a[136:139], v164 offset:640
    v_mfma_f32_16x16x32_bf16 v[42:45], a[112:115], a[124:127], v[42:45]
    ds_read_b128 a[144:147], v164 offset:1152
    v_mfma_f32_16x16x32_bf16 v[42:45], a[120:123], a[116:119], v[42:45]
    ds_read_b128 a[152:155], v164 offset:1664
    s_add_u32 s80, s80, 4096
    buffer_load_dwordx4 v[200:203], v175, s[52:55], s80 offen offset:0 sc1
    v_mfma_f32_16x16x32_bf16 v[46:49], a[120:123], a[124:127], v[46:49]
    ds_read_b128 a[160:163], v164 offset:192
    s_waitcnt lgkmcnt(6)
    v_mfma_f32_16x16x32_bf16 v[14:17], a[128:131], a[156:159], v[14:17]
    ds_read_b64 a[188:189], v165 offset:1536
    v_mfma_f32_16x16x32_bf16 v[10:13], a[128:131], a[148:151], v[10:13]
    ds_read_b64 a[190:191], v165 offset:1544
    v_mfma_f32_16x16x32_bf16 v[6:9], a[128:131], a[140:143], v[6:9]
    ds_read_b64 a[180:181], v165 offset:1024
    buffer_load_dwordx4 v[204:207], v175, s[52:55], s80 offen offset:1024 sc1
    s_waitcnt lgkmcnt(6)
    v_mfma_f32_16x16x32_bf16 v[2:5], a[128:131], a[132:135], v[2:5]
    ds_read_b64 a[182:183], v165 offset:1032
    v_mfma_f32_16x16x32_bf16 v[14:17], a[136:139], a[148:151], v[14:17]
    ds_read_b64 a[172:173], v165 offset:512
    v_mfma_f32_16x16x32_bf16 v[10:13], a[136:139], a[140:143], v[10:13]
    ds_read_b64 a[174:175], v165 offset:520
    ds_read_b64 a[164:165], v165 offset:0
    v_mfma_f32_16x16x32_bf16 v[6:9], a[136:139], a[132:135], v[6:9]
    ds_read_b64 a[166:167], v165 offset:8
    ds_read_b128 a[168:171], v164 offset:704
    buffer_load_dwordx4 v[208:211], v175, s[52:55], s80 offen offset:2048 sc1
    s_waitcnt lgkmcnt(7)
    v_mfma_f32_16x16x32_bf16 v[14:17], a[144:147], a[140:143], v[14:17]
    ds_read_b128 a[176:179], v164 offset:1216
    v_mfma_f32_16x16x32_bf16 v[10:13], a[144:147], a[132:135], v[10:13]
    ds_read_b128 a[184:187], v164 offset:1728
    v_mfma_f32_16x16x32_bf16 v[14:17], a[152:155], a[132:135], v[14:17]
    v_mfma_f32_16x16x32_bf16 v[14:17], a[160:163], a[188:191], v[14:17]
    buffer_load_dwordx4 v[212:215], v175, s[52:55], s80 offen offset:3072 sc1
    s_waitcnt lgkmcnt(7)
    v_mfma_f32_16x16x32_bf16 v[10:13], a[160:163], a[180:183], v[10:13]
    s_waitcnt lgkmcnt(5)
    v_mfma_f32_16x16x32_bf16 v[6:9], a[160:163], a[172:175], v[6:9]
    s_waitcnt lgkmcnt(3)
    v_mfma_f32_16x16x32_bf16 v[2:5], a[160:163], a[164:167], v[2:5]
    s_waitcnt lgkmcnt(2)
    v_mfma_f32_16x16x32_bf16 v[14:17], a[168:171], a[180:183], v[14:17]
    s_add_u32 s80, s80, 4096
    buffer_load_dwordx4 v[216:219], v175, s[52:55], s80 offen offset:0 sc1
    v_mfma_f32_16x16x32_bf16 v[10:13], a[168:171], a[172:175], v[10:13]
    v_mfma_f32_16x16x32_bf16 v[6:9], a[168:171], a[164:167], v[6:9]
    s_waitcnt lgkmcnt(1)
    v_mfma_f32_16x16x32_bf16 v[14:17], a[176:179], a[172:175], v[14:17]
    v_mfma_f32_16x16x32_bf16 v[10:13], a[176:179], a[164:167], v[10:13]
    buffer_load_dwordx4 v[220:223], v175, s[52:55], s80 offen offset:1024 sc1
    s_waitcnt lgkmcnt(0)
    v_mfma_f32_16x16x32_bf16 v[14:17], a[184:187], a[164:167], v[14:17]
    ds_write_b128 v170, v[18:21] offset:2048
    ds_write_b128 v170, v[22:25] offset:3072
    v_mfma_f32_16x16x32_bf16 v[26:29], a[40:43], a[60:63], 0
    buffer_load_dwordx4 v[224:227], v175, s[52:55], s80 offen offset:2048 sc1
    v_mfma_f32_16x16x32_bf16 v[26:29], a[48:51], a[52:55], v[26:29]
    ds_write2_b64 v170, v[4:5], v[8:9] offset0:0 offset1:1
    s_nop 1
    ds_write2_b64 v170, v[12:13], v[16:17] offset0:128 offset1:129
    s_waitcnt vmcnt(13)
    v_mfma_f32_16x16x32_bf16 v[30:33], a[48:51], a[60:63], 0
    v_lshlrev_b32 v150, 16, v154
    v_and_b32 v151, 0xffff0000, v154
    v_add_f32 v2, v2, v150
    v_mfma_f32_16x16x32_bf16 v[26:29], a[56:59], a[44:47], v[26:29]
    buffer_load_dwordx4 v[228:231], v175, s[52:55], s80 offen offset:3072 sc1
    v_add_f32 v3, v3, v151
    v_lshlrev_b32 v150, 16, v155
    v_and_b32 v151, 0xffff0000, v155
    v_mfma_f32_16x16x32_bf16 v[30:33], a[56:59], a[52:55], v[30:33]
    v_add_f32 v6, v6, v150
    v_add_f32 v7, v7, v151
    v_lshlrev_b32 v150, 16, v156
    v_mfma_f32_16x16x32_bf16 v[34:37], a[56:59], a[60:63], 0
    v_and_b32 v151, 0xffff0000, v156
    v_add_f32 v10, v10, v150
    v_add_f32 v11, v11, v151
    v_mfma_f32_16x16x32_bf16 v[26:29], a[72:75], a[92:95], v[26:29]
    v_lshlrev_b32 v150, 16, v157
    v_and_b32 v151, 0xffff0000, v157
    v_add_f32 v14, v14, v150
    v_mfma_f32_16x16x32_bf16 v[26:29], a[80:83], a[84:87], v[26:29]
    s_add_u32 s80, s80, 4096
    buffer_load_dwordx4 v[232:235], v175, s[52:55], s80 offen offset:0 sc1
    v_add_f32 v15, v15, v151
    v_lshlrev_b32 v152, 16, v158
    v_and_b32 v153, 0xffff0000, v158
    v_mfma_f32_16x16x32_bf16 v[30:33], a[80:83], a[92:95], v[30:33]
    s_waitcnt lgkmcnt(0)
    s_waitcnt vmcnt(13)
    s_barrier
    s_nop 0
    ds_read_b128 v[116:119], v171
    ds_read_b128 v[120:123], v171 offset:1024
    ds_read2st64_b64 v[124:127], v148 offset0:4 offset1:12
    ds_read2st64_b64 v[128:131], v148 offset0:20 offset1:28
    v_mfma_f32_16x16x32_bf16 v[26:29], a[88:91], a[76:79], v[26:29]
    buffer_load_dwordx4 v[236:239], v175, s[52:55], s80 offen offset:1024 sc1
    s_cmp_lg_u32 s60, 0
    s_cbranch_scc1 L_pub_7
    s_mov_b32 exec_hi, 0
    s_mov_b32 s3, 131328
    buffer_store_dword v174, v177, s[52:55], s3 offen sc1
    s_mov_b64 exec, -1
L_pub_7:
    v_mfma_f32_16x16x32_bf16 v[30:33], a[88:91], a[84:87], v[30:33]
    ds_read_b64 v[52:53], v167 offset:2112
    buffer_load_dwordx4 v[240:243], v175, s[52:55], s80 offen offset:2048 sc1
    v_mfma_f32_16x16x32_bf16 v[34:37], a[88:91], a[92:95], v[34:37]
    ds_read_b64 v[54:55], v167 offset:2120
    v_mfma_f32_16x16x32_bf16 v[26:29], a[136:139], a[156:159], v[26:29]
    ds_read_b128 v[56:59], v166 offset:2048
    v_mfma_f32_16x16x32_bf16 v[26:29], a[144:147], a[148:151], v[26:29]
    v_mfma_f32_16x16x32_bf16 v[30:33], a[144:147], a[156:159], v[30:33]
    ds_read_b64 v[60:61], v167 offset:2624
    buffer_load_dwordx4 v[244:247], v175, s[52:55], s80 offen offset:3072 sc1
    s_waitcnt lgkmcnt(6)
    v_add_f32 v2, v2, v116
    v_add_f32_e64 v3, v3, v117
    v_mfma_f32_16x16x32_bf16 v[26:29], a[152:155], a[140:143], v[26:29]
    ds_read_b64 v[62:63], v167 offset:2632
    v_cvt_pk_bf16_f32 v4, v2, v3
    buffer_store_dword v4, v169, s[52:55], s88 offen sc1
    s_add_u32 s88, s88, 327680
    v_add_f32 v6, v6, v118
    v_mfma_f32_16x16x32_bf16 v[30:33], a[152:155], a[148:151], v[30:33]
    ds_read_b128 v[64:67], v166 offset:2560
    s_add_u32 s80, s80, 4096
    buffer_load_dwordx4 v[248:251], v175, s[52:55], s80 offen offset:0 sc1
    v_add_f32 v7, v7, v119
    v_cvt_pk_bf16_f32 v8, v6, v7
    buffer_store_dword v8, v169, s[52:55], s88 offen sc1
    s_add_u32 s88, s88, 327680
    v_mfma_f32_16x16x32_bf16 v[34:37], a[152:155], a[156:159], v[34:37]
    v_add_f32 v10, v10, v120
    v_add_f32 v11, v11, v121
    v_cvt_pk_bf16_f32 v12, v10, v11
    v_mfma_f32_16x16x32_bf16 v[26:29], a[168:171], a[188:191], v[26:29]
    ds_read_b64 v[68:69], v167 offset:3136
    buffer_load_dwordx4 v[252:255], v175, s[52:55], s80 offen offset:1024 sc1
    buffer_store_dword v12, v169, s[52:55], s88 offen sc1
    s_add_u32 s88, s88, 327680
    v_add_f32 v14, v14, v122
    v_add_f32 v15, v15, v123
    v_mfma_f32_16x16x32_bf16 v[26:29], a[176:179], a[180:183], v[26:29]
    ds_read_b64 v[70:71], v167 offset:3144
    v_cvt_pk_bf16_f32 v16, v14, v15
    buffer_store_dword v16, v169, s[52:55], s88 offen sc1
    s_add_u32 s88, s88, 327680
    s_waitcnt lgkmcnt(8)
    s_nop 0
    v_mfma_f32_16x16x32_bf16 v[30:33], a[176:179], a[188:191], v[30:33]
    ds_read_b128 v[72:75], v166 offset:3072
    s_add_u32 m0, s81, 4294965248
    s_add_u32 s80, s32, 16384
    buffer_load_dwordx4 v149, s[52:55], s80 offen offset:2048 sc1 lds
    v_add_f32 v152, v152, v124
    v_add_f32 v153, v153, v125
    v_add_f32_e64 v152, v152, v126
    v_mfma_f32_16x16x32_bf16 v[26:29], a[184:187], a[172:175], v[26:29]
    ds_read_b64 v[76:77], v165 offset:2240
    s_add_u32 m0, s81, 2048
    s_add_u32 s80, s32, 20480
    buffer_load_dwordx4 v149, s[52:55], s80 offen offset:0 sc1 lds
    v_add_f32 v153, v153, v127
    v_add_f32 v152, v152, v128
    v_add_f32 v153, v153, v129
    v_mfma_f32_16x16x32_bf16 v[30:33], a[184:187], a[180:183], v[30:33]
    ds_read_b64 v[78:79], v165 offset:2248
    v_add_f32 v152, v152, v130
    v_add_f32 v153, v153, v131
    v_cvt_pk_bf16_f32 v152, v152, v153
    v_mfma_f32_16x16x32_bf16 v[34:37], a[184:187], a[188:191], v[34:37]
    buffer_store_dword v152, v169, s[52:55], s89 offen sc1
    s_add_u32 s89, s89, 1310720
    s_waitcnt lgkmcnt(8)
    v_mfma_f32_16x16x32_bf16 v[42:45], a[8:11], v[52:55], v[42:45]
    ds_read_b128 v[80:83], v164 offset:2048
    buffer_load_dword v159, v168, s[52:55], s84 offen offset:2048 sc1
    v_mfma_f32_16x16x32_bf16 v[46:49], a[16:19], v[52:55], v[46:49]
    buffer_load_dword v160, v168, s[52:55], s84 offen offset:2560 sc1
    v_mfma_f32_16x16x32_bf16 v[42:45], v[56:59], a[12:15], v[42:45]
    v_mfma_f32_16x16x32_bf16 v[46:49], v[56:59], a[20:23], v[46:49]
    buffer_load_dword v161, v168, s[52:55], s84 offen offset:3072 sc1
    s_waitcnt lgkmcnt(6)
    v_mfma_f32_16x16x32_bf16 v[42:45], a[0:3], v[60:63], v[42:45]
    ds_read_b64 v[84:85], v165 offset:2752
    buffer_load_dword v162, v168, s[52:55], s84 offen offset:3584 sc1
    v_mfma_f32_16x16x32_bf16 v[46:49], a[8:11], v[60:63], v[46:49]
    ds_read_b64 v[86:87], v165 offset:2760
    v_mfma_f32_16x16x32_bf16 v[42:45], v[64:67], a[4:7], v[42:45]
    buffer_load_dword v163, v168, s[52:55], s85 offen offset:2048 sc1
    v_mfma_f32_16x16x32_bf16 v[46:49], v[64:67], a[12:15], v[46:49]
    ds_read_b128 v[88:91], v164 offset:2560
    buffer_load_dwordx4 v149, s[52:55], s80 offen offset:2048 sc1 lds
    s_waitcnt lgkmcnt(6)
    v_mfma_f32_16x16x32_bf16 v[46:49], a[0:3], v[68:71], v[46:49]
    v_mfma_f32_16x16x32_bf16 v[46:49], v[72:75], a[4:7], v[46:49]
    s_waitcnt lgkmcnt(4)
    v_mfma_f32_16x16x32_bf16 v[26:29], a[32:35], v[76:79], v[26:29]
    ds_read_b64 v[92:93], v165 offset:3264
    v_mfma_f32_16x16x32_bf16 v[30:33], a[40:43], v[76:79], v[30:33]
    s_nop 0
    ds_read_b64 v[94:95], v165 offset:3272
    s_add_u32 m0, s81, 6144
    s_add_u32 s80, s32, 24576
    buffer_load_dwordx4 v149, s[52:55], s80 offen offset:0 sc1 lds
    v_mfma_f32_16x16x32_bf16 v[34:37], a[48:51], v[76:79], v[34:37]
    ds_read_b128 v[96:99], v164 offset:3072
    v_mfma_f32_16x16x32_bf16 v[38:41], a[56:59], v[76:79], 0
    s_waitcnt lgkmcnt(6)
    v_mfma_f32_16x16x32_bf16 v[26:29], v[80:83], a[36:39], v[26:29]
    ds_read_b64 v[100:101], v165 offset:3776
    v_mfma_f32_16x16x32_bf16 v[30:33], v[80:83], a[44:47], v[30:33]
    ds_read_b64 v[102:103], v165 offset:3784
    buffer_load_dwordx4 v149, s[52:55], s80 offen offset:2048 sc1 lds
    v_mfma_f32_16x16x32_bf16 v[34:37], v[80:83], a[52:55], v[34:37]
    ds_read_b128 v[104:107], v164 offset:3584
    v_mfma_f32_16x16x32_bf16 v[38:41], v[80:83], a[60:63], v[38:41]
    ds_read_b64 v[108:109], v165 offset:2176
    s_waitcnt lgkmcnt(7)
    v_mfma_f32_16x16x32_bf16 v[30:33], a[32:35], v[84:87], v[30:33]
    ds_read_b64 v[110:111], v165 offset:2184
    v_mfma_f32_16x16x32_bf16 v[34:37], a[40:43], v[84:87], v[34:37]
    s_add_u32 m0, s81, 10240
    s_add_u32 s80, s32, 28672
    buffer_load_dwordx4 v149, s[52:55], s80 offen offset:0 sc1 lds
    v_mfma_f32_16x16x32_bf16 v[38:41], a[48:51], v[84:87], v[38:41]
    ds_read_b128 v[112:115], v164 offset:2112
    v_mfma_f32_16x16x32_bf16 v[30:33], v[88:91], a[36:39], v[30:33]
    v_mfma_f32_16x16x32_bf16 v[34:37], v[88:91], a[44:47], v[34:37]
    v_mfma_f32_16x16x32_bf16 v[38:41], v[88:91], a[52:55], v[38:41]
    buffer_load_dwordx4 v149, s[52:55], s80 offen offset:2048 sc1 lds
    s_waitcnt lgkmcnt(6)
    v_mfma_f32_16x16x32_bf16 v[34:37], a[32:35], v[92:95], v[34:37]
    ds_read_b64 v[52:53], v165 offset:2688
    v_mfma_f32_16x16x32_bf16 v[38:41], a[40:43], v[92:95], v[38:41]
    s_nop 0
    ds_read_b64 v[54:55], v165 offset:2696
    v_mfma_f32_16x16x32_bf16 v[34:37], v[96:99], a[36:39], v[34:37]
    v_mfma_f32_16x16x32_bf16 v[38:41], v[96:99], a[44:47], v[38:41]
    ds_read_b128 v[56:59], v164 offset:2624
    s_add_u32 m0, s81, 14336
    s_add_u32 s80, s32, 32768
    buffer_load_dwordx4 v149, s[52:55], s80 offen offset:0 sc1 lds
    s_waitcnt lgkmcnt(6)
    v_mfma_f32_16x16x32_bf16 v[38:41], a[32:35], v[100:103], v[38:41]
    v_mfma_f32_16x16x32_bf16 v[38:41], v[104:107], a[36:39], v[38:41]
    s_waitcnt lgkmcnt(4)
    v_mfma_f32_16x16x32_bf16 v[26:29], a[64:67], v[108:111], v[26:29]
    ds_read_b64 v[60:61], v165 offset:3200
    s_mov_b32 s3, 131328
    buffer_load_dword v51, v178, s[52:55], s3 offen sc1
    v_mfma_f32_16x16x32_bf16 v[30:33], a[72:75], v[108:111], v[30:33]
    ds_read_b64 v[62:63], v165 offset:3208
    buffer_load_dwordx4 v149, s[52:55], s80 offen offset:2048 sc1 lds
    v_mfma_f32_16x16x32_bf16 v[34:37], a[80:83], v[108:111], v[34:37]
    ds_read_b128 v[64:67], v164 offset:3136
    v_mfma_f32_16x16x32_bf16 v[38:41], a[88:91], v[108:111], v[38:41]
    s_waitcnt lgkmcnt(6)
    v_mfma_f32_16x16x32_bf16 v[26:29], v[112:115], a[68:71], v[26:29]
    s_nop 0
    ds_read_b64 v[68:69], v165 offset:3712
    s_add_u32 m0, s81, 18432
    s_add_u32 s80, s32, 36864
    buffer_load_dwordx4 v149, s[52:55], s80 offen offset:0 sc1 lds
    v_mfma_f32_16x16x32_bf16 v[30:33], v[112:115], a[76:79], v[30:33]
    ds_read_b64 v[70:71], v165 offset:3720
    v_mfma_f32_16x16x32_bf16 v[34:37], v[112:115], a[84:87], v[34:37]
    ds_read_b128 v[72:75], v164 offset:3648
    v_mfma_f32_16x16x32_bf16 v[38:41], v[112:115], a[92:95], v[38:41]
    ds_read_b64 v[76:77], v167 offset:2048
    s_waitcnt lgkmcnt(7)
    v_mfma_f32_16x16x32_bf16 v[30:33], a[64:67], v[52:55], v[30:33]
    ds_read_b64 v[78:79], v167 offset:2056
    buffer_load_dwordx4 v149, s[52:55], s80 offen offset:2048 sc1 lds
    v_mfma_f32_16x16x32_bf16 v[34:37], a[72:75], v[52:55], v[34:37]
    ds_read_b128 v[80:83], v166 offset:2112
    v_mfma_f32_16x16x32_bf16 v[38:41], a[80:83], v[52:55], v[38:41]
    ds_read_b64 v[84:85], v167 offset:2560
    v_mfma_f32_16x16x32_bf16 v[30:33], v[56:59], a[68:71], v[30:33]
    s_nop 0
    ds_read_b64 v[86:87], v167 offset:2568
    v_mfma_f32_16x16x32_bf16 v[34:37], v[56:59], a[76:79], v[34:37]
    ds_read_b128 v[88:91], v166 offset:2624
    s_add_u32 m0, s81, 22528
    s_add_u32 s80, s32, 40960
    buffer_load_dwordx4 v149, s[52:55], s80 offen offset:0 sc1 lds
    v_mfma_f32_16x16x32_bf16 v[38:41], v[56:59], a[84:87], v[38:41]
    s_waitcnt lgkmcnt(9)
    v_mfma_f32_16x16x32_bf16 v[34:37], a[64:67], v[60:63], v[34:37]
    ds_read_b64 v[92:93], v167 offset:3072
    v_mfma_f32_16x16x32_bf16 v[38:41], a[72:75], v[60:63], v[38:41]
    ds_read_b64 v[94:95], v167 offset:3080
    v_mfma_f32_16x16x32_bf16 v[34:37], v[64:67], a[68:71], v[34:37]
    ds_read_b128 v[96:99], v166 offset:3136
    buffer_load_dwordx4 v149, s[52:55], s80 offen offset:2048 sc1 lds
    v_mfma_f32_16x16x32_bf16 v[38:41], v[64:67], a[76:79], v[38:41]
    ds_read_b64 v[100:101], v165 offset:2112
    s_waitcnt lgkmcnt(8)
    v_mfma_f32_16x16x32_bf16 v[38:41], a[64:67], v[68:71], v[38:41]
    ds_read_b64 v[102:103], v165 offset:2120
    v_mfma_f32_16x16x32_bf16 v[38:41], v[72:75], a[68:71], v[38:41]
    v_mfma_f32_16x16x32_bf16 v[42:45], a[104:107], v[76:79], v[42:45]
    ds_read_b128 v[104:107], v164 offset:2176
    s_add_u32 m0, s81, 26624
    s_add_u32 s80, s32, 45056
    buffer_load_dwordx4 v149, s[52:55], s80 offen offset:0 sc1 lds
    v_mfma_f32_16x16x32_bf16 v[46:49], a[112:115], v[76:79], v[46:49]
    s_waitcnt lgkmcnt(7)
    v_mfma_f32_16x16x32_bf16 v[42:45], v[80:83], a[108:111], v[42:45]
    v_mfma_f32_16x16x32_bf16 v[46:49], v[80:83], a[116:119], v[46:49]
    v_mfma_f32_16x16x32_bf16 v[42:45], a[96:99], v[84:87], v[42:45]
    ds_read_b64 v[108:109], v165 offset:2624
    s_waitcnt vmcnt(18)
    s_barrier
    s_cmp_lg_u32 s60, 0
    s_cbranch_scc1 L_pub_8
    s_mov_b64 exec, 15
    s_mov_b32 s3, 32768
    buffer_store_dword v174, v172, s[52:55], s3 offen sc1
    s_mov_b64 exec, -1
L_pub_8:
    v_mfma_f32_16x16x32_bf16 v[46:49], a[104:107], v[84:87], v[46:49]
    ds_read_b64 v[110:111], v165 offset:2632
    buffer_load_dwordx4 v149, s[52:55], s80 offen offset:2048 sc1 lds
    s_waitcnt lgkmcnt(6)
    v_mfma_f32_16x16x32_bf16 v[42:45], v[88:91], a[100:103], v[42:45]
    v_mfma_f32_16x16x32_bf16 v[46:49], v[88:91], a[108:111], v[46:49]
    ds_read_b128 v[112:115], v164 offset:2688
    s_add_u32 m0, s81, 30720
    s_add_u32 s80, s32, 49152
    buffer_load_dwordx4 v149, s[52:55], s80 offen offset:0 sc1 lds
    v_mfma_f32_16x16x32_bf16 v[46:49], a[96:99], v[92:95], v[46:49]
    s_waitcnt lgkmcnt(6)
    v_mfma_f32_16x16x32_bf16 v[46:49], v[96:99], a[100:103], v[46:49]
    s_waitcnt lgkmcnt(4)
    v_mfma_f32_16x16x32_bf16 v[26:29], a[128:131], v[100:103], v[26:29]
    ds_read_b64 v[52:53], v165 offset:3136
    v_mfma_f32_16x16x32_bf16 v[30:33], a[136:139], v[100:103], v[30:33]
    ds_read_b64 v[54:55], v165 offset:3144
    buffer_load_dwordx4 v149, s[52:55], s80 offen offset:2048 sc1 lds
    v_mfma_f32_16x16x32_bf16 v[34:37], a[144:147], v[100:103], v[34:37]
    ds_read_b128 v[56:59], v164 offset:3200
    v_mfma_f32_16x16x32_bf16 v[38:41], a[152:155], v[100:103], v[38:41]
    s_waitcnt lgkmcnt(6)
    v_mfma_f32_16x16x32_bf16 v[26:29], v[104:107], a[132:135], v[26:29]
    s_nop 0
    ds_read_b64 v[60:61], v165 offset:3648
    v_mfma_f32_16x16x32_bf16 v[30:33], v[104:107], a[140:143], v[30:33]
    ds_read_b64 v[62:63], v165 offset:3656
    s_add_u32 m0, s81, 34816
    s_add_u32 s80, s32, 53248
    buffer_load_dwordx4 v149, s[52:55], s80 offen offset:0 sc1 lds
    v_mfma_f32_16x16x32_bf16 v[34:37], v[104:107], a[148:151], v[34:37]
    ds_read_b128 v[64:67], v164 offset:3712
    v_mfma_f32_16x16x32_bf16 v[38:41], v[104:107], a[156:159], v[38:41]
    ds_read_b64 v[68:69], v165 offset:2048
    s_waitcnt lgkmcnt(7)
    v_mfma_f32_16x16x32_bf16 v[30:33], a[128:131], v[108:111], v[30:33]
    ds_read_b64 v[70:71], v165 offset:2056
    v_mfma_f32_16x16x32_bf16 v[34:37], a[136:139], v[108:111], v[34:37]
    buffer_load_dwordx4 v149, s[52:55], s80 offen offset:2048 sc1 lds
    v_mfma_f32_16x16x32_bf16 v[38:41], a[144:147], v[108:111], v[38:41]
    ds_read_b128 v[72:75], v164 offset:2240
    v_mfma_f32_16x16x32_bf16 v[30:33], v[112:115], a[132:135], v[30:33]
    v_mfma_f32_16x16x32_bf16 v[34:37], v[112:115], a[140:143], v[34:37]
    v_mfma_f32_16x16x32_bf16 v[38:41], v[112:115], a[148:151], v[38:41]
    s_add_u32 m0, s81, 38912
    s_add_u32 s80, s32, 57344
    buffer_load_dwordx4 v149, s[52:55], s80 offen offset:0 sc1 lds
    s_waitcnt lgkmcnt(6)
    v_mfma_f32_16x16x32_bf16 v[34:37], a[128:131], v[52:55], v[34:37]
    ds_read_b64 v[76:77], v165 offset:2560
    v_mfma_f32_16x16x32_bf16 v[38:41], a[136:139], v[52:55], v[38:41]
    ds_read_b64 v[78:79], v165 offset:2568
    v_mfma_f32_16x16x32_bf16 v[34:37], v[56:59], a[132:135], v[34:37]
    s_waitcnt vmcnt(12)
    v_cmp_ne_u32 vcc, v174, v51
    s_nop 1
    s_cbranch_vccnz L_slow_9
L_back_10:
    v_mfma_f32_16x16x32_bf16 v[38:41], v[56:59], a[140:143], v[38:41]
    ds_read_b128 v[80:83], v164 offset:2752
    buffer_load_dwordx4 v149, s[52:55], s80 offen offset:2048 sc1 lds
    s_waitcnt lgkmcnt(6)
    v_mfma_f32_16x16x32_bf16 v[38:41], a[128:131], v[60:63], v[38:41]
    v_mfma_f32_16x16x32_bf16 v[38:41], v[64:67], a[132:135], v[38:41]
    s_waitcnt lgkmcnt(4)
    v_mfma_f32_16x16x32_bf16 v[26:29], a[160:163], v[68:71], v[26:29]
    ds_read_b64 v[84:85], v165 offset:3072
    buffer_load_dword a240, v143, s[52:55], s14 offen sc1
    s_add_u32 s14, s14, 6144
    buffer_load_dword a241, v143, s[52:55], s14 offen sc1
    s_add_u32 s14, s14, 6144
    v_mfma_f32_16x16x32_bf16 v[30:33], a[168:171], v[68:71], v[30:33]
    ds_read_b64 v[86:87], v165 offset:3080
    v_mfma_f32_16x16x32_bf16 v[34:37], a[176:179], v[68:71], v[34:37]
    ds_read_b128 v[88:91], v164 offset:3264
    buffer_load_dword a242, v143, s[52:55], s14 offen sc1
    s_add_u32 s14, s14, 6144
    buffer_load_dword a243, v143, s[52:55], s14 offen sc1
    s_add_u32 s14, s14, 6144
    v_mfma_f32_16x16x32_bf16 v[38:41], a[184:187], v[68:71], v[38:41]
    buffer_load_dword a244, v143, s[52:55], s14 offen sc1
    s_add_u32 s14, s14, 6144
    buffer_load_dword a245, v143, s[52:55], s14 offen sc1
    s_add_u32 s14, s14, 6144
    s_waitcnt lgkmcnt(6)
    s_nop 0
    v_mfma_f32_16x16x32_bf16 v[26:29], v[72:75], a[164:167], v[26:29]
    ds_read_b64 v[92:93], v165 offset:3584
    v_mfma_f32_16x16x32_bf16 v[30:33], v[72:75], a[172:175], v[30:33]
    ds_read_b64 v[94:95], v165 offset:3592
    buffer_load_dword a246, v143, s[52:55], s14 offen sc1
    s_add_u32 s14, s14, 6144
    buffer_load_dword a247, v143, s[52:55], s14 offen sc1
    s_add_u32 s14, s14, 6144
    v_mfma_f32_16x16x32_bf16 v[34:37], v[72:75], a[180:183], v[34:37]
    ds_read_b128 v[96:99], v164 offset:3776
    buffer_load_dword a248, v143, s[52:55], s14 offen sc1
    s_add_u32 s14, s14, 6144
    buffer_load_dword a249, v143, s[52:55], s14 offen sc1
    s_add_u32 s14, s14, 6144
    v_mfma_f32_16x16x32_bf16 v[38:41], v[72:75], a[188:191], v[38:41]
    s_waitcnt lgkmcnt(6)
    v_mfma_f32_16x16x32_bf16 v[30:33], a[160:163], v[76:79], v[30:33]
    global_load_ushort a250, v141, s[26:27]
    v_mfma_f32_16x16x32_bf16 v[34:37], a[168:171], v[76:79], v[34:37]
    buffer_load_dwordx4 a[192:195], v183, s[52:55], s83 offen offset:0 sc1
    v_mfma_f32_16x16x32_bf16 v[38:41], a[176:179], v[76:79], v[38:41]
    v_mfma_f32_16x16x32_bf16 v[30:33], v[80:83], a[164:167], v[30:33]
    v_mfma_f32_16x16x32_bf16 v[34:37], v[80:83], a[172:175], v[34:37]
    v_mfma_f32_16x16x32_bf16 v[38:41], v[80:83], a[180:183], v[38:41]
    buffer_load_dwordx4 a[196:199], v183, s[52:55], s83 offen offset:1024 sc1
    s_waitcnt lgkmcnt(4)
    v_mfma_f32_16x16x32_bf16 v[34:37], a[160:163], v[84:87], v[34:37]
    v_mfma_f32_16x16x32_bf16 v[38:41], a[168:171], v[84:87], v[38:41]
    s_waitcnt lgkmcnt(3)
    v_mfma_f32_16x16x32_bf16 v[34:37], v[88:91], a[164:167], v[34:37]
    v_mfma_f32_16x16x32_bf16 v[38:41], v[88:91], a[172:175], v[38:41]
    buffer_load_dwordx4 a[200:203], v182, s[52:55], s83 offen offset:0 sc1
    s_waitcnt lgkmcnt(1)
    v_mfma_f32_16x16x32_bf16 v[38:41], a[160:163], v[92:95], v[38:41]
    s_waitcnt lgkmcnt(0)
    v_mfma_f32_16x16x32_bf16 v[38:41], v[96:99], a[164:167], v[38:41]
    ds_write_b128 v170, v[42:45] offset:2048
    ds_write_b128 v170, v[46:49] offset:3072
    ds_write2_b64 v170, v[28:29], v[32:33] offset0:0 offset1:1
    s_nop 4
    ds_write2_b64 v170, v[36:37], v[40:41] offset0:128 offset1:129
    v_lshlrev_b32 v150, 16, v159
    buffer_load_dwordx4 a[204:207], v182, s[52:55], s83 offen offset:1024 sc1
    v_and_b32 v151, 0xffff0000, v159
    v_add_f32 v26, v26, v150
    v_add_f32 v27, v27, v151
    v_lshlrev_b32 v150, 16, v160
    v_and_b32 v151, 0xffff0000, v160
    v_add_f32 v30, v30, v150
    v_add_f32 v31, v31, v151
    buffer_load_dwordx4 a[208:211], v142, s[52:55], s83 offen offset:0 sc1
    v_lshlrev_b32 v150, 16, v161
    v_and_b32 v151, 0xffff0000, v161
    v_add_f32 v34, v34, v150
    v_add_f32 v35, v35, v151
    v_lshlrev_b32 v150, 16, v162
    v_and_b32 v151, 0xffff0000, v162
    v_add_f32 v38, v38, v150
    v_add_f32 v39, v39, v151
    v_lshlrev_b32 v152, 16, v163
    v_and_b32 v153, 0xffff0000, v163
    s_waitcnt lgkmcnt(0)
    s_barrier
    s_nop 0
    s_add_u32 s83, s83, 5120
    buffer_load_dwordx4 a[212:215], v183, s[52:55], s83 offen offset:0 sc1
    ds_read_b128 v[116:119], v171
    ds_read_b128 v[120:123], v171 offset:1024
    ds_read2st64_b64 v[124:127], v148 offset0:4 offset1:12
    ds_read2st64_b64 v[128:131], v148 offset0:20 offset1:28
    s_waitcnt lgkmcnt(2)
    v_add_f32 v26, v26, v116
    v_add_f32 v27, v27, v117
    v_cvt_pk_bf16_f32 v28, v26, v27
    buffer_load_dwordx4 a[216:219], v183, s[52:55], s83 offen offset:1024 sc1
    buffer_store_dword v28, v169, s[52:55], s88 offen sc1
    s_add_u32 s88, s88, 327680
    v_add_f32 v30, v30, v118
    v_add_f32 v31, v31, v119
    v_cvt_pk_bf16_f32 v32, v30, v31
    buffer_store_dword v32, v169, s[52:55], s88 offen sc1
    s_add_u32 s88, s88, 327680
    buffer_load_dwordx4 a[220:223], v182, s[52:55], s83 offen offset:0 sc1
    v_add_f32 v34, v34, v120
    v_add_f32 v35, v35, v121
    v_cvt_pk_bf16_f32 v36, v34, v35
    buffer_store_dword v36, v169, s[52:55], s88 offen sc1
    s_add_u32 s88, s88, 327680
    v_add_f32 v38, v38, v122
    v_add_f32 v39, v39, v123
    v_cvt_pk_bf16_f32 v40, v38, v39
    buffer_load_dwordx4 a[224:227], v182, s[52:55], s83 offen offset:1024 sc1
    buffer_store_dword v40, v169, s[52:55], s88 offen sc1
    s_add_u32 s88, s88, 327680
    s_waitcnt lgkmcnt(0)
    v_add_f32 v152, v152, v124
    v_add_f32 v153, v153, v125
    v_add_f32 v152, v152, v126
    v_add_f32 v153, v153, v127
    v_add_f32 v152, v152, v128
    v_add_f32 v153, v153, v129
    v_add_f32 v152, v152, v130
    buffer_load_dwordx4 a[228:231], v142, s[52:55], s83 offen offset:0 sc1
    v_add_f32 v153, v153, v131
    v_cvt_pk_bf16_f32 v152, v152, v153
    buffer_store_dword v152, v169, s[52:55], s89 offen sc1
    s_add_u32 s89, s89, 1310720
    s_mov_b32 s3, 32768
    buffer_load_dword v51, v173, s[52:55], s3 offen sc1
    s_add_u32 s83, s83, 5120
    buffer_load_dwordx4 a[232:235], v183, s[52:55], s83 offen offset:0 sc1
    buffer_load_dwordx4 a[236:239], v183, s[52:55], s83 offen offset:1024 sc1
    buffer_load_dwordx4 a[0:3], v182, s[52:55], s83 offen offset:0 sc1
    buffer_load_dwordx4 a[4:7], v182, s[52:55], s83 offen offset:1024 sc1
    buffer_load_dwordx4 a[8:11], v142, s[52:55], s83 offen offset:0 sc1
    s_add_u32 s83, s83, 5120
    buffer_load_dwordx4 a[12:15], v183, s[52:55], s83 offen offset:0 sc1
    buffer_load_dwordx4 a[16:19], v183, s[52:55], s83 offen offset:1024 sc1
    buffer_load_dwordx4 a[20:23], v182, s[52:55], s83 offen offset:0 sc1
    s_waitcnt vmcnt(8)
    v_cmp_ne_u32 vcc, v174, v51
    s_nop 1
    s_cbranch_vccnz L_slow_11
L_back_12:
    s_barrier
    s_add_u32 m0, s8, 0
    s_nop 0
    s_nop 0
    buffer_load_dwordx4 v176, s[52:55], s16 offen offset:0 sc1 lds
    buffer_load_dwordx4 v176, s[52:55], s16 offen offset:1024 sc1 lds
    buffer_load_dwordx4 v176, s[52:55], s16 offen offset:2048 sc1 lds
    buffer_load_dwordx4 v176, s[52:55], s16 offen offset:3072 sc1 lds
    s_add_u32 m0, s8, 1024
    s_nop 0
    buffer_load_dwordx4 v139, s[52:55], s16 offen offset:3072 sc1 lds
    s_add_u32 m0, s8, 5120
    s_nop 0
    buffer_load_dwordx4 v176, s[52:55], s17 offen offset:0 sc1 lds
    buffer_load_dwordx4 v176, s[52:55], s17 offen offset:1024 sc1 lds
    buffer_load_dwordx4 v176, s[52:55], s17 offen offset:2048 sc1 lds
    s_branch L_conv_done
L_slow_1:
    s_sleep 3
    s_sub_u32 s93, s93, 1
    s_cbranch_scc1 L_fail
    s_mov_b64 exec, vcc
    buffer_load_dword v20, v122, s[52:55], 0 offen sc1
    s_waitcnt vmcnt(0)
    v_cmp_ne_u32 vcc, v15, v20
    s_nop 1
    s_cbranch_vccnz L_slow_1
    s_mov_b64 exec, -1
    s_branch L_back_2
L_slow_3:
    s_sleep 3
    s_sub_u32 s93, s93, 1
    s_cbranch_scc1 L_fail
    buffer_load_dwordx4 v[216:219], v176, s[52:55], s7 offen offset:0 sc1
    buffer_load_dwordx4 v[220:223], v176, s[52:55], s7 offen offset:1024 sc1
    buffer_load_dwordx4 v[224:227], v176, s[52:55], s7 offen offset:2048 sc1
    buffer_load_dwordx4 v[228:231], v176, s[52:55], s7 offen offset:3072 sc1
    s_waitcnt vmcnt(0)
    v_xor_b32 v244, v219, v174
    v_xor_b32 v245, v223, v174
    v_xor_b32 v246, v227, v174
    v_xor_b32 v247, v231, v174
    v_or3_b32 v244, v244, v245, v246
    v_or_b32 v244, v244, v247
    v_cmp_ne_u32 vcc, 0, v244
    s_nop 1
    s_cbranch_vccnz L_slow_3
    s_mov_b64 exec, -1
    s_branch L_back_4
L_slow_5:
    s_sleep 3
    s_sub_u32 s93, s93, 1
    s_cbranch_scc1 L_fail
    s_mov_b64 exec, vcc
    buffer_load_dword v50, v140, s[52:55], 0 offen sc1
    s_waitcnt vmcnt(0)
    v_cmp_ne_u32 vcc, v174, v50
    s_nop 1
    s_cbranch_vccnz L_slow_5
    s_mov_b64 exec, -1
    s_branch L_back_6
L_slow_9:
    s_sleep 3
    s_sub_u32 s93, s93, 1
    s_cbranch_scc1 L_fail
    s_mov_b64 exec, vcc
    s_mov_b32 s3, 131328
    buffer_load_dword v51, v178, s[52:55], s3 offen sc1
    s_waitcnt vmcnt(0)
    v_cmp_ne_u32 vcc, v174, v51
    s_nop 1
    s_cbranch_vccnz L_slow_9
    s_mov_b64 exec, -1
    s_branch L_back_10
L_slow_11:
    s_sleep 3
    s_sub_u32 s93, s93, 1
    s_cbranch_scc1 L_fail
    s_mov_b64 exec, vcc
    s_mov_b32 s3, 32768
    buffer_load_dword v51, v173, s[52:55], s3 offen sc1
    s_waitcnt vmcnt(0)
    v_cmp_ne_u32 vcc, v174, v51
    s_nop 1
    s_cbranch_vccnz L_slow_11
    s_mov_b64 exec, -1
    s_branch L_back_12
L_slow_13:
    s_sleep 3
    s_sub_u32 s93, s93, 1
    s_cbranch_scc1 L_fail
    s_mov_b64 exec, vcc
    buffer_load_dword v50, v140, s[52:55], 0 offen sc1
    s_waitcnt vmcnt(0)
    v_cmp_ne_u32 vcc, v174, v50
    s_nop 1
    s_cbranch_vccnz L_slow_13
    s_mov_b64 exec, -1
    s_branch L_back_14
L_slow_17:
    s_sleep 3
    s_sub_u32 s93, s93, 1
    s_cbranch_scc1 L_fail
    s_mov_b64 exec, vcc
    s_mov_b32 s3, 131328
    buffer_load_dword v51, v178, s[52:55], s3 offen sc1
    s_waitcnt vmcnt(0)
    v_cmp_ne_u32 vcc, v174, v51
    s_nop 1
    s_cbranch_vccnz L_slow_17
    s_mov_b64 exec, -1
    s_branch L_back_18
L_slow_19:
    s_sleep 3
    s_sub_u32 s93, s93, 1
    s_cbranch_scc1 L_fail
    s_mov_b64 exec, vcc
    s_mov_b32 s3, 32768
    buffer_load_dword v51, v173, s[52:55], s3 offen sc1
    s_waitcnt vmcnt(0)
    v_cmp_ne_u32 vcc, v174, v51
    s_nop 1
    s_cbranch_vccnz L_slow_19
    s_mov_b64 exec, -1
    s_branch L_back_20
L_slow_23:
    s_sleep 3
    s_sub_u32 s93, s93, 1
    s_cbranch_scc1 L_fail
    buffer_load_dword v116, v180, s[52:55], s39 offen offset:0 sc1
    buffer_load_dword v117, v180, s[52:55], s39 offen offset:256 sc1
    buffer_load_dword v118, v180, s[52:55], s39 offen offset:512 sc1
    buffer_load_dword v119, v180, s[52:55], s39 offen offset:768 sc1
    buffer_load_dword v120, v180, s[52:55], s39 offen offset:1024 sc1
    buffer_load_dword v121, v180, s[52:55], s39 offen offset:1280 sc1
    buffer_load_dword v122, v180, s[52:55], s39 offen offset:1536 sc1
    buffer_load_dword v123, v180, s[52:55], s39 offen offset:1792 sc1
    s_waitcnt vmcnt(0)
    v_and_b32 v126, v116, v117
    v_bitop3_b32 v126, v126, v118, v119 bitop3:0x80
    v_bitop3_b32 v126, v126, v120, v121 bitop3:0x80
    v_bitop3_b32 v126, v126, v122, v123 bitop3:0x80
    v_and_b32 v126, 1, v126
    v_cmp_eq_u32 vcc, 0, v126
    s_nop 1
    s_cbranch_vccnz L_slow_23
    s_mov_b64 exec, -1
    s_branch L_back_24
L_slow_25:
    s_sleep 3
    s_sub_u32 s93, s93, 1
    s_cbranch_scc1 L_fail
    s_mov_b64 exec, vcc
    s_mov_b32 s3, 36864
    buffer_load_dword v51, v173, s[52:55], s3 offen sc1
    s_waitcnt vmcnt(0)
    v_cmp_ne_u32 vcc, v174, v51
    s_nop 1
    s_cbranch_vccnz L_slow_25
    s_mov_b64 exec, -1
    s_branch L_back_26
L_slow_29:
    s_sleep 3
    s_sub_u32 s93, s93, 1
    s_cbranch_scc1 L_fail
    s_nop 0
    buffer_load_dword v116, v180, s[52:55], s39 offen offset:0 sc1
    buffer_load_dword v117, v180, s[52:55], s39 offen offset:256 sc1
    buffer_load_dword v118, v180, s[52:55], s39 offen offset:512 sc1
    buffer_load_dword v119, v180, s[52:55], s39 offen offset:768 sc1
    buffer_load_dword v120, v180, s[52:55], s39 offen offset:1024 sc1
    buffer_load_dword v121, v180, s[52:55], s39 offen offset:1280 sc1
    buffer_load_dword v122, v180, s[52:55], s39 offen offset:1536 sc1
    buffer_load_dword v123, v180, s[52:55], s39 offen offset:1792 sc1
    s_waitcnt vmcnt(0)
    v_and_b32 v126, v116, v117
    v_bitop3_b32 v126, v126, v118, v119 bitop3:0x80
    v_bitop3_b32 v126, v126, v120, v121 bitop3:0x80
    v_bitop3_b32 v126, v126, v122, v123 bitop3:0x80
    v_and_b32 v126, 1, v126
    v_cmp_eq_u32 vcc, 0, v126
    s_nop 1
    s_cbranch_vccnz L_slow_29
    s_mov_b64 exec, -1
    s_branch L_back_30
L_slow_31:
    s_sleep 3
    s_sub_u32 s93, s93, 1
    s_cbranch_scc1 L_fail
    s_mov_b64 exec, vcc
    s_mov_b32 s3, 458752
    buffer_load_dword v51, v136, s[52:55], s3 offen sc1
    s_waitcnt vmcnt(0)
    v_cmp_ne_u32 vcc, v174, v51
    s_nop 1
    s_cbranch_vccnz L_slow_31
    s_mov_b64 exec, -1
    s_branch L_back_32
L_slow_33:
    s_sleep 3
    s_sub_u32 s93, s93, 1
    s_cbranch_scc1 L_fail
    s_add_u32 s3, s80, 3145728
    buffer_load_dwordx4 v[184:187], v240, s[52:55], s3 offen sc1
    buffer_load_dwordx4 v[188:191], v241, s[52:55], s3 offen sc1
    s_waitcnt vmcnt(0)
    v_max_u32 v82, v184, v188
    v_cmp_eq_u32 vcc, -1, v82
    s_nop 1
    s_cbranch_vccnz L_slow_33
    s_mov_b64 exec, -1
    s_branch L_back_34
L_slow_35:
    s_sleep 3
    s_sub_u32 s93, s93, 1
    s_cbranch_scc1 L_fail
    s_add_u32 s3, s80, 3147776
    buffer_load_dwordx4 v[192:195], v240, s[52:55], s3 offen sc1
    buffer_load_dwordx4 v[196:199], v241, s[52:55], s3 offen sc1
    s_waitcnt vmcnt(0)
    v_max_u32 v82, v192, v196
    v_cmp_eq_u32 vcc, -1, v82
    s_nop 1
    s_cbranch_vccnz L_slow_35
    s_mov_b64 exec, -1
    s_branch L_back_36
L_slow_37:
    s_sleep 3
    s_sub_u32 s93, s93, 1
    s_cbranch_scc1 L_fail
    s_add_u32 s3, s80, 3149824
    buffer_load_dwordx4 v[200:203], v240, s[52:55], s3 offen sc1
    buffer_load_dwordx4 v[204:207], v241, s[52:55], s3 offen sc1
    s_waitcnt vmcnt(0)
    v_max_u32 v82, v200, v204
    v_cmp_eq_u32 vcc, -1, v82
    s_nop 1
    s_cbranch_vccnz L_slow_37
    s_mov_b64 exec, -1
    s_branch L_back_38
L_slow_39:
    s_sleep 3
    s_sub_u32 s93, s93, 1
    s_cbranch_scc1 L_fail
    s_add_u32 s3, s80, 3151872
    buffer_load_dwordx4 v[208:211], v240, s[52:55], s3 offen sc1
    buffer_load_dwordx4 v[212:215], v241, s[52:55], s3 offen sc1
    s_waitcnt vmcnt(0)
    v_max_u32 v82, v208, v212
    v_cmp_eq_u32 vcc, -1, v82
    s_nop 1
    s_cbranch_vccnz L_slow_39
    s_mov_b64 exec, -1
    s_branch L_back_40
L_slow_41:
    s_sleep 3
    s_sub_u32 s93, s93, 1
    s_cbranch_scc1 L_fail
    s_add_u32 s3, s80, 3153920
    buffer_load_dwordx4 v[216:219], v240, s[52:55], s3 offen sc1
    buffer_load_dwordx4 v[220:223], v241, s[52:55], s3 offen sc1
    s_waitcnt vmcnt(0)
    v_max_u32 v82, v216, v220
    v_cmp_eq_u32 vcc, -1, v82
    s_nop 1
    s_cbranch_vccnz L_slow_41
    s_mov_b64 exec, -1
    s_branch L_back_42
L_slow_43:
    s_sleep 3
    s_sub_u32 s93, s93, 1
    s_cbranch_scc1 L_fail
    s_add_u32 s3, s80, 3155968
    buffer_load_dwordx4 v[224:227], v240, s[52:55], s3 offen sc1
    buffer_load_dwordx4 v[228:231], v241, s[52:55], s3 offen sc1
    s_waitcnt vmcnt(0)
    v_max_u32 v82, v224, v228
    v_cmp_eq_u32 vcc, -1, v82
    s_nop 1
    s_cbranch_vccnz L_slow_43
    s_mov_b64 exec, -1
    s_branch L_back_44
L_slow_45:
    s_sleep 3
    s_sub_u32 s93, s93, 1
    s_cbranch_scc1 L_fail
    s_add_u32 s3, s80, 3158016
    buffer_load_dwordx4 v[84:87], v240, s[52:55], s3 offen sc1
    buffer_load_dwordx4 v[88:91], v241, s[52:55], s3 offen sc1
    s_waitcnt vmcnt(0)
    v_max_u32 v82, v84, v88
    v_cmp_eq_u32 vcc, -1, v82
    s_nop 1
    s_cbranch_vccnz L_slow_45
    s_mov_b64 exec, -1
    s_branch L_back_46
L_slow_47:
    s_sleep 3
    s_sub_u32 s93, s93, 1
    s_cbranch_scc1 L_fail
    s_add_u32 s3, s80, 3160064
    buffer_load_dwordx4 v[92:95], v240, s[52:55], s3 offen sc1
    buffer_load_dwordx4 v[96:99], v241, s[52:55], s3 offen sc1
    s_waitcnt vmcnt(0)
    v_max_u32 v82, v92, v96
    v_cmp_eq_u32 vcc, -1, v82
    s_nop 1
    s_cbranch_vccnz L_slow_47
    s_mov_b64 exec, -1
    s_branch L_back_48
L_slow_49:
    s_sleep 3
    s_sub_u32 s93, s93, 1
    s_cbranch_scc1 L_fail
    s_add_u32 s3, s80, 3162112
    buffer_load_dwordx4 v[100:103], v240, s[52:55], s3 offen sc1
    buffer_load_dwordx4 v[104:107], v241, s[52:55], s3 offen sc1
    s_waitcnt vmcnt(0)
    v_max_u32 v82, v100, v104
    v_cmp_eq_u32 vcc, -1, v82
    s_nop 1
    s_cbranch_vccnz L_slow_49
    s_mov_b64 exec, -1
    s_branch L_back_50
L_slow_51:
    s_sleep 3
    s_sub_u32 s93, s93, 1
    s_cbranch_scc1 L_fail
    s_add_u32 s3, s80, 3164160
    buffer_load_dwordx4 v[108:111], v240, s[52:55], s3 offen sc1
    buffer_load_dwordx4 v[112:115], v241, s[52:55], s3 offen sc1
    s_waitcnt vmcnt(0)
    v_max_u32 v82, v108, v112
    v_cmp_eq_u32 vcc, -1, v82
    s_nop 1
    s_cbranch_vccnz L_slow_51
    s_mov_b64 exec, -1
    s_branch L_back_52
L_slow_53:
    s_sleep 3
    s_sub_u32 s93, s93, 1
    s_cbranch_scc1 L_fail
    s_add_u32 s3, s80, 3166208
    buffer_load_dwordx4 v[116:119], v240, s[52:55], s3 offen sc1
    buffer_load_dwordx4 v[120:123], v241, s[52:55], s3 offen sc1
    s_waitcnt vmcnt(0)
    v_max_u32 v82, v116, v120
    v_cmp_eq_u32 vcc, -1, v82
    s_nop 1
    s_cbranch_vccnz L_slow_53
    s_mov_b64 exec, -1
    s_branch L_back_54
L_slow_55:
    s_sleep 3
    s_sub_u32 s93, s93, 1
    s_cbranch_scc1 L_fail
    s_add_u32 s3, s80, 3168256
    buffer_load_dwordx4 v[124:127], v240, s[52:55], s3 offen sc1
    buffer_load_dwordx4 v[128:131], v241, s[52:55], s3 offen sc1
    s_waitcnt vmcnt(0)
    v_max_u32 v82, v124, v128
    v_cmp_eq_u32 vcc, -1, v82
    s_nop 1
    s_cbranch_vccnz L_slow_55
    s_mov_b64 exec, -1
    s_branch L_back_56
L_codeend:
.if (L_codeend - sequential_preLN__ssm_conv_s4__dense_activation_gelu__prompt_kernel) < 49408
.fill (49408 - (L_codeend - sequential_preLN__ssm_conv_s4__dense_activation_gelu__prompt_kernel))/4, 4, 0xbf810000
.endif
.section .rodata,"a"
.p2align 6
.amdhsa_kernel sequential_preLN__ssm_conv_s4__dense_activation_gelu__prompt_kernel
  .amdhsa_next_free_vgpr 512
  .amdhsa_next_free_sgpr 102
  .amdhsa_accum_offset 256
  .amdhsa_group_segment_fixed_size 0
  .amdhsa_kernarg_size 136
  .amdhsa_user_sgpr_count 2
  .amdhsa_user_sgpr_kernarg_segment_ptr 1
  .amdhsa_system_sgpr_workgroup_id_x 1
.end_amdhsa_kernel
```
